```python
import torch

def _softmax(x, axis=-1):
    return torch.softmax(x, dim=axis)
def _gelu(x):
    return torch.nn.functional.gelu(x, approximate="tanh")
def _silu(x):
    return torch.nn.functional.silu(x)
def _sigmoid(x):
    return torch.sigmoid(x)
def _layernorm(x, axis=-1, eps=1e-5):
    m = x.mean(dim=axis, keepdim=True)
    v = x.var(dim=axis, keepdim=True, unbiased=False)
    return (x - m) / torch.sqrt(v + eps)
def _scatter_add(tgt, idx, src, axis=0):
    return tgt.clone().index_add_(axis, idx, src)
def _segment_sum(src, seg, n):
    out = torch.zeros((n,) + src.shape[1:], dtype=src.dtype)
    return out.index_add_(0, seg, src)
def _pad(x, pw):
    flat = tuple(v for pair in reversed(pw) for v in pair)
    return torch.nn.functional.pad(x, flat)

kernel_name = 'gated_mix__ssm_conv_s4__swiglu_ffn__prompt'

def setup_inputs():

    _w = (lambda a: (lambda t: t.to(torch.bfloat16) if t.is_floating_point() else t)(torch.as_tensor(a)))
    def _A_setup():
        B, L, D, N = 1, 2048, 576, 128
        A_re = -(lambda _x: torch.exp(torch.as_tensor(_x)))((lambda *s: torch.randn(*s, dtype=torch.bfloat16) * 3.2)(D, N))
        A_im = torch.pi * (lambda *s: torch.randn(*s, dtype=torch.bfloat16) * 0.05)(D, N)
        B_re = (lambda *s: torch.randn(*s, dtype=torch.bfloat16) * 0.1)(D, N)
        B_im = (lambda *s: torch.randn(*s, dtype=torch.bfloat16) * 0.1)(D, N)
        C_re = (lambda *s: torch.randn(*s, dtype=torch.bfloat16) * 0.1)(D, N)
        C_im = (lambda *s: torch.randn(*s, dtype=torch.bfloat16) * 0.1)(D, N)
        log_dt = (lambda *s: torch.randn(*s, dtype=torch.bfloat16) * 0.05)(D) * 0.5 - 4.0
        Dskip = (lambda *s: torch.randn(*s, dtype=torch.bfloat16) * 0.05)(D)
        return {
            "u": _w((lambda *s: torch.randn(*s, dtype=torch.bfloat16) * 0.05)(B, L, D)),
            "A_re": _w(A_re),
            "A_im": _w(A_im),
            "B_re": _w(B_re),
            "B_im": _w(B_im),
            "C_re": _w(C_re),
            "C_im": _w(C_im),
            "log_dt": _w(log_dt),
            "Dskip": _w(Dskip),
        }
    _A_in = _A_setup()

    def _B_setup():
        B, S, D, F = 1, 2048, 576, 4608
        return {
            "x": _w((lambda *s: torch.randn(*s, dtype=torch.bfloat16) * 0.05)(B, S, D)),
            "w_gate": _w((lambda *s: torch.randn(*s, dtype=torch.bfloat16) * 0.05)(D, F)),
            "w_up": _w((lambda *s: torch.randn(*s, dtype=torch.bfloat16) * 0.05)(D, F)),
            "w_down": _w((lambda *s: torch.randn(*s, dtype=torch.bfloat16) * 0.05)(F, D)),
        }
    _B_in = _B_setup()

    return {
        "A_u": _A_in["u"],
        "A_A_re": _A_in["A_re"],
        "A_A_im": _A_in["A_im"],
        "A_B_re": _A_in["B_re"],
        "A_B_im": _A_in["B_im"],
        "A_C_re": _A_in["C_re"],
        "A_C_im": _A_in["C_im"],
        "A_log_dt": _A_in["log_dt"],
        "A_Dskip": _A_in["Dskip"],
        "B_x": _B_in["x"],
        "B_w_gate": _B_in["w_gate"],
        "B_w_up": _B_in["w_up"],
        "B_w_down": _B_in["w_down"],
        "gate_w": _w((lambda *s: torch.randn(*s, dtype=torch.bfloat16) * 0.05)(576) * 16.0),
    }

def reference(A_u, A_A_re, A_A_im, A_B_re, A_B_im, A_C_re, A_C_im, A_log_dt, A_Dskip, B_x, B_w_gate, B_w_up, B_w_down, gate_w):
    def _A_ref(u, A_re, A_im, B_re, B_im, C_re, C_im, log_dt, Dskip):
        Bsz, L, D = u.shape
        dt = torch.exp(log_dt)[:, None]
        A = A_re + 1j * A_im
        Bc = B_re + 1j * B_im
        Cc = C_re + 1j * C_im
        logdA = dt * A
        dB = dt * Bc
        l = (lambda x, dt: x.to(dt))(torch.arange(L), A_re.dtype)
        P = torch.exp(logdA[:, :, None] * l[None, None, :])
        K = torch.einsum("dn,dnl,dn->dl", Cc, P, dB).real
        L2 = 2 * L
        Kp = _pad(K, ((0, 0), (0, L)))
        up = (lambda x, *d: x.permute(*d))(u, 0, 2, 1)
        up = _pad(up, ((0, 0), (0, 0), (0, L)))
        Kf = (lambda x, axes=(-2,-1): torch.fft.rfft2(x.float(), dim=axes))(Kp[:, None, :], axes=(-2, -1))
        Uf = (lambda x, axes=(-2,-1): torch.fft.rfft2(x.float(), dim=axes))(up[:, :, None, :], axes=(-2, -1))
        Yf = Uf * Kf[None, :, :, :]
        y = (lambda x, s, axes=(-2,-1): torch.fft.irfft2(x, s=s, dim=axes).to(torch.bfloat16))(Yf, (1, L2), axes=(-2, -1))[:, :, 0, :L]
        y = (lambda x, *d: x.permute(*d))(y, 0, 2, 1) + u * Dskip[None, None, :]
        return y

    def _B_ref(x, w_gate, w_up, w_down):
        g = _silu(x @ w_gate)
        u = x @ w_up
        return (g * u) @ w_down

    x = A_u
    g = _sigmoid((x * gate_w).sum(-1, keepdims=True))
    a = _A_ref(x, A_A_re, A_A_im, A_B_re, A_B_im, A_C_re, A_C_im, A_log_dt, A_Dskip)
    b = _B_ref(x, B_w_gate, B_w_up, B_w_down)
    return g * a + (1 - g) * b
```

```asm
; @launch grid=(256,1,1) block=(256,1,1) lds=163840
.amdgcn_target "amdgcn-amd-amdhsa--gfx950"
.text
.globl gated_mix__ssm_conv_s4__swiglu_ffn__prompt_kernel
.p2align 8
.type gated_mix__ssm_conv_s4__swiglu_ffn__prompt_kernel,@function
gated_mix__ssm_conv_s4__swiglu_ffn__prompt_kernel:
    s_cmp_ge_u32 s2, 256
    s_cbranch_scc0 L_go
    s_endpgm
L_go:
    s_load_dwordx2 s[4:5], s[0:1], 0
    s_load_dwordx2 s[8:9], s[0:1], 80
    s_load_dwordx2 s[44:45], s[0:1], 88
    v_lshrrev_b32 v1, 6, v0
    s_and_b32 s29, s2, 7
    s_bfe_u32 s30, s2, 0x10003
    v_readfirstlane_b32 s22, v1
    s_lshl_b32 s20, s29, 1
    s_add_u32 s20, s20, s30
    s_lshr_b32 s21, s2, 4
    v_and_b32 v1, 63, v0
    s_mul_i32 s31, s20, 5
    s_add_u32 s31, s31, s21
    s_mul_i32 s32, s31, 7282
    s_lshr_b32 s32, s32, 16
    s_mul_i32 s32, s32, 9
    s_sub_u32 s50, s31, s32
    s_lshl_b32 s29, s21, 2
    s_add_u32 s29, s29, s22
    s_mul_i32 s28, s29, 36864
    s_mul_i32 s23, s22, 3072
    s_lshl_b32 s24, s22, 12
    v_lshrrev_b32 v56, 3, v1
    v_mul_u32_u24 v56, 1152, v56
    v_lshrrev_b32 v57, 4, v1
    v_and_b32 v58, 7, v1
    v_xor_b32 v57, v57, v58
    v_lshl_add_u32 v27, v57, 4, v56
    v_xor_b32 v57, 4, v57
    v_lshl_add_u32 v28, v57, 4, v56
    v_add_u32 v28, 8192, v28
    v_add_u32 v29, 16384, v27
    v_add_u32 v30, 16384, v28
    s_mul_i32 s69, s50, 128
    s_add_u32 s69, s69, s28
    s_mov_b32 s6, 2359296
    s_mov_b32 s7, 0x00020000
    s_mov_b32 s10, 5308416
    s_mov_b32 s11, 0x00020000
    s_waitcnt lgkmcnt(0)
    s_and_b32 s5, s5, 0xffff
    s_add_u32 m0, s24, 147456
    s_nop 0
    buffer_load_dwordx4 v27, s[4:7], s69 offen offset:0 lds
    buffer_load_dwordx4 v28, s[4:7], s69 offen offset:1024 lds
    buffer_load_dwordx4 v29, s[4:7], s69 offen offset:2048 lds
    buffer_load_dwordx4 v30, s[4:7], s69 offen offset:3072 lds
    s_mul_i32 s30, s20, 576
    s_mul_i32 s60, s50, 589824
    s_add_u32 s60, s60, s30
    s_and_b32 s29, s22, 1
    s_lshl_b32 s29, s29, 4
    v_add_u32 v56, 0, v1
    v_mul_u32_u24 v57, 43691, v56
    v_lshrrev_b32 v57, 19, v57
    v_mul_u32_u24 v58, 12, v57
    v_sub_u32 v58, v56, v58
    v_add_u32 v57, s29, v57
    v_bfe_u32 v59, v57, 3, 1
    v_lshlrev_b32 v59, 1, v59
    v_xor_b32 v58, v58, v59
    v_mul_u32_u24 v57, 9216, v57
    v_lshl_add_u32 v2, v58, 4, v57
    v_add_u32 v5, 294912, v2
    v_add_u32 v56, 64, v1
    v_mul_u32_u24 v57, 43691, v56
    v_lshrrev_b32 v57, 19, v57
    v_mul_u32_u24 v58, 12, v57
    v_sub_u32 v58, v56, v58
    v_add_u32 v57, s29, v57
    v_bfe_u32 v59, v57, 3, 1
    v_lshlrev_b32 v59, 1, v59
    v_xor_b32 v58, v58, v59
    v_mul_u32_u24 v57, 9216, v57
    v_lshl_add_u32 v3, v58, 4, v57
    v_subrev_u32 v3, 1024, v3
    v_add_u32 v6, 294912, v3
    v_add_u32 v56, 128, v1
    v_mul_u32_u24 v57, 43691, v56
    v_lshrrev_b32 v57, 19, v57
    v_mul_u32_u24 v58, 12, v57
    v_sub_u32 v58, v56, v58
    v_add_u32 v57, s29, v57
    v_bfe_u32 v59, v57, 3, 1
    v_lshlrev_b32 v59, 1, v59
    v_xor_b32 v58, v58, v59
    v_mul_u32_u24 v57, 9216, v57
    v_lshl_add_u32 v4, v58, 4, v57
    v_subrev_u32 v4, 2048, v4
    v_add_u32 v7, 294912, v4
    s_cmp_ge_u32 s22, 2
    s_cselect_b32 s8, s44, s8
    s_cselect_b32 s9, s45, s9
    s_and_b32 s9, s9, 0xffff
    s_add_u32 m0, s23, 0
    s_nop 0
    buffer_load_dwordx4 v2, s[8:11], s60 offen offset:0 lds
    buffer_load_dwordx4 v3, s[8:11], s60 offen offset:1024 lds
    buffer_load_dwordx4 v4, s[8:11], s60 offen offset:2048 lds
    s_add_u32 m0, s23, 12288
    s_nop 0
    buffer_load_dwordx4 v5, s[8:11], s60 offen offset:0 lds
    buffer_load_dwordx4 v6, s[8:11], s60 offen offset:1024 lds
    buffer_load_dwordx4 v7, s[8:11], s60 offen offset:2048 lds
    s_add_u32 s29, s30, 5308416
    s_add_u32 s61, s60, 589824
    s_cmp_eq_u32 s61, s29
    s_cselect_b32 s61, s30, s61
    s_add_u32 s29, s28, 1152
    s_add_u32 s70, s69, 128
    s_cmp_eq_u32 s70, s29
    s_cselect_b32 s70, s28, s70
    s_add_u32 m0, s24, 98304
    s_nop 0
    buffer_load_dwordx4 v27, s[4:7], s70 offen offset:0 lds
    buffer_load_dwordx4 v28, s[4:7], s70 offen offset:1024 lds
    buffer_load_dwordx4 v29, s[4:7], s70 offen offset:2048 lds
    buffer_load_dwordx4 v30, s[4:7], s70 offen offset:3072 lds
    s_add_u32 m0, s23, 24576
    s_nop 0
    buffer_load_dwordx4 v2, s[8:11], s61 offen offset:0 lds
    buffer_load_dwordx4 v3, s[8:11], s61 offen offset:1024 lds
    buffer_load_dwordx4 v4, s[8:11], s61 offen offset:2048 lds
    s_add_u32 m0, s23, 36864
    s_nop 0
    buffer_load_dwordx4 v5, s[8:11], s61 offen offset:0 lds
    buffer_load_dwordx4 v6, s[8:11], s61 offen offset:1024 lds
    buffer_load_dwordx4 v7, s[8:11], s61 offen offset:2048 lds
    s_load_dwordx2 s[12:13], s[0:1], 96
    s_load_dwordx2 s[16:17], s[0:1], 128
    s_load_dwordx2 s[36:37], s[0:1], 104
    s_load_dwordx8 s[52:59], s[0:1], 8
    s_load_dwordx4 s[96:99], s[0:1], 40
    s_load_dwordx2 s[100:101], s[0:1], 56
    s_load_dwordx2 s[44:45], s[0:1], 112
    s_mov_b32 s3, 0
    s_add_u32 s71, s70, 128
    s_cmp_eq_u32 s71, s29
    s_cselect_b32 s71, s28, s71
    s_add_u32 s72, s71, 128
    s_cmp_eq_u32 s72, s29
    s_cselect_b32 s72, s28, s72
    s_add_u32 s73, s72, 128
    s_cmp_eq_u32 s73, s29
    s_cselect_b32 s73, s28, s73
    s_add_u32 s74, s73, 128
    s_cmp_eq_u32 s74, s29
    s_cselect_b32 s74, s28, s74
    s_add_u32 s75, s74, 128
    s_cmp_eq_u32 s75, s29
    s_cselect_b32 s75, s28, s75
    s_add_u32 s76, s75, 128
    s_cmp_eq_u32 s76, s29
    s_cselect_b32 s76, s28, s76
    s_add_u32 s77, s76, 128
    s_cmp_eq_u32 s77, s29
    s_cselect_b32 s77, s28, s77
    s_add_u32 s29, s30, 5308416
    s_add_u32 s62, s61, 589824
    s_cmp_eq_u32 s62, s29
    s_cselect_b32 s62, s30, s62
    s_add_u32 s63, s62, 589824
    s_cmp_eq_u32 s63, s29
    s_cselect_b32 s63, s30, s63
    s_add_u32 s64, s63, 589824
    s_cmp_eq_u32 s64, s29
    s_cselect_b32 s64, s30, s64
    s_add_u32 s65, s64, 589824
    s_cmp_eq_u32 s65, s29
    s_cselect_b32 s65, s30, s65
    s_add_u32 s66, s65, 589824
    s_cmp_eq_u32 s66, s29
    s_cselect_b32 s66, s30, s66
    s_add_u32 s67, s66, 589824
    s_cmp_eq_u32 s67, s29
    s_cselect_b32 s67, s30, s67
    s_add_u32 s68, s67, 589824
    s_cmp_eq_u32 s68, s29
    s_cselect_b32 s68, s30, s68
    s_getpc_b64 s[40:41]
L_pc:
    s_and_b32 s41, s41, 0xffff
    s_mov_b32 s42, L_end-L_pc
    s_mov_b32 s43, 0x00020000
    s_lshl_b32 s29, s21, 12
    s_lshl_b32 s30, s22, 10
    s_add_u32 s29, s29, s30
    v_and_b32 v57, 15, v1
    v_lshl_add_u32 v56, v57, 6, s29
    v_lshrrev_b32 v57, 4, v1
    v_lshl_add_u32 v56, v57, 16, v56
    buffer_load_dword v55, v56, s[40:43], 0 offen
    s_load_dwordx2 s[40:41], s[0:1], 120
    s_and_b32 s29, s2, 7
    s_bfe_u32 s30, s2, 0x10003
    s_sub_u32 s31, s21, 9
    s_cmp_ge_u32 s21, 9
    s_cselect_b32 s51, s31, s21
    s_mul_i32 s48, s29, 18
    s_lshr_b32 s31, s21, 1
    s_and_b32 s32, s21, 1
    s_add_u32 s32, s32, 16
    s_cmp_eq_u32 s30, 0
    s_cselect_b32 s32, s21, s32
    s_cselect_b32 s33, s29, s31
    s_add_u32 s48, s48, s32
    s_cmp_eq_u32 s33, s29
    s_cselect_b32 s48, s48, -1
    s_cmp_gt_u32 s29, s31
    s_cselect_b32 s32, 1, 0
    s_sub_u32 s32, s29, s32
    s_cmp_eq_u32 s30, 0
    s_cselect_b32 s33, s29, 8
    s_cmp_eq_u32 s48, -1
    s_cselect_b32 s49, s32, s33
    s_lshr_b32 s31, s20, 2
    s_lshl_b32 s32, 0x111, s31
    s_and_b32 s32, s32, 0x1ff
    s_lshl_b32 s33, s32, 9
    s_or_b32 s32, s32, s33
    s_lshr_b32 s25, s32, s50
    v_lshrrev_b32 v56, 4, v1
    v_bfe_u32 v57, v1, 2, 2
    v_lshl_add_u32 v57, v56, 3, v57
    v_mul_u32_u24 v57, 192, v57
    v_and_b32 v58, 3, v1
    v_lshl_add_u32 v57, v58, 3, v57
    v_and_b32 v59, 1, v56
    v_lshlrev_b32 v59, 5, v59
    v_add_u32 v17, v57, v59
    v_xor_b32 v59, 32, v59
    v_add_u32 v18, v57, v59
    s_add_u32 s29, s24, 98304
    v_and_b32 v57, 15, v1
    v_lshrrev_b32 v59, 1, v57
    v_xor_b32 v59, v56, v59
    v_lshlrev_b32 v60, 7, v57
    v_lshl_add_u32 v60, v59, 4, v60
    v_add_u32 v31, s29, v60
    v_xor_b32 v32, 64, v31
    s_and_b32 s30, s20, 3
    s_lshl_b32 s31, s30, 1
    v_bfe_u32 v59, v1, 2, 2
    v_sub_u32 v59, 3, v59
    v_lshl_add_u32 v59, v56, 3, v59
    v_bfe_u32 v60, v1, 1, 1
    v_add_u32 v60, s31, v60
    v_lshrrev_b32 v61, 1, v59
    v_and_b32 v61, 7, v61
    v_xor_b32 v60, v60, v61
    v_lshlrev_b32 v59, 7, v59
    v_and_b32 v61, 1, v1
    v_lshl_add_u32 v59, v61, 3, v59
    v_add_u32 v59, s29, v59
    v_lshl_add_u32 v34, v60, 4, v59
    v_xor_b32 v60, 2, v60
    v_lshl_add_u32 v33, v60, 4, v59
    v_add_u32 v33, 512, v33
    s_lshl_b32 s30, s30, 16
    s_lshl_b32 s31, s21, 8
    s_lshl_b32 s32, s22, 6
    s_add_u32 s31, s31, s32
    s_sub_u32 s30, s30, s31
    s_add_u32 s30, s30, 4198384
    v_lshlrev_b32 v57, 12, v57
    v_lshlrev_b32 v59, 4, v56
    v_sub_u32 v57, v57, v59
    v_add_u32 v35, s30, v57
    s_waitcnt lgkmcnt(0)
    s_and_b32 s13, s13, 0xffff
    s_mov_b32 s14, 5308416
    s_mov_b32 s15, 0x00020000
    s_and_b32 s17, s17, 0xffff
    s_mov_b32 s18, 268435456
    s_mov_b32 s19, 0x00020000
    s_and_b32 s37, s37, 0xffff
    s_mov_b32 s38, 1152
    s_mov_b32 s39, 0x00020000
    s_and_b32 s41, s41, 0xffff
    s_mov_b32 s42, 256
    s_mov_b32 s43, 0x00020000
    s_and_b32 s45, s45, 0xffff
    s_mov_b32 s46, 2359296
    s_mov_b32 s47, 0x00020000
    s_waitcnt vmcnt(11)
    s_barrier
    ds_read_b128 a[0:3], v31 offset:49152
    ds_read_b128 a[4:7], v31 offset:51200
    ds_read_b64_tr_b16 a[216:217], v17 offset:0
    ds_read_b64_tr_b16 a[218:219], v17 offset:768
    ds_read_b64_tr_b16 a[220:221], v17 offset:6144
    ds_read_b64_tr_b16 a[222:223], v17 offset:6912
    ds_read_b64_tr_b16 a[224:225], v18 offset:0
    ds_read_b64_tr_b16 a[226:227], v18 offset:768
    ds_read_b64_tr_b16 a[228:229], v18 offset:6144
    ds_read_b64_tr_b16 a[230:231], v18 offset:6912
    ds_read_b64_tr_b16 a[232:233], v17 offset:64
    ds_read_b64_tr_b16 a[234:235], v17 offset:832
    ds_read_b64_tr_b16 a[236:237], v17 offset:6208
    ds_read_b64_tr_b16 a[238:239], v17 offset:6976
    ds_read_b64_tr_b16 a[240:241], v18 offset:64
    ds_read_b64_tr_b16 a[242:243], v18 offset:832
    ds_read_b64_tr_b16 a[244:245], v18 offset:6208
    ds_read_b64_tr_b16 a[246:247], v18 offset:6976
    s_waitcnt lgkmcnt(10)
    v_mfma_f32_16x16x32_bf16 v[64:67], a[216:219], a[0:3], 0
    ds_read_b64_tr_b16 a[248:249], v17 offset:128
    ds_read_b64_tr_b16 a[250:251], v17 offset:896
    v_mfma_f32_16x16x32_bf16 v[68:71], a[216:219], a[4:7], 0
    v_mfma_f32_16x16x32_bf16 v[76:79], a[220:223], a[4:7], 0
    ds_read_b64_tr_b16 a[216:217], v17 offset:6272
    ds_read_b64_tr_b16 a[218:219], v17 offset:7040
    v_mfma_f32_16x16x32_bf16 v[72:75], a[220:223], a[0:3], 0
    s_add_u32 m0, s24, 114688
    v_mfma_f32_16x16x32_bf16 v[80:83], a[224:227], a[0:3], 0
    s_waitcnt lgkmcnt(8)
    ds_read_b64_tr_b16 a[220:221], v18 offset:128
    ds_read_b64_tr_b16 a[222:223], v18 offset:896
    v_mfma_f32_16x16x32_bf16 v[84:87], a[224:227], a[4:7], 0
    ds_read_b128 a[8:11], v32 offset:49152
    ds_read_b128 a[12:15], v32 offset:51200
    v_mfma_f32_16x16x32_bf16 v[92:95], a[228:231], a[4:7], 0
    ds_read_b64_tr_b16 a[224:225], v18 offset:6272
    ds_read_b64_tr_b16 a[226:227], v18 offset:7040
    v_mfma_f32_16x16x32_bf16 v[88:91], a[228:231], a[0:3], 0
    buffer_load_dwordx4 v27, s[4:7], s71 offen offset:0 lds
    v_mfma_f32_16x16x32_bf16 v[96:99], a[232:235], a[0:3], 0
    ds_read_b64_tr_b16 a[228:229], v17 offset:12288
    ds_read_b64_tr_b16 a[230:231], v17 offset:13056
    v_mfma_f32_16x16x32_bf16 v[100:103], a[232:235], a[4:7], 0
    buffer_load_dwordx4 v28, s[4:7], s71 offen offset:1024 lds
    v_mfma_f32_16x16x32_bf16 v[108:111], a[236:239], a[4:7], 0
    s_waitcnt lgkmcnt(10)
    ds_read_b64_tr_b16 a[232:233], v17 offset:18432
    ds_read_b64_tr_b16 a[234:235], v17 offset:19200
    v_mfma_f32_16x16x32_bf16 v[104:107], a[236:239], a[0:3], 0
    buffer_load_dwordx4 v29, s[4:7], s71 offen offset:2048 lds
    ds_read_b64_tr_b16 v[36:37], v33 offset:49152
    ds_read_b64_tr_b16 v[38:39], v34 offset:49152
    v_mfma_f32_16x16x32_bf16 v[112:115], a[240:243], a[0:3], 0
    ds_read_b64_tr_b16 a[236:237], v18 offset:12288
    ds_read_b64_tr_b16 a[238:239], v18 offset:13056
    v_mfma_f32_16x16x32_bf16 v[116:119], a[240:243], a[4:7], 0
    buffer_load_dwordx4 v30, s[4:7], s71 offen offset:3072 lds
    v_mfma_f32_16x16x32_bf16 v[124:127], a[244:247], a[4:7], 0
    ds_read_b64_tr_b16 a[240:241], v18 offset:18432
    ds_read_b64_tr_b16 a[242:243], v18 offset:19200
    v_mfma_f32_16x16x32_bf16 v[120:123], a[244:247], a[0:3], 0
    s_add_u32 m0, s23, 49152
    v_mfma_f32_16x16x32_bf16 v[128:131], a[248:251], a[0:3], 0
    s_waitcnt lgkmcnt(4)
    ds_read_b64_tr_b16 a[244:245], v17 offset:12352
    ds_read_b64_tr_b16 a[246:247], v17 offset:13120
    v_mfma_f32_16x16x32_bf16 v[132:135], a[248:251], a[4:7], 0
    buffer_load_dwordx4 v2, s[8:11], s62 offen offset:0 lds
    v_mfma_f32_16x16x32_bf16 v[140:143], a[216:219], a[4:7], 0
    ds_read_b64_tr_b16 a[248:249], v17 offset:18496
    ds_read_b64_tr_b16 a[250:251], v17 offset:19264
    v_mfma_f32_16x16x32_bf16 v[136:139], a[216:219], a[0:3], 0
    buffer_load_dwordx4 v3, s[8:11], s62 offen offset:1024 lds
    v_mfma_f32_16x16x32_bf16 v[144:147], a[220:223], a[0:3], 0
    ds_read_b64_tr_b16 a[216:217], v18 offset:12352
    ds_read_b64_tr_b16 a[218:219], v18 offset:13120
    v_mfma_f32_16x16x32_bf16 v[148:151], a[220:223], a[4:7], 0
    buffer_load_dwordx4 v4, s[8:11], s62 offen offset:2048 lds
    v_mfma_f32_16x16x32_bf16 v[156:159], a[224:227], a[4:7], 0
    s_waitcnt lgkmcnt(8)
    ds_read_b64_tr_b16 a[220:221], v18 offset:18496
    ds_read_b64_tr_b16 a[222:223], v18 offset:19264
    v_mfma_f32_16x16x32_bf16 v[152:155], a[224:227], a[0:3], 0
    s_sub_u32 s32, s69, s28
    s_lshl_b32 s32, s32, 11
    v_mfma_f32_16x16x32_bf16 v[64:67], a[228:231], a[8:11], v[64:67]
    ds_read_b64_tr_b16 a[224:225], v17 offset:12416
    ds_read_b64_tr_b16 a[226:227], v17 offset:13184
    v_mfma_f32_16x16x32_bf16 v[68:71], a[228:231], a[12:15], v[68:71]
    s_mul_i32 s29, s22, 24
    s_add_u32 m0, s23, 61440
    v_mfma_f32_16x16x32_bf16 v[76:79], a[232:235], a[12:15], v[76:79]
    ds_read_b64_tr_b16 a[228:229], v17 offset:18560
    ds_read_b64_tr_b16 a[230:231], v17 offset:19328
    v_mfma_f32_16x16x32_bf16 v[72:75], a[232:235], a[8:11], v[72:75]
    buffer_load_dwordx4 v5, s[8:11], s62 offen offset:0 lds
    v_mfma_f32_16x16x32_bf16 v[80:83], a[236:239], a[8:11], v[80:83]
    s_waitcnt lgkmcnt(8)
    ds_read_b64_tr_b16 a[232:233], v18 offset:12416
    ds_read_b64_tr_b16 a[234:235], v18 offset:13184
    v_mfma_f32_16x16x32_bf16 v[84:87], a[236:239], a[12:15], v[84:87]
    s_bitcmp1_b32 s25, 0
    s_cselect_b32 s32, s32, 0x7ff00000
    v_mfma_f32_16x16x32_bf16 v[92:95], a[240:243], a[12:15], v[92:95]
    s_waitcnt vmcnt(9)
    ds_read_b64_tr_b16 a[236:237], v18 offset:18560
    ds_read_b64_tr_b16 a[238:239], v18 offset:19328
    v_mfma_f32_16x16x32_bf16 v[88:91], a[240:243], a[8:11], v[88:91]
    s_barrier
    v_mfma_f32_16x16x32_bf16 v[96:99], a[244:247], a[8:11], v[96:99]
    ds_read_b64_tr_b16 a[240:241], v17 offset:24576
    ds_read_b64_tr_b16 a[242:243], v17 offset:25344
    v_mfma_f32_16x16x32_bf16 v[100:103], a[244:247], a[12:15], v[100:103]
    buffer_load_dwordx4 v6, s[8:11], s62 offen offset:1024 lds
    v_add_u32 v40, s32, v35
    v_mfma_f32_16x16x32_bf16 v[108:111], a[248:251], a[12:15], v[108:111]
    s_waitcnt lgkmcnt(8)
    ds_read_b64_tr_b16 a[244:245], v17 offset:30720
    ds_read_b64_tr_b16 a[246:247], v17 offset:31488
    v_mfma_f32_16x16x32_bf16 v[104:107], a[248:251], a[8:11], v[104:107]
    buffer_store_dwordx4 v[36:39], v40, s[16:19], 0 offen sc0 sc1
    v_mfma_f32_16x16x32_bf16 v[112:115], a[216:219], a[8:11], v[112:115]
    ds_read_b64_tr_b16 a[248:249], v18 offset:24576
    ds_read_b64_tr_b16 a[250:251], v18 offset:25344
    v_mfma_f32_16x16x32_bf16 v[116:119], a[216:219], a[12:15], v[116:119]
    buffer_load_dwordx4 v7, s[8:11], s62 offen offset:2048 lds
    ds_read_b128 a[16:19], v31 offset:0
    ds_read_b128 a[20:23], v31 offset:2048
    v_mfma_f32_16x16x32_bf16 v[124:127], a[220:223], a[12:15], v[124:127]
    ds_read_b64_tr_b16 a[216:217], v18 offset:30720
    ds_read_b64_tr_b16 a[218:219], v18 offset:31488
    v_mfma_f32_16x16x32_bf16 v[120:123], a[220:223], a[8:11], v[120:123]
    ds_read_b128 a[24:27], v32 offset:0
    ds_read_b128 a[28:31], v32 offset:2048
    v_lshrrev_b32 v56, 3, v1
    v_mfma_f32_16x16x32_bf16 v[128:131], a[224:227], a[8:11], v[128:131]
    s_waitcnt lgkmcnt(12)
    ds_read_b64_tr_b16 a[220:221], v17 offset:24640
    ds_read_b64_tr_b16 a[222:223], v17 offset:25408
    v_mfma_f32_16x16x32_bf16 v[132:135], a[224:227], a[12:15], v[132:135]
    ds_read_b64_tr_b16 v[36:37], v33 offset:0
    ds_read_b64_tr_b16 v[38:39], v34 offset:0
    s_add_u32 m0, s24, 131072
    v_mfma_f32_16x16x32_bf16 v[140:143], a[228:231], a[12:15], v[140:143]
    ds_read_b64_tr_b16 a[224:225], v17 offset:30784
    ds_read_b64_tr_b16 a[226:227], v17 offset:31552
    v_mfma_f32_16x16x32_bf16 v[136:139], a[228:231], a[8:11], v[136:139]
    buffer_load_dwordx4 v27, s[4:7], s72 offen offset:0 lds
    v_add_u32 v56, s29, v56
    v_mfma_f32_16x16x32_bf16 v[144:147], a[232:235], a[8:11], v[144:147]
    ds_read_b64_tr_b16 a[228:229], v18 offset:24640
    ds_read_b64_tr_b16 a[230:231], v18 offset:25408
    v_mfma_f32_16x16x32_bf16 v[148:151], a[232:235], a[12:15], v[148:151]
    buffer_load_dwordx4 v28, s[4:7], s72 offen offset:1024 lds
    v_mul_u32_u24 v56, 1152, v56
    v_mfma_f32_16x16x32_bf16 v[156:159], a[236:239], a[12:15], v[156:159]
    s_waitcnt lgkmcnt(12)
    ds_read_b64_tr_b16 a[232:233], v18 offset:30784
    ds_read_b64_tr_b16 a[234:235], v18 offset:31552
    v_mfma_f32_16x16x32_bf16 v[152:155], a[236:239], a[8:11], v[152:155]
    buffer_load_dwordx4 v29, s[4:7], s72 offen offset:2048 lds
    v_bfe_u32 v57, v1, 4, 2
    v_mfma_f32_16x16x32_bf16 v[64:67], a[240:243], a[16:19], v[64:67]
    ds_read_b64_tr_b16 a[236:237], v17 offset:24704
    ds_read_b64_tr_b16 a[238:239], v17 offset:25472
    v_mfma_f32_16x16x32_bf16 v[68:71], a[240:243], a[20:23], v[68:71]
    buffer_load_dwordx4 v30, s[4:7], s72 offen offset:3072 lds
    s_add_u32 m0, s23, 73728
    v_mfma_f32_16x16x32_bf16 v[76:79], a[244:247], a[20:23], v[76:79]
    ds_read_b64_tr_b16 a[240:241], v17 offset:30848
    ds_read_b64_tr_b16 a[242:243], v17 offset:31616
    v_mfma_f32_16x16x32_bf16 v[72:75], a[244:247], a[16:19], v[72:75]
    buffer_load_dwordx4 v2, s[8:11], s63 offen offset:0 lds
    v_lshlrev_b32 v57, 1, v57
    v_mfma_f32_16x16x32_bf16 v[80:83], a[248:251], a[16:19], v[80:83]
    s_waitcnt lgkmcnt(8)
    ds_read_b64_tr_b16 a[244:245], v18 offset:24704
    ds_read_b64_tr_b16 a[246:247], v18 offset:25472
    v_mfma_f32_16x16x32_bf16 v[84:87], a[248:251], a[20:23], v[84:87]
    buffer_load_dwordx4 v3, s[8:11], s63 offen offset:1024 lds
    v_and_b32 v58, 7, v1
    v_mfma_f32_16x16x32_bf16 v[92:95], a[216:219], a[20:23], v[92:95]
    ds_read_b64_tr_b16 a[248:249], v18 offset:30848
    ds_read_b64_tr_b16 a[250:251], v18 offset:31616
    v_mfma_f32_16x16x32_bf16 v[88:91], a[216:219], a[16:19], v[88:91]
    buffer_load_dwordx4 v4, s[8:11], s63 offen offset:2048 lds
    s_add_u32 m0, s23, 86016
    v_mfma_f32_16x16x32_bf16 v[96:99], a[220:223], a[16:19], v[96:99]
    ds_read_b64_tr_b16 a[216:217], v17 offset:36864
    ds_read_b64_tr_b16 a[218:219], v17 offset:37632
    v_mfma_f32_16x16x32_bf16 v[100:103], a[220:223], a[20:23], v[100:103]
    buffer_load_dwordx4 v5, s[8:11], s63 offen offset:0 lds
    v_xor_b32 v57, v57, v58
    v_mfma_f32_16x16x32_bf16 v[108:111], a[224:227], a[20:23], v[108:111]
    s_waitcnt lgkmcnt(8)
    ds_read_b64_tr_b16 a[220:221], v17 offset:43008
    ds_read_b64_tr_b16 a[222:223], v17 offset:43776
    v_mfma_f32_16x16x32_bf16 v[104:107], a[224:227], a[16:19], v[104:107]
    buffer_load_dwordx4 v6, s[8:11], s63 offen offset:1024 lds
    v_lshl_add_u32 v8, v57, 4, v56
    v_mfma_f32_16x16x32_bf16 v[112:115], a[228:231], a[16:19], v[112:115]
    ds_read_b64_tr_b16 a[224:225], v18 offset:36864
    ds_read_b64_tr_b16 a[226:227], v18 offset:37632
    v_mfma_f32_16x16x32_bf16 v[116:119], a[228:231], a[20:23], v[116:119]
    buffer_load_dwordx4 v7, s[8:11], s63 offen offset:2048 lds
    s_mul_i32 s29, s3, 110592
    v_mfma_f32_16x16x32_bf16 v[124:127], a[232:235], a[20:23], v[124:127]
    ds_read_b64_tr_b16 a[228:229], v18 offset:43008
    ds_read_b64_tr_b16 a[230:231], v18 offset:43776
    v_mfma_f32_16x16x32_bf16 v[120:123], a[232:235], a[16:19], v[120:123]
    v_add_u32 v8, s29, v8
    s_mov_b32 s29, 110592
    v_mfma_f32_16x16x32_bf16 v[128:131], a[236:239], a[16:19], v[128:131]
    s_waitcnt lgkmcnt(8)
    ds_read_b64_tr_b16 a[232:233], v17 offset:36928
    ds_read_b64_tr_b16 a[234:235], v17 offset:37696
    v_mfma_f32_16x16x32_bf16 v[132:135], a[236:239], a[20:23], v[132:135]
    s_sub_u32 s32, s70, s28
    s_add_u32 m0, s24, 147456
    v_mfma_f32_16x16x32_bf16 v[140:143], a[240:243], a[20:23], v[140:143]
    ds_read_b64_tr_b16 a[236:237], v17 offset:43072
    ds_read_b64_tr_b16 a[238:239], v17 offset:43840
    v_mfma_f32_16x16x32_bf16 v[136:139], a[240:243], a[16:19], v[136:139]
    buffer_load_dwordx4 v27, s[4:7], s73 offen offset:0 lds
    v_mfma_f32_16x16x32_bf16 v[144:147], a[244:247], a[16:19], v[144:147]
    ds_read_b64_tr_b16 a[240:241], v18 offset:36928
    ds_read_b64_tr_b16 a[242:243], v18 offset:37696
    v_mfma_f32_16x16x32_bf16 v[148:151], a[244:247], a[20:23], v[148:151]
    buffer_load_dwordx4 v28, s[4:7], s73 offen offset:1024 lds
    s_lshl_b32 s32, s32, 11
    v_mfma_f32_16x16x32_bf16 v[156:159], a[248:251], a[20:23], v[156:159]
    s_waitcnt lgkmcnt(8)
    ds_read_b64_tr_b16 a[244:245], v18 offset:43072
    ds_read_b64_tr_b16 a[246:247], v18 offset:43840
    v_mfma_f32_16x16x32_bf16 v[152:155], a[248:251], a[16:19], v[152:155]
    s_cmp_eq_u32 s3, 2
    s_cselect_b32 s29, -221184, s29
    s_bitcmp1_b32 s25, 1
    s_cselect_b32 s32, s32, 0x7ff00000
    v_mfma_f32_16x16x32_bf16 v[64:67], a[216:219], a[24:27], v[64:67]
    ds_read_b64_tr_b16 a[248:249], v17 offset:36992
    ds_read_b64_tr_b16 a[250:251], v17 offset:37760
    v_mfma_f32_16x16x32_bf16 v[68:71], a[216:219], a[28:31], v[68:71]
    v_add_u32 v40, s32, v35
    v_add_u32 v11, s29, v8
    v_mfma_f32_16x16x32_bf16 v[76:79], a[220:223], a[28:31], v[76:79]
    ds_read_b64_tr_b16 a[216:217], v17 offset:43136
    ds_read_b64_tr_b16 a[218:219], v17 offset:43904
    v_mfma_f32_16x16x32_bf16 v[72:75], a[220:223], a[24:27], v[72:75]
    buffer_load_dwordx4 v29, s[4:7], s73 offen offset:2048 lds
    v_mfma_f32_16x16x32_bf16 v[80:83], a[224:227], a[24:27], v[80:83]
    s_waitcnt lgkmcnt(8)
    ds_read_b64_tr_b16 a[220:221], v18 offset:36992
    ds_read_b64_tr_b16 a[222:223], v18 offset:37760
    v_mfma_f32_16x16x32_bf16 v[84:87], a[224:227], a[28:31], v[84:87]
    buffer_store_dwordx4 v[36:39], v40, s[16:19], 0 offen sc0 sc1
    v_mfma_f32_16x16x32_bf16 v[92:95], a[228:231], a[28:31], v[92:95]
    s_waitcnt vmcnt(14)
    ds_read_b64_tr_b16 a[224:225], v18 offset:43136
    ds_read_b64_tr_b16 a[226:227], v18 offset:43904
    v_mfma_f32_16x16x32_bf16 v[88:91], a[228:231], a[24:27], v[88:91]
    s_barrier
    v_mfma_f32_16x16x32_bf16 v[96:99], a[232:235], a[24:27], v[96:99]
    ds_read_b64_tr_b16 a[228:229], v17 offset:49152
    ds_read_b64_tr_b16 a[230:231], v17 offset:49920
    v_mfma_f32_16x16x32_bf16 v[100:103], a[232:235], a[28:31], v[100:103]
    buffer_load_dwordx4 v30, s[4:7], s73 offen offset:3072 lds
    s_mov_b32 s29, 110592
    v_mfma_f32_16x16x32_bf16 v[108:111], a[236:239], a[28:31], v[108:111]
    s_waitcnt lgkmcnt(8)
    ds_read_b64_tr_b16 a[232:233], v17 offset:55296
    ds_read_b64_tr_b16 a[234:235], v17 offset:56064
    v_mfma_f32_16x16x32_bf16 v[104:107], a[236:239], a[24:27], v[104:107]
    ds_read_b128 a[32:35], v31 offset:16384
    ds_read_b128 a[36:39], v31 offset:18432
    v_mfma_f32_16x16x32_bf16 v[112:115], a[240:243], a[24:27], v[112:115]
    ds_read_b64_tr_b16 a[236:237], v18 offset:49152
    ds_read_b64_tr_b16 a[238:239], v18 offset:49920
    v_mfma_f32_16x16x32_bf16 v[116:119], a[240:243], a[28:31], v[116:119]
    ds_read_b128 a[40:43], v32 offset:16384
    ds_read_b128 a[44:47], v32 offset:18432
    s_cmp_eq_u32 s3, 1
    s_cselect_b32 s29, -221184, s29
    v_mfma_f32_16x16x32_bf16 v[124:127], a[244:247], a[28:31], v[124:127]
    ds_read_b64_tr_b16 a[240:241], v18 offset:55296
    ds_read_b64_tr_b16 a[242:243], v18 offset:56064
    v_mfma_f32_16x16x32_bf16 v[120:123], a[244:247], a[24:27], v[120:123]
    s_add_u32 m0, s23, 0
    v_add_u32 v14, s29, v11
    v_mfma_f32_16x16x32_bf16 v[128:131], a[248:251], a[24:27], v[128:131]
    s_waitcnt lgkmcnt(12)
    ds_read_b64_tr_b16 a[244:245], v17 offset:49216
    ds_read_b64_tr_b16 a[246:247], v17 offset:49984
    v_mfma_f32_16x16x32_bf16 v[132:135], a[248:251], a[28:31], v[132:135]
    ds_read_b64_tr_b16 v[36:37], v33 offset:16384
    ds_read_b64_tr_b16 v[38:39], v34 offset:16384
    v_mfma_f32_16x16x32_bf16 v[140:143], a[216:219], a[28:31], v[140:143]
    ds_read_b64_tr_b16 a[248:249], v17 offset:55360
    ds_read_b64_tr_b16 a[250:251], v17 offset:56128
    v_mfma_f32_16x16x32_bf16 v[136:139], a[216:219], a[24:27], v[136:139]
    buffer_load_dwordx4 v2, s[8:11], s64 offen offset:0 lds
    v_mfma_f32_16x16x32_bf16 v[144:147], a[220:223], a[24:27], v[144:147]
    ds_read_b64_tr_b16 a[216:217], v18 offset:49216
    ds_read_b64_tr_b16 a[218:219], v18 offset:49984
    v_mfma_f32_16x16x32_bf16 v[148:151], a[220:223], a[28:31], v[148:151]
    buffer_load_dwordx4 v3, s[8:11], s64 offen offset:1024 lds
    v_mfma_f32_16x16x32_bf16 v[156:159], a[224:227], a[28:31], v[156:159]
    s_waitcnt lgkmcnt(12)
    ds_read_b64_tr_b16 a[220:221], v18 offset:55360
    ds_read_b64_tr_b16 a[222:223], v18 offset:56128
    v_mfma_f32_16x16x32_bf16 v[152:155], a[224:227], a[24:27], v[152:155]
    buffer_load_dwordx4 v4, s[8:11], s64 offen offset:2048 lds
    v_add_u32 v9, 8192, v8
    v_mfma_f32_16x16x32_bf16 v[64:67], a[228:231], a[32:35], v[64:67]
    ds_read_b64_tr_b16 a[224:225], v17 offset:49280
    ds_read_b64_tr_b16 a[226:227], v17 offset:50048
    v_mfma_f32_16x16x32_bf16 v[68:71], a[228:231], a[36:39], v[68:71]
    v_add_u32 v10, 16384, v8
    v_add_u32 v12, 8192, v11
    v_mfma_f32_16x16x32_bf16 v[76:79], a[232:235], a[36:39], v[76:79]
    ds_read_b64_tr_b16 a[228:229], v17 offset:55424
    ds_read_b64_tr_b16 a[230:231], v17 offset:56192
    v_mfma_f32_16x16x32_bf16 v[72:75], a[232:235], a[32:35], v[72:75]
    s_add_u32 m0, s23, 12288
    v_add_u32 v13, 16384, v11
    v_mfma_f32_16x16x32_bf16 v[80:83], a[236:239], a[32:35], v[80:83]
    s_waitcnt lgkmcnt(8)
    ds_read_b64_tr_b16 a[232:233], v18 offset:49280
    ds_read_b64_tr_b16 a[234:235], v18 offset:50048
    v_mfma_f32_16x16x32_bf16 v[84:87], a[236:239], a[36:39], v[84:87]
    buffer_load_dwordx4 v5, s[8:11], s64 offen offset:0 lds
    v_mfma_f32_16x16x32_bf16 v[92:95], a[240:243], a[36:39], v[92:95]
    ds_read_b64_tr_b16 a[236:237], v18 offset:55424
    ds_read_b64_tr_b16 a[238:239], v18 offset:56192
    v_mfma_f32_16x16x32_bf16 v[88:91], a[240:243], a[32:35], v[88:91]
    buffer_load_dwordx4 v6, s[8:11], s64 offen offset:1024 lds
    v_mfma_f32_16x16x32_bf16 v[96:99], a[244:247], a[32:35], v[96:99]
    ds_read_b64_tr_b16 a[240:241], v17 offset:61440
    ds_read_b64_tr_b16 a[242:243], v17 offset:62208
    v_mfma_f32_16x16x32_bf16 v[100:103], a[244:247], a[36:39], v[100:103]
    v_add_u32 v17, 61440, v17
    v_add_u32 v18, 61440, v18
    v_mfma_f32_16x16x32_bf16 v[108:111], a[248:251], a[36:39], v[108:111]
    s_waitcnt lgkmcnt(8)
    ds_read_b64_tr_b16 a[244:245], v17 offset:6144
    ds_read_b64_tr_b16 a[246:247], v17 offset:6912
    v_mfma_f32_16x16x32_bf16 v[104:107], a[248:251], a[32:35], v[104:107]
    buffer_load_dwordx4 v7, s[8:11], s64 offen offset:2048 lds
    v_mfma_f32_16x16x32_bf16 v[112:115], a[216:219], a[32:35], v[112:115]
    ds_read_b64_tr_b16 a[248:249], v18 offset:0
    ds_read_b64_tr_b16 a[250:251], v18 offset:768
    v_mfma_f32_16x16x32_bf16 v[116:119], a[216:219], a[36:39], v[116:119]
    v_add_u32 v15, 8192, v14
    v_add_u32 v16, 16384, v14
    v_mfma_f32_16x16x32_bf16 v[124:127], a[220:223], a[36:39], v[124:127]
    ds_read_b64_tr_b16 a[216:217], v18 offset:6144
    ds_read_b64_tr_b16 a[218:219], v18 offset:6912
    v_mfma_f32_16x16x32_bf16 v[120:123], a[220:223], a[32:35], v[120:123]
    v_lshrrev_b32 v56, 2, v1
    s_sub_u32 s32, s71, s28
    v_mfma_f32_16x16x32_bf16 v[128:131], a[224:227], a[32:35], v[128:131]
    s_waitcnt lgkmcnt(8)
    ds_read_b64_tr_b16 a[220:221], v17 offset:64
    ds_read_b64_tr_b16 a[222:223], v17 offset:832
    v_mfma_f32_16x16x32_bf16 v[132:135], a[224:227], a[36:39], v[132:135]
    s_add_u32 m0, s24, 98304
    v_bfe_u32 v57, v56, 1, 2
    v_mfma_f32_16x16x32_bf16 v[140:143], a[228:231], a[36:39], v[140:143]
    ds_read_b64_tr_b16 a[224:225], v17 offset:6208
    ds_read_b64_tr_b16 a[226:227], v17 offset:6976
    v_mfma_f32_16x16x32_bf16 v[136:139], a[228:231], a[32:35], v[136:139]
    buffer_load_dwordx4 v27, s[4:7], s74 offen offset:0 lds
    v_mfma_f32_16x16x32_bf16 v[144:147], a[232:235], a[32:35], v[144:147]
    ds_read_b64_tr_b16 a[228:229], v18 offset:64
    ds_read_b64_tr_b16 a[230:231], v18 offset:832
    v_mfma_f32_16x16x32_bf16 v[148:151], a[232:235], a[36:39], v[148:151]
    buffer_load_dwordx4 v28, s[4:7], s74 offen offset:1024 lds
    s_lshl_b32 s32, s32, 11
    v_mfma_f32_16x16x32_bf16 v[156:159], a[236:239], a[36:39], v[156:159]
    s_waitcnt lgkmcnt(8)
    ds_read_b64_tr_b16 a[232:233], v18 offset:6208
    ds_read_b64_tr_b16 a[234:235], v18 offset:6976
    v_mfma_f32_16x16x32_bf16 v[152:155], a[236:239], a[32:35], v[152:155]
    s_bitcmp1_b32 s25, 2
    s_cselect_b32 s32, s32, 0x7ff00000
    v_mfma_f32_16x16x32_bf16 v[64:67], a[240:243], a[40:43], v[64:67]
    ds_read_b64_tr_b16 a[236:237], v17 offset:128
    ds_read_b64_tr_b16 a[238:239], v17 offset:896
    v_mfma_f32_16x16x32_bf16 v[68:71], a[240:243], a[44:47], v[68:71]
    v_add_u32 v40, s32, v35
    v_lshlrev_b32 v56, 7, v56
    v_mfma_f32_16x16x32_bf16 v[76:79], a[244:247], a[44:47], v[76:79]
    ds_read_b64_tr_b16 a[240:241], v17 offset:6272
    ds_read_b64_tr_b16 a[242:243], v17 offset:7040
    v_mfma_f32_16x16x32_bf16 v[72:75], a[244:247], a[40:43], v[72:75]
    buffer_load_dwordx4 v29, s[4:7], s74 offen offset:2048 lds
    v_mfma_f32_16x16x32_bf16 v[80:83], a[248:251], a[40:43], v[80:83]
    s_waitcnt lgkmcnt(8)
    ds_read_b64_tr_b16 a[244:245], v18 offset:128
    ds_read_b64_tr_b16 a[246:247], v18 offset:896
    v_mfma_f32_16x16x32_bf16 v[84:87], a[248:251], a[44:47], v[84:87]
    buffer_store_dwordx4 v[36:39], v40, s[16:19], 0 offen sc0 sc1
    v_mfma_f32_16x16x32_bf16 v[92:95], a[216:219], a[44:47], v[92:95]
    s_waitcnt vmcnt(15)
    ds_read_b64_tr_b16 a[248:249], v18 offset:6272
    ds_read_b64_tr_b16 a[250:251], v18 offset:7040
    v_mfma_f32_16x16x32_bf16 v[88:91], a[216:219], a[40:43], v[88:91]
    s_barrier
    v_mfma_f32_16x16x32_bf16 v[96:99], a[220:223], a[40:43], v[96:99]
    ds_read_b64_tr_b16 a[216:217], v17 offset:12288
    ds_read_b64_tr_b16 a[218:219], v17 offset:13056
    v_mfma_f32_16x16x32_bf16 v[100:103], a[220:223], a[44:47], v[100:103]
    buffer_load_dwordx4 v30, s[4:7], s74 offen offset:3072 lds
    v_and_b32 v58, 3, v1
    v_mfma_f32_16x16x32_bf16 v[108:111], a[224:227], a[44:47], v[108:111]
    s_waitcnt lgkmcnt(8)
    ds_read_b64_tr_b16 a[220:221], v17 offset:18432
    ds_read_b64_tr_b16 a[222:223], v17 offset:19200
    v_mfma_f32_16x16x32_bf16 v[104:107], a[224:227], a[40:43], v[104:107]
    ds_read_b128 a[48:51], v31 offset:32768
    ds_read_b128 a[52:55], v31 offset:34816
    v_lshl_add_u32 v56, v58, 3, v56
    v_mfma_f32_16x16x32_bf16 v[112:115], a[228:231], a[40:43], v[112:115]
    ds_read_b64_tr_b16 a[224:225], v18 offset:12288
    ds_read_b64_tr_b16 a[226:227], v18 offset:13056
    v_mfma_f32_16x16x32_bf16 v[116:119], a[228:231], a[44:47], v[116:119]
    ds_read_b128 a[56:59], v32 offset:32768
    ds_read_b128 a[60:63], v32 offset:34816
    v_xor_b32 v59, 0, v57
    v_mfma_f32_16x16x32_bf16 v[124:127], a[232:235], a[44:47], v[124:127]
    ds_read_b64_tr_b16 a[228:229], v18 offset:18432
    ds_read_b64_tr_b16 a[230:231], v18 offset:19200
    v_mfma_f32_16x16x32_bf16 v[120:123], a[232:235], a[40:43], v[120:123]
    v_lshl_add_u32 v19, v59, 5, v56
    s_add_u32 m0, s23, 24576
    v_mfma_f32_16x16x32_bf16 v[128:131], a[236:239], a[40:43], v[128:131]
    s_waitcnt lgkmcnt(12)
    ds_read_b64_tr_b16 a[232:233], v17 offset:12352
    ds_read_b64_tr_b16 a[234:235], v17 offset:13120
    v_mfma_f32_16x16x32_bf16 v[132:135], a[236:239], a[44:47], v[132:135]
    ds_read_b64_tr_b16 v[36:37], v33 offset:32768
    ds_read_b64_tr_b16 v[38:39], v34 offset:32768
    v_mfma_f32_16x16x32_bf16 v[140:143], a[240:243], a[44:47], v[140:143]
    ds_read_b64_tr_b16 a[236:237], v17 offset:18496
    ds_read_b64_tr_b16 a[238:239], v17 offset:19264
    v_mfma_f32_16x16x32_bf16 v[136:139], a[240:243], a[40:43], v[136:139]
    buffer_load_dwordx4 v2, s[8:11], s65 offen offset:0 lds
    v_xor_b32 v59, 1, v57
    v_mfma_f32_16x16x32_bf16 v[144:147], a[244:247], a[40:43], v[144:147]
    ds_read_b64_tr_b16 a[240:241], v18 offset:12352
    ds_read_b64_tr_b16 a[242:243], v18 offset:13120
    v_mfma_f32_16x16x32_bf16 v[148:151], a[244:247], a[44:47], v[148:151]
    buffer_load_dwordx4 v3, s[8:11], s65 offen offset:1024 lds
    v_mfma_f32_16x16x32_bf16 v[156:159], a[248:251], a[44:47], v[156:159]
    s_waitcnt lgkmcnt(12)
    ds_read_b64_tr_b16 a[244:245], v18 offset:18496
    ds_read_b64_tr_b16 a[246:247], v18 offset:19264
    v_mfma_f32_16x16x32_bf16 v[152:155], a[248:251], a[40:43], v[152:155]
    buffer_load_dwordx4 v4, s[8:11], s65 offen offset:2048 lds
    v_lshl_add_u32 v20, v59, 5, v56
    v_mfma_f32_16x16x32_bf16 v[64:67], a[216:219], a[48:51], v[64:67]
    ds_read_b64_tr_b16 a[248:249], v17 offset:12416
    ds_read_b64_tr_b16 a[250:251], v17 offset:13184
    v_mfma_f32_16x16x32_bf16 v[68:71], a[216:219], a[52:55], v[68:71]
    v_xor_b32 v59, 2, v57
    v_lshl_add_u32 v21, v59, 5, v56
    v_mfma_f32_16x16x32_bf16 v[76:79], a[220:223], a[52:55], v[76:79]
    ds_read_b64_tr_b16 a[216:217], v17 offset:18560
    ds_read_b64_tr_b16 a[218:219], v17 offset:19328
    v_mfma_f32_16x16x32_bf16 v[72:75], a[220:223], a[48:51], v[72:75]
    s_add_u32 m0, s23, 36864
    v_xor_b32 v59, 3, v57
    v_mfma_f32_16x16x32_bf16 v[80:83], a[224:227], a[48:51], v[80:83]
    s_waitcnt lgkmcnt(8)
    ds_read_b64_tr_b16 a[220:221], v18 offset:12416
    ds_read_b64_tr_b16 a[222:223], v18 offset:13184
    v_mfma_f32_16x16x32_bf16 v[84:87], a[224:227], a[52:55], v[84:87]
    buffer_load_dwordx4 v5, s[8:11], s65 offen offset:0 lds
    v_mfma_f32_16x16x32_bf16 v[92:95], a[228:231], a[52:55], v[92:95]
    ds_read_b64_tr_b16 a[224:225], v18 offset:18560
    ds_read_b64_tr_b16 a[226:227], v18 offset:19328
    v_mfma_f32_16x16x32_bf16 v[88:91], a[228:231], a[48:51], v[88:91]
    buffer_load_dwordx4 v6, s[8:11], s65 offen offset:1024 lds
    v_mfma_f32_16x16x32_bf16 v[96:99], a[232:235], a[48:51], v[96:99]
    ds_read_b64_tr_b16 a[228:229], v17 offset:24576
    ds_read_b64_tr_b16 a[230:231], v17 offset:25344
    v_mfma_f32_16x16x32_bf16 v[100:103], a[232:235], a[52:55], v[100:103]
    v_lshl_add_u32 v22, v59, 5, v56
    v_lshlrev_b32 v23, 4, v1
    v_mfma_f32_16x16x32_bf16 v[108:111], a[236:239], a[52:55], v[108:111]
    s_waitcnt lgkmcnt(8)
    ds_read_b64_tr_b16 a[232:233], v17 offset:30720
    ds_read_b64_tr_b16 a[234:235], v17 offset:31488
    v_mfma_f32_16x16x32_bf16 v[104:107], a[236:239], a[48:51], v[104:107]
    buffer_load_dwordx4 v7, s[8:11], s65 offen offset:2048 lds
    v_mfma_f32_16x16x32_bf16 v[112:115], a[240:243], a[48:51], v[112:115]
    ds_read_b64_tr_b16 a[236:237], v18 offset:24576
    ds_read_b64_tr_b16 a[238:239], v18 offset:25344
    v_mfma_f32_16x16x32_bf16 v[116:119], a[240:243], a[52:55], v[116:119]
    v_add_u32 v24, 16384, v23
    s_sub_u32 s32, s72, s28
    v_mfma_f32_16x16x32_bf16 v[124:127], a[244:247], a[52:55], v[124:127]
    ds_read_b64_tr_b16 a[240:241], v18 offset:30720
    ds_read_b64_tr_b16 a[242:243], v18 offset:31488
    v_mfma_f32_16x16x32_bf16 v[120:123], a[244:247], a[48:51], v[120:123]
    v_add_u32 v25, 294912, v23
    s_add_u32 m0, s24, 114688
    v_mfma_f32_16x16x32_bf16 v[128:131], a[248:251], a[48:51], v[128:131]
    s_waitcnt lgkmcnt(8)
    ds_read_b64_tr_b16 a[244:245], v17 offset:24640
    ds_read_b64_tr_b16 a[246:247], v17 offset:25408
    v_mfma_f32_16x16x32_bf16 v[132:135], a[248:251], a[52:55], v[132:135]
    buffer_load_dwordx4 v27, s[4:7], s75 offen offset:0 lds
    v_mfma_f32_16x16x32_bf16 v[140:143], a[216:219], a[52:55], v[140:143]
    ds_read_b64_tr_b16 a[248:249], v17 offset:30784
    ds_read_b64_tr_b16 a[250:251], v17 offset:31552
    v_mfma_f32_16x16x32_bf16 v[136:139], a[216:219], a[48:51], v[136:139]
    s_lshl_b32 s32, s32, 11
    v_add_u32 v26, 311296, v23
    v_mfma_f32_16x16x32_bf16 v[144:147], a[220:223], a[48:51], v[144:147]
    ds_read_b64_tr_b16 a[216:217], v18 offset:24640
    ds_read_b64_tr_b16 a[218:219], v18 offset:25408
    v_mfma_f32_16x16x32_bf16 v[148:151], a[220:223], a[52:55], v[148:151]
    buffer_load_dwordx4 v28, s[4:7], s75 offen offset:1024 lds
    v_mfma_f32_16x16x32_bf16 v[156:159], a[224:227], a[52:55], v[156:159]
    s_waitcnt lgkmcnt(8)
    ds_read_b64_tr_b16 a[220:221], v18 offset:30784
    ds_read_b64_tr_b16 a[222:223], v18 offset:31552
    v_mfma_f32_16x16x32_bf16 v[152:155], a[224:227], a[48:51], v[152:155]
    s_bitcmp1_b32 s25, 3
    s_cselect_b32 s32, s32, 0x7ff00000
    v_mfma_f32_16x16x32_bf16 v[64:67], a[228:231], a[56:59], v[64:67]
    ds_read_b64_tr_b16 a[224:225], v17 offset:24704
    ds_read_b64_tr_b16 a[226:227], v17 offset:25472
    v_mfma_f32_16x16x32_bf16 v[68:71], a[228:231], a[60:63], v[68:71]
    v_add_u32 v40, s32, v35
    s_lshl_b32 s29, s21, 3
    v_mfma_f32_16x16x32_bf16 v[76:79], a[232:235], a[60:63], v[76:79]
    ds_read_b64_tr_b16 a[228:229], v17 offset:30848
    ds_read_b64_tr_b16 a[230:231], v17 offset:31616
    v_mfma_f32_16x16x32_bf16 v[72:75], a[232:235], a[56:59], v[72:75]
    buffer_load_dwordx4 v29, s[4:7], s75 offen offset:2048 lds
    v_mfma_f32_16x16x32_bf16 v[80:83], a[236:239], a[56:59], v[80:83]
    s_waitcnt lgkmcnt(8)
    ds_read_b64_tr_b16 a[232:233], v18 offset:24704
    ds_read_b64_tr_b16 a[234:235], v18 offset:25472
    v_mfma_f32_16x16x32_bf16 v[84:87], a[236:239], a[60:63], v[84:87]
    buffer_store_dwordx4 v[36:39], v40, s[16:19], 0 offen sc0 sc1
    v_mfma_f32_16x16x32_bf16 v[92:95], a[240:243], a[60:63], v[92:95]
    s_waitcnt vmcnt(15)
    ds_read_b64_tr_b16 a[236:237], v18 offset:30848
    ds_read_b64_tr_b16 a[238:239], v18 offset:31616
    v_mfma_f32_16x16x32_bf16 v[88:91], a[240:243], a[56:59], v[88:91]
    s_barrier
    v_subrev_u32 v17, 61440, v17
    v_subrev_u32 v18, 61440, v18
    v_mfma_f32_16x16x32_bf16 v[96:99], a[244:247], a[56:59], v[96:99]
    ds_read_b64_tr_b16 a[240:241], v17 offset:0
    ds_read_b64_tr_b16 a[242:243], v17 offset:768
    v_mfma_f32_16x16x32_bf16 v[100:103], a[244:247], a[60:63], v[100:103]
    buffer_load_dwordx4 v30, s[4:7], s75 offen offset:3072 lds
    s_lshl_b32 s30, s22, 1
    v_mfma_f32_16x16x32_bf16 v[108:111], a[248:251], a[60:63], v[108:111]
    s_waitcnt lgkmcnt(8)
    ds_read_b64_tr_b16 a[244:245], v17 offset:6144
    ds_read_b64_tr_b16 a[246:247], v17 offset:6912
    v_mfma_f32_16x16x32_bf16 v[104:107], a[248:251], a[56:59], v[104:107]
    ds_read_b128 a[64:67], v31 offset:49152
    ds_read_b128 a[68:71], v31 offset:51200
    s_add_u32 s29, s29, s30
    v_mfma_f32_16x16x32_bf16 v[112:115], a[216:219], a[56:59], v[112:115]
    ds_read_b64_tr_b16 a[248:249], v18 offset:0
    ds_read_b64_tr_b16 a[250:251], v18 offset:768
    v_mfma_f32_16x16x32_bf16 v[116:119], a[216:219], a[60:63], v[116:119]
    ds_read_b128 a[72:75], v32 offset:49152
    ds_read_b128 a[76:79], v32 offset:51200
    v_mfma_f32_16x16x32_bf16 v[124:127], a[220:223], a[60:63], v[124:127]
    ds_read_b64_tr_b16 a[216:217], v18 offset:6144
    ds_read_b64_tr_b16 a[218:219], v18 offset:6912
    v_mfma_f32_16x16x32_bf16 v[120:123], a[220:223], a[56:59], v[120:123]
    s_mul_i32 s29, s29, 294912
    s_add_u32 m0, s23, 49152
    v_mfma_f32_16x16x32_bf16 v[128:131], a[224:227], a[56:59], v[128:131]
    s_waitcnt lgkmcnt(12)
    ds_read_b64_tr_b16 a[220:221], v17 offset:64
    ds_read_b64_tr_b16 a[222:223], v17 offset:832
    v_mfma_f32_16x16x32_bf16 v[132:135], a[224:227], a[60:63], v[132:135]
    ds_read_b64_tr_b16 v[36:37], v33 offset:49152
    ds_read_b64_tr_b16 v[38:39], v34 offset:49152
    v_mfma_f32_16x16x32_bf16 v[140:143], a[228:231], a[60:63], v[140:143]
    ds_read_b64_tr_b16 a[224:225], v17 offset:6208
    ds_read_b64_tr_b16 a[226:227], v17 offset:6976
    v_mfma_f32_16x16x32_bf16 v[136:139], a[228:231], a[56:59], v[136:139]
    buffer_load_dwordx4 v2, s[8:11], s66 offen offset:0 lds
    s_lshl_b32 s30, s20, 10
    v_mfma_f32_16x16x32_bf16 v[144:147], a[232:235], a[56:59], v[144:147]
    ds_read_b64_tr_b16 a[228:229], v18 offset:64
    ds_read_b64_tr_b16 a[230:231], v18 offset:832
    v_mfma_f32_16x16x32_bf16 v[148:151], a[232:235], a[60:63], v[148:151]
    buffer_load_dwordx4 v3, s[8:11], s66 offen offset:1024 lds
    s_add_u32 s29, s29, s30
    v_mfma_f32_16x16x32_bf16 v[156:159], a[236:239], a[60:63], v[156:159]
    s_waitcnt lgkmcnt(12)
    ds_read_b64_tr_b16 a[232:233], v18 offset:6208
    ds_read_b64_tr_b16 a[234:235], v18 offset:6976
    v_mfma_f32_16x16x32_bf16 v[152:155], a[236:239], a[56:59], v[152:155]
    buffer_load_dwordx4 v4, s[8:11], s66 offen offset:2048 lds
    v_mfma_f32_16x16x32_bf16 v[64:67], a[240:243], a[64:67], v[64:67]
    ds_read_b64_tr_b16 a[236:237], v17 offset:128
    ds_read_b64_tr_b16 a[238:239], v17 offset:896
    v_mfma_f32_16x16x32_bf16 v[68:71], a[240:243], a[68:71], v[68:71]
    s_add_u32 s26, s29, 8388608
    s_mul_i32 s30, s20, 331776
    v_mfma_f32_16x16x32_bf16 v[76:79], a[244:247], a[68:71], v[76:79]
    ds_read_b64_tr_b16 a[240:241], v17 offset:6272
    ds_read_b64_tr_b16 a[242:243], v17 offset:7040
    v_mfma_f32_16x16x32_bf16 v[72:75], a[244:247], a[64:67], v[72:75]
    s_add_u32 m0, s23, 61440
    s_lshl_b32 s29, s30, 8
    v_mfma_f32_16x16x32_bf16 v[80:83], a[248:251], a[64:67], v[80:83]
    s_waitcnt lgkmcnt(8)
    ds_read_b64_tr_b16 a[244:245], v18 offset:128
    ds_read_b64_tr_b16 a[246:247], v18 offset:896
    v_mfma_f32_16x16x32_bf16 v[84:87], a[248:251], a[68:71], v[84:87]
    s_sub_u32 s26, s26, s29
    s_mov_b32 s34, 0xbfb8aa3b
    v_mfma_f32_16x16x32_bf16 v[92:95], a[216:219], a[68:71], v[92:95]
    ds_read_b64_tr_b16 a[248:249], v18 offset:6272
    ds_read_b64_tr_b16 a[250:251], v18 offset:7040
    v_mfma_f32_16x16x32_bf16 v[88:91], a[216:219], a[64:67], v[88:91]
    buffer_load_dwordx4 v5, s[8:11], s66 offen offset:0 lds
    v_mfma_f32_16x16x32_bf16 v[96:99], a[220:223], a[64:67], v[96:99]
    ds_read_b64_tr_b16 a[216:217], v17 offset:12288
    ds_read_b64_tr_b16 a[218:219], v17 offset:13056
    v_mfma_f32_16x16x32_bf16 v[100:103], a[220:223], a[68:71], v[100:103]
    buffer_load_dwordx4 v6, s[8:11], s66 offen offset:1024 lds
    v_mfma_f32_16x16x32_bf16 v[108:111], a[224:227], a[68:71], v[108:111]
    s_waitcnt lgkmcnt(8)
    ds_read_b64_tr_b16 a[220:221], v17 offset:18432
    ds_read_b64_tr_b16 a[222:223], v17 offset:19200
    v_mfma_f32_16x16x32_bf16 v[104:107], a[224:227], a[64:67], v[104:107]
    buffer_load_dwordx4 v7, s[8:11], s66 offen offset:2048 lds
    v_mfma_f32_16x16x32_bf16 v[112:115], a[228:231], a[64:67], v[112:115]
    ds_read_b64_tr_b16 a[224:225], v18 offset:12288
    ds_read_b64_tr_b16 a[226:227], v18 offset:13056
    v_mfma_f32_16x16x32_bf16 v[116:119], a[228:231], a[68:71], v[116:119]
    s_sub_u32 s32, s73, s28
    s_lshl_b32 s32, s32, 11
    v_mfma_f32_16x16x32_bf16 v[124:127], a[232:235], a[68:71], v[124:127]
    ds_read_b64_tr_b16 a[228:229], v18 offset:18432
    ds_read_b64_tr_b16 a[230:231], v18 offset:19200
    v_mfma_f32_16x16x32_bf16 v[120:123], a[232:235], a[64:67], v[120:123]
    s_add_u32 m0, s24, 131072
    v_mfma_f32_16x16x32_bf16 v[128:131], a[236:239], a[64:67], v[128:131]
    s_waitcnt lgkmcnt(8)
    ds_read_b64_tr_b16 a[232:233], v17 offset:12352
    ds_read_b64_tr_b16 a[234:235], v17 offset:13120
    v_mfma_f32_16x16x32_bf16 v[132:135], a[236:239], a[68:71], v[132:135]
    buffer_load_dwordx4 v27, s[4:7], s76 offen offset:0 lds
    v_mfma_f32_16x16x32_bf16 v[140:143], a[240:243], a[68:71], v[140:143]
    ds_read_b64_tr_b16 a[236:237], v17 offset:18496
    ds_read_b64_tr_b16 a[238:239], v17 offset:19264
    v_mfma_f32_16x16x32_bf16 v[136:139], a[240:243], a[64:67], v[136:139]
    buffer_load_dwordx4 v28, s[4:7], s76 offen offset:1024 lds
    v_mfma_f32_16x16x32_bf16 v[144:147], a[244:247], a[64:67], v[144:147]
    ds_read_b64_tr_b16 a[240:241], v18 offset:12352
    ds_read_b64_tr_b16 a[242:243], v18 offset:13120
    v_mfma_f32_16x16x32_bf16 v[148:151], a[244:247], a[68:71], v[148:151]
    s_bitcmp1_b32 s25, 4
    s_cselect_b32 s32, s32, 0x7ff00000
    v_mfma_f32_16x16x32_bf16 v[156:159], a[248:251], a[68:71], v[156:159]
    s_waitcnt lgkmcnt(8)
    ds_read_b64_tr_b16 a[244:245], v18 offset:18496
    ds_read_b64_tr_b16 a[246:247], v18 offset:19264
    v_mfma_f32_16x16x32_bf16 v[152:155], a[248:251], a[64:67], v[152:155]
    buffer_load_dwordx4 v29, s[4:7], s76 offen offset:2048 lds
    v_mfma_f32_16x16x32_bf16 v[64:67], a[216:219], a[72:75], v[64:67]
    ds_read_b64_tr_b16 a[248:249], v17 offset:12416
    ds_read_b64_tr_b16 a[250:251], v17 offset:13184
    v_mfma_f32_16x16x32_bf16 v[68:71], a[216:219], a[76:79], v[68:71]
    v_add_u32 v40, s32, v35
    s_lshl_b32 s31, s21, 7
    v_mfma_f32_16x16x32_bf16 v[76:79], a[220:223], a[76:79], v[76:79]
    ds_read_b64_tr_b16 a[216:217], v17 offset:18560
    ds_read_b64_tr_b16 a[218:219], v17 offset:19328
    v_mfma_f32_16x16x32_bf16 v[72:75], a[220:223], a[72:75], v[72:75]
    buffer_store_dwordx4 v[36:39], v40, s[16:19], 0 offen sc0 sc1
    v_mfma_f32_16x16x32_bf16 v[80:83], a[224:227], a[72:75], v[80:83]
    s_waitcnt lgkmcnt(8)
    ds_read_b64_tr_b16 a[220:221], v18 offset:12416
    ds_read_b64_tr_b16 a[222:223], v18 offset:13184
    v_mfma_f32_16x16x32_bf16 v[84:87], a[224:227], a[76:79], v[84:87]
    buffer_load_dwordx4 v30, s[4:7], s76 offen offset:3072 lds
    s_lshl_b32 s33, s20, 2
    v_mfma_f32_16x16x32_bf16 v[92:95], a[228:231], a[76:79], v[92:95]
    s_waitcnt vmcnt(16)
    ds_read_b64_tr_b16 a[224:225], v18 offset:18560
    ds_read_b64_tr_b16 a[226:227], v18 offset:19328
    v_mfma_f32_16x16x32_bf16 v[88:91], a[228:231], a[72:75], v[88:91]
    s_barrier
    v_mfma_f32_16x16x32_bf16 v[96:99], a[232:235], a[72:75], v[96:99]
    ds_read_b64_tr_b16 a[228:229], v17 offset:24576
    ds_read_b64_tr_b16 a[230:231], v17 offset:25344
    v_mfma_f32_16x16x32_bf16 v[100:103], a[232:235], a[76:79], v[100:103]
    ds_read_b128 a[80:83], v31 offset:0
    ds_read_b128 a[84:87], v31 offset:2048
    s_add_u32 s31, s31, s33
    v_mfma_f32_16x16x32_bf16 v[108:111], a[236:239], a[76:79], v[108:111]
    s_waitcnt lgkmcnt(10)
    ds_read_b64_tr_b16 a[232:233], v17 offset:30720
    ds_read_b64_tr_b16 a[234:235], v17 offset:31488
    v_mfma_f32_16x16x32_bf16 v[104:107], a[236:239], a[72:75], v[104:107]
    s_add_u32 s31, s31, 4096
    v_mov_b32 v41, s31
    v_mfma_f32_16x16x32_bf16 v[112:115], a[240:243], a[72:75], v[112:115]
    ds_read_b64_tr_b16 a[236:237], v18 offset:24576
    ds_read_b64_tr_b16 a[238:239], v18 offset:25344
    v_mfma_f32_16x16x32_bf16 v[116:119], a[240:243], a[76:79], v[116:119]
    ds_read_b128 a[88:91], v32 offset:0
    ds_read_b128 a[92:95], v32 offset:2048
    v_mfma_f32_16x16x32_bf16 v[124:127], a[244:247], a[76:79], v[124:127]
    ds_read_b64_tr_b16 a[240:241], v18 offset:30720
    ds_read_b64_tr_b16 a[242:243], v18 offset:31488
    v_mfma_f32_16x16x32_bf16 v[120:123], a[244:247], a[72:75], v[120:123]
    s_add_u32 m0, s23, 73728
    s_lshl_b32 s31, s48, 14
    v_mfma_f32_16x16x32_bf16 v[128:131], a[248:251], a[72:75], v[128:131]
    s_waitcnt lgkmcnt(12)
    ds_read_b64_tr_b16 a[244:245], v17 offset:24640
    ds_read_b64_tr_b16 a[246:247], v17 offset:25408
    v_mfma_f32_16x16x32_bf16 v[132:135], a[248:251], a[76:79], v[132:135]
    ds_read_b64_tr_b16 v[36:37], v33 offset:0
    ds_read_b64_tr_b16 v[38:39], v34 offset:0
    v_mfma_f32_16x16x32_bf16 v[140:143], a[216:219], a[76:79], v[140:143]
    ds_read_b64_tr_b16 a[248:249], v17 offset:30784
    ds_read_b64_tr_b16 a[250:251], v17 offset:31552
    v_mfma_f32_16x16x32_bf16 v[136:139], a[216:219], a[72:75], v[136:139]
    buffer_load_dwordx4 v2, s[8:11], s67 offen offset:0 lds
    v_mfma_f32_16x16x32_bf16 v[144:147], a[220:223], a[72:75], v[144:147]
    ds_read_b64_tr_b16 a[216:217], v18 offset:24640
    ds_read_b64_tr_b16 a[218:219], v18 offset:25408
    v_mfma_f32_16x16x32_bf16 v[148:151], a[220:223], a[76:79], v[148:151]
    buffer_load_dwordx4 v3, s[8:11], s67 offen offset:1024 lds
    v_mfma_f32_16x16x32_bf16 v[156:159], a[224:227], a[76:79], v[156:159]
    s_waitcnt lgkmcnt(12)
    ds_read_b64_tr_b16 a[220:221], v18 offset:30784
    ds_read_b64_tr_b16 a[222:223], v18 offset:31552
    v_mfma_f32_16x16x32_bf16 v[152:155], a[224:227], a[72:75], v[152:155]
    buffer_load_dwordx4 v4, s[8:11], s67 offen offset:2048 lds
    s_lshl_b32 s33, s22, 12
    v_mfma_f32_16x16x32_bf16 v[64:67], a[228:231], a[80:83], v[64:67]
    ds_read_b64_tr_b16 a[224:225], v17 offset:24704
    ds_read_b64_tr_b16 a[226:227], v17 offset:25472
    v_mfma_f32_16x16x32_bf16 v[68:71], a[228:231], a[84:87], v[68:71]
    s_add_u32 s31, s31, s33
    s_add_u32 s31, s31, 1048576
    v_mfma_f32_16x16x32_bf16 v[76:79], a[232:235], a[84:87], v[76:79]
    ds_read_b64_tr_b16 a[228:229], v17 offset:30848
    ds_read_b64_tr_b16 a[230:231], v17 offset:31616
    v_mfma_f32_16x16x32_bf16 v[72:75], a[232:235], a[80:83], v[72:75]
    s_add_u32 m0, s23, 86016
    v_mfma_f32_16x16x32_bf16 v[80:83], a[236:239], a[80:83], v[80:83]
    s_waitcnt lgkmcnt(8)
    ds_read_b64_tr_b16 a[232:233], v18 offset:24704
    ds_read_b64_tr_b16 a[234:235], v18 offset:25472
    v_mfma_f32_16x16x32_bf16 v[84:87], a[236:239], a[84:87], v[84:87]
    buffer_load_dwordx4 v5, s[8:11], s67 offen offset:0 lds
    v_mfma_f32_16x16x32_bf16 v[92:95], a[240:243], a[84:87], v[92:95]
    ds_read_b64_tr_b16 a[236:237], v18 offset:30848
    ds_read_b64_tr_b16 a[238:239], v18 offset:31616
    v_mfma_f32_16x16x32_bf16 v[88:91], a[240:243], a[80:83], v[88:91]
    buffer_load_dwordx4 v6, s[8:11], s67 offen offset:1024 lds
    v_mfma_f32_16x16x32_bf16 v[96:99], a[244:247], a[80:83], v[96:99]
    ds_read_b64_tr_b16 a[240:241], v17 offset:36864
    ds_read_b64_tr_b16 a[242:243], v17 offset:37632
    v_mfma_f32_16x16x32_bf16 v[100:103], a[244:247], a[84:87], v[100:103]
    s_cmp_eq_u32 s48, -1
    s_cselect_b32 s31, 0x7ff00000, s31
    v_mfma_f32_16x16x32_bf16 v[108:111], a[248:251], a[84:87], v[108:111]
    s_waitcnt lgkmcnt(8)
    ds_read_b64_tr_b16 a[244:245], v17 offset:43008
    ds_read_b64_tr_b16 a[246:247], v17 offset:43776
    v_mfma_f32_16x16x32_bf16 v[104:107], a[248:251], a[80:83], v[104:107]
    buffer_load_dwordx4 v7, s[8:11], s67 offen offset:2048 lds
    v_mfma_f32_16x16x32_bf16 v[112:115], a[216:219], a[80:83], v[112:115]
    ds_read_b64_tr_b16 a[248:249], v18 offset:36864
    ds_read_b64_tr_b16 a[250:251], v18 offset:37632
    v_mfma_f32_16x16x32_bf16 v[116:119], a[216:219], a[84:87], v[116:119]
    v_lshl_add_u32 v42, v1, 4, s31
    v_mov_b32 v43, 0
    v_mfma_f32_16x16x32_bf16 v[124:127], a[220:223], a[84:87], v[124:127]
    ds_read_b64_tr_b16 a[216:217], v18 offset:43008
    ds_read_b64_tr_b16 a[218:219], v18 offset:43776
    v_mfma_f32_16x16x32_bf16 v[120:123], a[220:223], a[80:83], v[120:123]
    s_sub_u32 s32, s74, s28
    s_add_u32 m0, s24, 147456
    v_mfma_f32_16x16x32_bf16 v[128:131], a[224:227], a[80:83], v[128:131]
    s_waitcnt lgkmcnt(8)
    ds_read_b64_tr_b16 a[220:221], v17 offset:36928
    ds_read_b64_tr_b16 a[222:223], v17 offset:37696
    v_mfma_f32_16x16x32_bf16 v[132:135], a[224:227], a[84:87], v[132:135]
    buffer_load_dwordx4 v27, s[4:7], s77 offen offset:0 lds
    v_mfma_f32_16x16x32_bf16 v[140:143], a[228:231], a[84:87], v[140:143]
    ds_read_b64_tr_b16 a[224:225], v17 offset:43072
    ds_read_b64_tr_b16 a[226:227], v17 offset:43840
    v_mfma_f32_16x16x32_bf16 v[136:139], a[228:231], a[80:83], v[136:139]
    s_lshl_b32 s32, s32, 11
    v_mov_b32 v44, 0x7fffff00
    v_mfma_f32_16x16x32_bf16 v[144:147], a[232:235], a[80:83], v[144:147]
    ds_read_b64_tr_b16 a[228:229], v18 offset:36928
    ds_read_b64_tr_b16 a[230:231], v18 offset:37696
    v_mfma_f32_16x16x32_bf16 v[148:151], a[232:235], a[84:87], v[148:151]
    buffer_load_dwordx4 v28, s[4:7], s77 offen offset:1024 lds
    v_mfma_f32_16x16x32_bf16 v[156:159], a[236:239], a[84:87], v[156:159]
    s_waitcnt lgkmcnt(8)
    ds_read_b64_tr_b16 a[232:233], v18 offset:43072
    ds_read_b64_tr_b16 a[234:235], v18 offset:43840
    v_mfma_f32_16x16x32_bf16 v[152:155], a[236:239], a[80:83], v[152:155]
    s_bitcmp1_b32 s25, 5
    s_cselect_b32 s32, s32, 0x7ff00000
    v_mfma_f32_16x16x32_bf16 v[64:67], a[240:243], a[88:91], v[64:67]
    ds_read_b64_tr_b16 a[236:237], v17 offset:36992
    ds_read_b64_tr_b16 a[238:239], v17 offset:37760
    v_mfma_f32_16x16x32_bf16 v[68:71], a[240:243], a[92:95], v[68:71]
    v_add_u32 v40, s32, v35
    v_mfma_f32_16x16x32_bf16 v[76:79], a[244:247], a[92:95], v[76:79]
    ds_read_b64_tr_b16 a[240:241], v17 offset:43136
    ds_read_b64_tr_b16 a[242:243], v17 offset:43904
    v_mfma_f32_16x16x32_bf16 v[72:75], a[244:247], a[88:91], v[72:75]
    buffer_load_dwordx4 v29, s[4:7], s77 offen offset:2048 lds
    v_cmp_eq_u32 vcc, 0, v0
    v_mov_b32 v45, 1
    v_mov_b32 v60, -1
    v_cndmask_b32 v41, v44, v41, vcc
    v_cndmask_b32 v43, v44, v43, vcc
    v_mfma_f32_16x16x32_bf16 v[80:83], a[248:251], a[88:91], v[80:83]
    s_waitcnt lgkmcnt(8)
    ds_read_b64_tr_b16 a[244:245], v18 offset:36992
    ds_read_b64_tr_b16 a[246:247], v18 offset:37760
    v_mfma_f32_16x16x32_bf16 v[84:87], a[248:251], a[92:95], v[84:87]
    buffer_store_dwordx4 v[36:39], v40, s[16:19], 0 offen sc0 sc1
    v_mfma_f32_16x16x32_bf16 v[92:95], a[216:219], a[92:95], v[92:95]
    s_waitcnt vmcnt(15)
    ds_read_b64_tr_b16 a[248:249], v18 offset:43136
    ds_read_b64_tr_b16 a[250:251], v18 offset:43904
    v_mfma_f32_16x16x32_bf16 v[88:91], a[216:219], a[88:91], v[88:91]
    s_barrier
    v_mfma_f32_16x16x32_bf16 v[96:99], a[220:223], a[88:91], v[96:99]
    ds_read_b64_tr_b16 a[216:217], v17 offset:49152
    ds_read_b64_tr_b16 a[218:219], v17 offset:49920
    v_mfma_f32_16x16x32_bf16 v[100:103], a[220:223], a[92:95], v[100:103]
    buffer_load_dwordx4 v30, s[4:7], s77 offen offset:3072 lds
    v_mfma_f32_16x16x32_bf16 v[108:111], a[224:227], a[92:95], v[108:111]
    s_waitcnt lgkmcnt(8)
    ds_read_b64_tr_b16 a[220:221], v17 offset:55296
    ds_read_b64_tr_b16 a[222:223], v17 offset:56064
    v_mfma_f32_16x16x32_bf16 v[104:107], a[224:227], a[88:91], v[104:107]
    ds_read_b128 a[96:99], v31 offset:16384
    ds_read_b128 a[100:103], v31 offset:18432
    v_mfma_f32_16x16x32_bf16 v[112:115], a[228:231], a[88:91], v[112:115]
    ds_read_b64_tr_b16 a[224:225], v18 offset:49152
    ds_read_b64_tr_b16 a[226:227], v18 offset:49920
    v_mfma_f32_16x16x32_bf16 v[116:119], a[228:231], a[92:95], v[116:119]
    ds_read_b128 a[104:107], v32 offset:16384
    ds_read_b128 a[108:111], v32 offset:18432
    v_mfma_f32_16x16x32_bf16 v[124:127], a[232:235], a[92:95], v[124:127]
    ds_read_b64_tr_b16 a[228:229], v18 offset:55296
    ds_read_b64_tr_b16 a[230:231], v18 offset:56064
    v_mfma_f32_16x16x32_bf16 v[120:123], a[232:235], a[88:91], v[120:123]
    s_add_u32 m0, s23, 0
    v_mov_b32 v44, 0
    v_mfma_f32_16x16x32_bf16 v[128:131], a[236:239], a[88:91], v[128:131]
    s_waitcnt lgkmcnt(12)
    ds_read_b64_tr_b16 a[232:233], v17 offset:49216
    ds_read_b64_tr_b16 a[234:235], v17 offset:49984
    v_mfma_f32_16x16x32_bf16 v[132:135], a[236:239], a[92:95], v[132:135]
    ds_read_b64_tr_b16 v[36:37], v33 offset:16384
    ds_read_b64_tr_b16 v[38:39], v34 offset:16384
    v_mfma_f32_16x16x32_bf16 v[140:143], a[240:243], a[92:95], v[140:143]
    ds_read_b64_tr_b16 a[236:237], v17 offset:55360
    ds_read_b64_tr_b16 a[238:239], v17 offset:56128
    v_mfma_f32_16x16x32_bf16 v[136:139], a[240:243], a[88:91], v[136:139]
    buffer_load_dwordx4 v2, s[8:11], s68 offen offset:0 lds
    v_mfma_f32_16x16x32_bf16 v[144:147], a[244:247], a[88:91], v[144:147]
    ds_read_b64_tr_b16 a[240:241], v18 offset:49216
    ds_read_b64_tr_b16 a[242:243], v18 offset:49984
    v_mfma_f32_16x16x32_bf16 v[148:151], a[244:247], a[92:95], v[148:151]
    buffer_load_dwordx4 v3, s[8:11], s68 offen offset:1024 lds
    v_mfma_f32_16x16x32_bf16 v[156:159], a[248:251], a[92:95], v[156:159]
    s_waitcnt lgkmcnt(12)
    ds_read_b64_tr_b16 a[244:245], v18 offset:55360
    ds_read_b64_tr_b16 a[246:247], v18 offset:56128
    v_mfma_f32_16x16x32_bf16 v[152:155], a[248:251], a[88:91], v[152:155]
    v_mov_b32 v61, -1
    v_mov_b32 v62, -1
    v_mfma_f32_16x16x32_bf16 v[64:67], a[216:219], a[96:99], v[64:67]
    ds_read_b64_tr_b16 a[248:249], v17 offset:49280
    ds_read_b64_tr_b16 a[250:251], v17 offset:50048
    v_mfma_f32_16x16x32_bf16 v[68:71], a[216:219], a[100:103], v[68:71]
    buffer_load_dwordx4 v4, s[8:11], s68 offen offset:2048 lds
    v_mfma_f32_16x16x32_bf16 v[76:79], a[220:223], a[100:103], v[76:79]
    ds_read_b64_tr_b16 a[216:217], v17 offset:55424
    ds_read_b64_tr_b16 a[218:219], v17 offset:56192
    v_mfma_f32_16x16x32_bf16 v[72:75], a[220:223], a[96:99], v[72:75]
    v_mov_b32 v63, -1
    v_mfma_f32_16x16x32_bf16 v[80:83], a[224:227], a[96:99], v[80:83]
    s_waitcnt lgkmcnt(8)
    ds_read_b64_tr_b16 a[220:221], v18 offset:49280
    ds_read_b64_tr_b16 a[222:223], v18 offset:50048
    v_mfma_f32_16x16x32_bf16 v[84:87], a[224:227], a[100:103], v[84:87]
    buffer_store_dword v44, v41, s[16:19], 0 offen sc0 sc1
    v_mfma_f32_16x16x32_bf16 v[92:95], a[228:231], a[100:103], v[92:95]
    ds_read_b64_tr_b16 a[224:225], v18 offset:55424
    ds_read_b64_tr_b16 a[226:227], v18 offset:56192
    v_mfma_f32_16x16x32_bf16 v[88:91], a[228:231], a[96:99], v[88:91]
    buffer_store_dwordx4 v[60:63], v42, s[16:19], 0 offen offset:0 sc0 sc1
    v_mfma_f32_16x16x32_bf16 v[96:99], a[232:235], a[96:99], v[96:99]
    ds_read_b64_tr_b16 a[228:229], v17 offset:61440
    ds_read_b64_tr_b16 a[230:231], v17 offset:62208
    v_mfma_f32_16x16x32_bf16 v[100:103], a[232:235], a[100:103], v[100:103]
    v_add_u32 v17, 61440, v17
    v_add_u32 v18, 61440, v18
    v_mfma_f32_16x16x32_bf16 v[108:111], a[236:239], a[100:103], v[108:111]
    s_waitcnt lgkmcnt(8)
    ds_read_b64_tr_b16 a[232:233], v17 offset:6144
    ds_read_b64_tr_b16 a[234:235], v17 offset:6912
    v_mfma_f32_16x16x32_bf16 v[104:107], a[236:239], a[96:99], v[104:107]
    buffer_store_dwordx4 v[60:63], v42, s[16:19], 0 offen offset:1024 sc0 sc1
    v_mfma_f32_16x16x32_bf16 v[112:115], a[240:243], a[96:99], v[112:115]
    ds_read_b64_tr_b16 a[236:237], v18 offset:0
    ds_read_b64_tr_b16 a[238:239], v18 offset:768
    v_mfma_f32_16x16x32_bf16 v[116:119], a[240:243], a[100:103], v[116:119]
    s_add_u32 m0, s23, 12288
    s_sub_u32 s32, s75, s28
    v_mfma_f32_16x16x32_bf16 v[124:127], a[244:247], a[100:103], v[124:127]
    ds_read_b64_tr_b16 a[240:241], v18 offset:6144
    ds_read_b64_tr_b16 a[242:243], v18 offset:6912
    v_mfma_f32_16x16x32_bf16 v[120:123], a[244:247], a[96:99], v[120:123]
    buffer_load_dwordx4 v5, s[8:11], s68 offen offset:0 lds
    v_mfma_f32_16x16x32_bf16 v[128:131], a[248:251], a[96:99], v[128:131]
    s_waitcnt lgkmcnt(8)
    ds_read_b64_tr_b16 a[244:245], v17 offset:64
    ds_read_b64_tr_b16 a[246:247], v17 offset:832
    v_mfma_f32_16x16x32_bf16 v[132:135], a[248:251], a[100:103], v[132:135]
    buffer_load_dwordx4 v6, s[8:11], s68 offen offset:1024 lds
    v_mfma_f32_16x16x32_bf16 v[140:143], a[216:219], a[100:103], v[140:143]
    ds_read_b64_tr_b16 a[248:249], v17 offset:6208
    ds_read_b64_tr_b16 a[250:251], v17 offset:6976
    v_mfma_f32_16x16x32_bf16 v[136:139], a[216:219], a[96:99], v[136:139]
    s_lshl_b32 s32, s32, 11
    v_mfma_f32_16x16x32_bf16 v[144:147], a[220:223], a[96:99], v[144:147]
    ds_read_b64_tr_b16 a[216:217], v18 offset:64
    ds_read_b64_tr_b16 a[218:219], v18 offset:832
    v_mfma_f32_16x16x32_bf16 v[148:151], a[220:223], a[100:103], v[148:151]
    s_bitcmp1_b32 s25, 6
    s_cselect_b32 s32, s32, 0x7ff00000
    v_mfma_f32_16x16x32_bf16 v[156:159], a[224:227], a[100:103], v[156:159]
    s_waitcnt lgkmcnt(8)
    ds_read_b64_tr_b16 a[220:221], v18 offset:6208
    ds_read_b64_tr_b16 a[222:223], v18 offset:6976
    v_mfma_f32_16x16x32_bf16 v[152:155], a[224:227], a[96:99], v[152:155]
    buffer_store_dwordx4 v[60:63], v42, s[16:19], 0 offen offset:2048 sc0 sc1
    v_mfma_f32_16x16x32_bf16 v[64:67], a[228:231], a[104:107], v[64:67]
    ds_read_b64_tr_b16 a[224:225], v17 offset:128
    ds_read_b64_tr_b16 a[226:227], v17 offset:896
    v_mfma_f32_16x16x32_bf16 v[68:71], a[228:231], a[108:111], v[68:71]
    v_add_u32 v40, s32, v35
    v_mfma_f32_16x16x32_bf16 v[76:79], a[232:235], a[108:111], v[76:79]
    ds_read_b64_tr_b16 a[228:229], v17 offset:6272
    ds_read_b64_tr_b16 a[230:231], v17 offset:7040
    v_mfma_f32_16x16x32_bf16 v[72:75], a[232:235], a[104:107], v[72:75]
    buffer_store_dwordx4 v[36:39], v40, s[16:19], 0 offen sc0 sc1
    v_mfma_f32_16x16x32_bf16 v[80:83], a[236:239], a[104:107], v[80:83]
    s_waitcnt lgkmcnt(8)
    ds_read_b64_tr_b16 a[232:233], v18 offset:128
    ds_read_b64_tr_b16 a[234:235], v18 offset:896
    v_mfma_f32_16x16x32_bf16 v[84:87], a[236:239], a[108:111], v[84:87]
    buffer_load_dwordx4 v7, s[8:11], s68 offen offset:2048 lds
    v_mfma_f32_16x16x32_bf16 v[92:95], a[240:243], a[108:111], v[92:95]
    s_waitcnt vmcnt(16)
    ds_read_b64_tr_b16 a[236:237], v18 offset:6272
    ds_read_b64_tr_b16 a[238:239], v18 offset:7040
    v_mfma_f32_16x16x32_bf16 v[88:91], a[240:243], a[104:107], v[88:91]
    s_barrier
    v_mfma_f32_16x16x32_bf16 v[96:99], a[244:247], a[104:107], v[96:99]
    ds_read_b64_tr_b16 a[240:241], v17 offset:12288
    ds_read_b64_tr_b16 a[242:243], v17 offset:13056
    v_mfma_f32_16x16x32_bf16 v[100:103], a[244:247], a[108:111], v[100:103]
    ds_read_b128 a[112:115], v31 offset:32768
    ds_read_b128 a[116:119], v31 offset:34816
    v_mfma_f32_16x16x32_bf16 v[108:111], a[248:251], a[108:111], v[108:111]
    s_waitcnt lgkmcnt(10)
    ds_read_b64_tr_b16 a[244:245], v17 offset:18432
    ds_read_b64_tr_b16 a[246:247], v17 offset:19200
    v_mfma_f32_16x16x32_bf16 v[104:107], a[248:251], a[104:107], v[104:107]
    buffer_store_dwordx4 v[60:63], v42, s[16:19], 0 offen offset:3072 sc0 sc1
    v_mfma_f32_16x16x32_bf16 v[112:115], a[216:219], a[104:107], v[112:115]
    ds_read_b64_tr_b16 a[248:249], v18 offset:12288
    ds_read_b64_tr_b16 a[250:251], v18 offset:13056
    v_mfma_f32_16x16x32_bf16 v[116:119], a[216:219], a[108:111], v[116:119]
    ds_read_b128 a[120:123], v32 offset:32768
    ds_read_b128 a[124:127], v32 offset:34816
    s_cmp_eq_u32 s3, 2
    s_cselect_b32 s35, -2, 1
    s_mul_i32 s35, s35, 192
    v_mfma_f32_16x16x32_bf16 v[124:127], a[220:223], a[108:111], v[124:127]
    ds_read_b64_tr_b16 a[216:217], v18 offset:18432
    ds_read_b64_tr_b16 a[218:219], v18 offset:19200
    v_mfma_f32_16x16x32_bf16 v[120:123], a[220:223], a[104:107], v[120:123]
    s_add_u32 s60, s60, s35
    s_nop 0
    v_mfma_f32_16x16x32_bf16 v[128:131], a[224:227], a[104:107], v[128:131]
    s_waitcnt lgkmcnt(12)
    ds_read_b64_tr_b16 a[220:221], v17 offset:12352
    ds_read_b64_tr_b16 a[222:223], v17 offset:13120
    v_mfma_f32_16x16x32_bf16 v[132:135], a[224:227], a[108:111], v[132:135]
    ds_read_b64_tr_b16 v[36:37], v33 offset:32768
    ds_read_b64_tr_b16 v[38:39], v34 offset:32768
    v_mfma_f32_16x16x32_bf16 v[140:143], a[228:231], a[108:111], v[140:143]
    ds_read_b64_tr_b16 a[224:225], v17 offset:18496
    ds_read_b64_tr_b16 a[226:227], v17 offset:19264
    v_mfma_f32_16x16x32_bf16 v[136:139], a[228:231], a[104:107], v[136:139]
    s_add_u32 s61, s61, s35
    s_add_u32 s62, s62, s35
    v_mfma_f32_16x16x32_bf16 v[144:147], a[232:235], a[104:107], v[144:147]
    ds_read_b64_tr_b16 a[228:229], v18 offset:12352
    ds_read_b64_tr_b16 a[230:231], v18 offset:13120
    v_mfma_f32_16x16x32_bf16 v[148:151], a[232:235], a[108:111], v[148:151]
    s_add_u32 s63, s63, s35
    s_add_u32 s64, s64, s35
    v_mfma_f32_16x16x32_bf16 v[156:159], a[236:239], a[108:111], v[156:159]
    s_waitcnt lgkmcnt(12)
    ds_read_b64_tr_b16 a[232:233], v18 offset:18496
    ds_read_b64_tr_b16 a[234:235], v18 offset:19264
    v_mfma_f32_16x16x32_bf16 v[152:155], a[236:239], a[104:107], v[152:155]
    s_add_u32 s65, s65, s35
    s_add_u32 s66, s66, s35
    v_mfma_f32_16x16x32_bf16 v[64:67], a[240:243], a[112:115], v[64:67]
    ds_read_b64_tr_b16 a[236:237], v17 offset:12416
    ds_read_b64_tr_b16 a[238:239], v17 offset:13184
    v_mfma_f32_16x16x32_bf16 v[68:71], a[240:243], a[116:119], v[68:71]
    s_add_u32 s67, s67, s35
    s_max_i32 s33, s48, 0
    v_mfma_f32_16x16x32_bf16 v[76:79], a[244:247], a[116:119], v[76:79]
    ds_read_b64_tr_b16 a[240:241], v17 offset:18560
    ds_read_b64_tr_b16 a[242:243], v17 offset:19328
    v_mfma_f32_16x16x32_bf16 v[72:75], a[244:247], a[112:115], v[72:75]
    s_add_u32 s68, s68, s35
    s_add_u32 m0, s23, 24576
    v_mfma_f32_16x16x32_bf16 v[80:83], a[248:251], a[112:115], v[80:83]
    s_waitcnt lgkmcnt(8)
    ds_read_b64_tr_b16 a[244:245], v18 offset:12416
    ds_read_b64_tr_b16 a[246:247], v18 offset:13184
    v_mfma_f32_16x16x32_bf16 v[84:87], a[248:251], a[116:119], v[84:87]
    buffer_load_dwordx4 v2, s[8:11], s60 offen offset:0 lds
    s_lshl_b32 s33, s33, 2
    v_mfma_f32_16x16x32_bf16 v[92:95], a[216:219], a[116:119], v[92:95]
    ds_read_b64_tr_b16 a[248:249], v18 offset:18560
    ds_read_b64_tr_b16 a[250:251], v18 offset:19328
    v_mfma_f32_16x16x32_bf16 v[88:91], a[216:219], a[112:115], v[88:91]
    buffer_load_dwordx4 v3, s[8:11], s60 offen offset:1024 lds
    v_mfma_f32_16x16x32_bf16 v[96:99], a[220:223], a[112:115], v[96:99]
    ds_read_b64_tr_b16 a[216:217], v17 offset:24576
    ds_read_b64_tr_b16 a[218:219], v17 offset:25344
    v_mfma_f32_16x16x32_bf16 v[100:103], a[220:223], a[116:119], v[100:103]
    buffer_load_dwordx4 v4, s[8:11], s60 offen offset:2048 lds
    s_add_u32 s33, s33, s22
    v_mfma_f32_16x16x32_bf16 v[108:111], a[224:227], a[116:119], v[108:111]
    s_waitcnt lgkmcnt(8)
    ds_read_b64_tr_b16 a[220:221], v17 offset:30720
    ds_read_b64_tr_b16 a[222:223], v17 offset:31488
    v_mfma_f32_16x16x32_bf16 v[104:107], a[224:227], a[112:115], v[104:107]
    s_lshl_b32 s31, s33, 8
    v_lshl_add_u32 v62, v1, 2, s31
    v_mfma_f32_16x16x32_bf16 v[112:115], a[228:231], a[112:115], v[112:115]
    ds_read_b64_tr_b16 a[224:225], v18 offset:24576
    ds_read_b64_tr_b16 a[226:227], v18 offset:25344
    v_mfma_f32_16x16x32_bf16 v[116:119], a[228:231], a[116:119], v[116:119]
    s_add_u32 m0, s23, 36864
    s_lshl_b32 s33, s33, 1
    v_mfma_f32_16x16x32_bf16 v[124:127], a[232:235], a[116:119], v[124:127]
    ds_read_b64_tr_b16 a[228:229], v18 offset:30720
    ds_read_b64_tr_b16 a[230:231], v18 offset:31488
    v_mfma_f32_16x16x32_bf16 v[120:123], a[232:235], a[112:115], v[120:123]
    buffer_load_dwordx4 v5, s[8:11], s60 offen offset:0 lds
    v_mfma_f32_16x16x32_bf16 v[128:131], a[236:239], a[112:115], v[128:131]
    s_waitcnt lgkmcnt(8)
    ds_read_b64_tr_b16 a[232:233], v17 offset:24640
    ds_read_b64_tr_b16 a[234:235], v17 offset:25408
    v_mfma_f32_16x16x32_bf16 v[132:135], a[236:239], a[116:119], v[132:135]
    s_sub_u32 s32, s76, s28
    v_mov_b32 v63, s33
    v_mfma_f32_16x16x32_bf16 v[140:143], a[240:243], a[116:119], v[140:143]
    ds_read_b64_tr_b16 a[236:237], v17 offset:30784
    ds_read_b64_tr_b16 a[238:239], v17 offset:31552
    v_mfma_f32_16x16x32_bf16 v[136:139], a[240:243], a[112:115], v[136:139]
    global_load_dword v48, v62, s[52:53]
    v_mfma_f32_16x16x32_bf16 v[144:147], a[244:247], a[112:115], v[144:147]
    ds_read_b64_tr_b16 a[240:241], v18 offset:24640
    ds_read_b64_tr_b16 a[242:243], v18 offset:25408
    v_mfma_f32_16x16x32_bf16 v[148:151], a[244:247], a[116:119], v[148:151]
    buffer_load_dwordx4 v6, s[8:11], s60 offen offset:1024 lds
    s_lshl_b32 s32, s32, 11
    v_mfma_f32_16x16x32_bf16 v[156:159], a[248:251], a[116:119], v[156:159]
    s_waitcnt lgkmcnt(8)
    ds_read_b64_tr_b16 a[244:245], v18 offset:30784
    ds_read_b64_tr_b16 a[246:247], v18 offset:31552
    v_mfma_f32_16x16x32_bf16 v[152:155], a[248:251], a[112:115], v[152:155]
    s_bitcmp1_b32 s25, 7
    s_cselect_b32 s32, s32, 0x7ff00000
    v_mfma_f32_16x16x32_bf16 v[64:67], a[216:219], a[120:123], v[64:67]
    ds_read_b64_tr_b16 a[248:249], v17 offset:24704
    ds_read_b64_tr_b16 a[250:251], v17 offset:25472
    v_mfma_f32_16x16x32_bf16 v[68:71], a[216:219], a[124:127], v[68:71]
    v_add_u32 v40, s32, v35
    v_mfma_f32_16x16x32_bf16 v[76:79], a[220:223], a[124:127], v[76:79]
    ds_read_b64_tr_b16 a[216:217], v17 offset:30848
    ds_read_b64_tr_b16 a[218:219], v17 offset:31616
    v_mfma_f32_16x16x32_bf16 v[72:75], a[220:223], a[120:123], v[72:75]
    buffer_store_dwordx4 v[36:39], v40, s[16:19], 0 offen sc0 sc1
    v_mfma_f32_16x16x32_bf16 v[80:83], a[224:227], a[120:123], v[80:83]
    s_waitcnt lgkmcnt(8)
    ds_read_b64_tr_b16 a[220:221], v18 offset:24704
    ds_read_b64_tr_b16 a[222:223], v18 offset:25472
    v_mfma_f32_16x16x32_bf16 v[84:87], a[224:227], a[124:127], v[84:87]
    buffer_load_dwordx4 v7, s[8:11], s60 offen offset:2048 lds
    v_mfma_f32_16x16x32_bf16 v[92:95], a[228:231], a[124:127], v[92:95]
    s_waitcnt vmcnt(9)
    ds_read_b64_tr_b16 a[224:225], v18 offset:30848
    ds_read_b64_tr_b16 a[226:227], v18 offset:31616
    v_mfma_f32_16x16x32_bf16 v[88:91], a[228:231], a[120:123], v[88:91]
    s_barrier
    v_subrev_u32 v17, 61440, v17
    v_subrev_u32 v18, 61440, v18
    v_mfma_f32_16x16x32_bf16 v[96:99], a[232:235], a[120:123], v[96:99]
    ds_read_b64_tr_b16 a[228:229], v17 offset:0
    ds_read_b64_tr_b16 a[230:231], v17 offset:768
    v_mfma_f32_16x16x32_bf16 v[100:103], a[232:235], a[124:127], v[100:103]
    ds_read_b128 a[128:131], v31 offset:49152
    ds_read_b128 a[132:135], v31 offset:51200
    v_mfma_f32_16x16x32_bf16 v[108:111], a[236:239], a[124:127], v[108:111]
    s_waitcnt lgkmcnt(10)
    ds_read_b64_tr_b16 a[232:233], v17 offset:6144
    ds_read_b64_tr_b16 a[234:235], v17 offset:6912
    v_mfma_f32_16x16x32_bf16 v[104:107], a[236:239], a[120:123], v[104:107]
    global_load_dword v49, v62, s[54:55]
    v_mfma_f32_16x16x32_bf16 v[112:115], a[240:243], a[120:123], v[112:115]
    ds_read_b64_tr_b16 a[236:237], v18 offset:0
    ds_read_b64_tr_b16 a[238:239], v18 offset:768
    v_mfma_f32_16x16x32_bf16 v[116:119], a[240:243], a[124:127], v[116:119]
    ds_read_b128 a[136:139], v32 offset:49152
    ds_read_b128 a[140:143], v32 offset:51200
    v_mfma_f32_16x16x32_bf16 v[124:127], a[244:247], a[124:127], v[124:127]
    ds_read_b64_tr_b16 a[240:241], v18 offset:6144
    ds_read_b64_tr_b16 a[242:243], v18 offset:6912
    v_mfma_f32_16x16x32_bf16 v[120:123], a[244:247], a[120:123], v[120:123]
    global_load_dword v50, v62, s[56:57]
    v_mfma_f32_16x16x32_bf16 v[128:131], a[248:251], a[120:123], v[128:131]
    s_waitcnt lgkmcnt(12)
    ds_read_b64_tr_b16 a[244:245], v17 offset:64
    ds_read_b64_tr_b16 a[246:247], v17 offset:832
    v_mfma_f32_16x16x32_bf16 v[132:135], a[248:251], a[124:127], v[132:135]
    ds_read_b64_tr_b16 v[36:37], v33 offset:49152
    ds_read_b64_tr_b16 v[38:39], v34 offset:49152
    v_mfma_f32_16x16x32_bf16 v[140:143], a[216:219], a[124:127], v[140:143]
    ds_read_b64_tr_b16 a[248:249], v17 offset:6208
    ds_read_b64_tr_b16 a[250:251], v17 offset:6976
    v_mfma_f32_16x16x32_bf16 v[136:139], a[216:219], a[120:123], v[136:139]
    global_load_dword v51, v62, s[58:59]
    s_add_u32 m0, s23, 49152
    v_mfma_f32_16x16x32_bf16 v[144:147], a[220:223], a[120:123], v[144:147]
    ds_read_b64_tr_b16 a[216:217], v18 offset:64
    ds_read_b64_tr_b16 a[218:219], v18 offset:832
    v_mfma_f32_16x16x32_bf16 v[148:151], a[220:223], a[124:127], v[148:151]
    buffer_load_dwordx4 v2, s[8:11], s61 offen offset:0 lds
    v_mfma_f32_16x16x32_bf16 v[156:159], a[224:227], a[124:127], v[156:159]
    s_waitcnt lgkmcnt(12)
    ds_read_b64_tr_b16 a[220:221], v18 offset:6208
    ds_read_b64_tr_b16 a[222:223], v18 offset:6976
    v_mfma_f32_16x16x32_bf16 v[152:155], a[224:227], a[120:123], v[152:155]
    buffer_load_dwordx4 v3, s[8:11], s61 offen offset:1024 lds
    v_mfma_f32_16x16x32_bf16 v[64:67], a[228:231], a[128:131], v[64:67]
    ds_read_b64_tr_b16 a[224:225], v17 offset:128
    ds_read_b64_tr_b16 a[226:227], v17 offset:896
    v_mfma_f32_16x16x32_bf16 v[68:71], a[228:231], a[132:135], v[68:71]
    global_load_dword v52, v62, s[96:97]
    v_mfma_f32_16x16x32_bf16 v[76:79], a[232:235], a[132:135], v[76:79]
    ds_read_b64_tr_b16 a[228:229], v17 offset:6272
    ds_read_b64_tr_b16 a[230:231], v17 offset:7040
    v_mfma_f32_16x16x32_bf16 v[72:75], a[232:235], a[128:131], v[72:75]
    buffer_load_dwordx4 v4, s[8:11], s61 offen offset:2048 lds
    v_mfma_f32_16x16x32_bf16 v[80:83], a[236:239], a[128:131], v[80:83]
    s_waitcnt lgkmcnt(8)
    ds_read_b64_tr_b16 a[232:233], v18 offset:128
    ds_read_b64_tr_b16 a[234:235], v18 offset:896
    v_mfma_f32_16x16x32_bf16 v[84:87], a[236:239], a[132:135], v[84:87]
    global_load_dword v53, v62, s[98:99]
    v_mfma_f32_16x16x32_bf16 v[92:95], a[240:243], a[132:135], v[92:95]
    ds_read_b64_tr_b16 a[236:237], v18 offset:6272
    ds_read_b64_tr_b16 a[238:239], v18 offset:7040
    v_mfma_f32_16x16x32_bf16 v[88:91], a[240:243], a[128:131], v[88:91]
    global_load_ushort v54, v63, s[100:101]
    v_mfma_f32_16x16x32_bf16 v[96:99], a[244:247], a[128:131], v[96:99]
    ds_read_b64_tr_b16 a[240:241], v17 offset:12288
    ds_read_b64_tr_b16 a[242:243], v17 offset:13056
    v_mfma_f32_16x16x32_bf16 v[100:103], a[244:247], a[132:135], v[100:103]
    s_add_u32 m0, s23, 61440
    v_mfma_f32_16x16x32_bf16 v[108:111], a[248:251], a[132:135], v[108:111]
    s_waitcnt lgkmcnt(8)
    ds_read_b64_tr_b16 a[244:245], v17 offset:18432
    ds_read_b64_tr_b16 a[246:247], v17 offset:19200
    v_mfma_f32_16x16x32_bf16 v[104:107], a[248:251], a[128:131], v[104:107]
    buffer_load_dwordx4 v5, s[8:11], s61 offen offset:0 lds
    v_mfma_f32_16x16x32_bf16 v[112:115], a[216:219], a[128:131], v[112:115]
    ds_read_b64_tr_b16 a[248:249], v18 offset:12288
    ds_read_b64_tr_b16 a[250:251], v18 offset:13056
    v_mfma_f32_16x16x32_bf16 v[116:119], a[216:219], a[132:135], v[116:119]
    buffer_load_dwordx4 v6, s[8:11], s61 offen offset:1024 lds
    v_mfma_f32_16x16x32_bf16 v[124:127], a[220:223], a[132:135], v[124:127]
    ds_read_b64_tr_b16 a[216:217], v18 offset:18432
    ds_read_b64_tr_b16 a[218:219], v18 offset:19200
    v_mfma_f32_16x16x32_bf16 v[120:123], a[220:223], a[128:131], v[120:123]
    s_sub_u32 s32, s77, s28
    s_lshl_b32 s32, s32, 11
    v_mfma_f32_16x16x32_bf16 v[128:131], a[224:227], a[128:131], v[128:131]
    s_waitcnt lgkmcnt(8)
    ds_read_b64_tr_b16 a[220:221], v17 offset:12352
    ds_read_b64_tr_b16 a[222:223], v17 offset:13120
    v_mfma_f32_16x16x32_bf16 v[132:135], a[224:227], a[132:135], v[132:135]
    s_bitcmp1_b32 s25, 8
    s_cselect_b32 s32, s32, 0x7ff00000
    v_mfma_f32_16x16x32_bf16 v[140:143], a[228:231], a[132:135], v[140:143]
    ds_read_b64_tr_b16 a[224:225], v17 offset:18496
    ds_read_b64_tr_b16 a[226:227], v17 offset:19264
    v_mfma_f32_16x16x32_bf16 v[136:139], a[228:231], a[128:131], v[136:139]
    buffer_load_dwordx4 v7, s[8:11], s61 offen offset:2048 lds
    v_mfma_f32_16x16x32_bf16 v[144:147], a[232:235], a[128:131], v[144:147]
    ds_read_b64_tr_b16 a[228:229], v18 offset:12352
    ds_read_b64_tr_b16 a[230:231], v18 offset:13120
    v_mfma_f32_16x16x32_bf16 v[148:151], a[232:235], a[132:135], v[148:151]
    v_add_u32 v40, s32, v35
    v_mfma_f32_16x16x32_bf16 v[156:159], a[236:239], a[132:135], v[156:159]
    s_waitcnt lgkmcnt(8)
    ds_read_b64_tr_b16 a[232:233], v18 offset:18496
    ds_read_b64_tr_b16 a[234:235], v18 offset:19264
    v_mfma_f32_16x16x32_bf16 v[152:155], a[236:239], a[128:131], v[152:155]
    buffer_store_dwordx4 v[36:39], v40, s[16:19], 0 offen sc0 sc1
    v_mfma_f32_16x16x32_bf16 v[64:67], a[240:243], a[136:139], v[64:67]
    ds_read_b64_tr_b16 a[236:237], v17 offset:12416
    ds_read_b64_tr_b16 a[238:239], v17 offset:13184
    v_mfma_f32_16x16x32_bf16 v[68:71], a[240:243], a[140:143], v[68:71]
    v_mfma_f32_16x16x32_bf16 v[76:79], a[244:247], a[140:143], v[76:79]
    ds_read_b64_tr_b16 a[240:241], v17 offset:18560
    ds_read_b64_tr_b16 a[242:243], v17 offset:19328
    v_mfma_f32_16x16x32_bf16 v[72:75], a[244:247], a[136:139], v[72:75]
    v_mfma_f32_16x16x32_bf16 v[80:83], a[248:251], a[136:139], v[80:83]
    s_waitcnt lgkmcnt(8)
    ds_read_b64_tr_b16 a[244:245], v18 offset:12416
    ds_read_b64_tr_b16 a[246:247], v18 offset:13184
    v_mfma_f32_16x16x32_bf16 v[84:87], a[248:251], a[140:143], v[84:87]
    v_mfma_f32_16x16x32_bf16 v[92:95], a[216:219], a[140:143], v[92:95]
    s_waitcnt vmcnt(13)
    ds_read_b64_tr_b16 a[248:249], v18 offset:18560
    ds_read_b64_tr_b16 a[250:251], v18 offset:19328
    v_mfma_f32_16x16x32_bf16 v[88:91], a[216:219], a[136:139], v[88:91]
    s_barrier
    v_mfma_f32_16x16x32_bf16 v[96:99], a[220:223], a[136:139], v[96:99]
    ds_read_b64_tr_b16 a[216:217], v17 offset:24576
    ds_read_b64_tr_b16 a[218:219], v17 offset:25344
    v_mfma_f32_16x16x32_bf16 v[100:103], a[220:223], a[140:143], v[100:103]
    v_mfma_f32_16x16x32_bf16 v[108:111], a[224:227], a[140:143], v[108:111]
    s_waitcnt lgkmcnt(8)
    ds_read_b64_tr_b16 a[220:221], v17 offset:30720
    ds_read_b64_tr_b16 a[222:223], v17 offset:31488
    v_mfma_f32_16x16x32_bf16 v[104:107], a[224:227], a[136:139], v[104:107]
    s_add_u32 m0, s23, 73728
    v_mfma_f32_16x16x32_bf16 v[112:115], a[228:231], a[136:139], v[112:115]
    ds_read_b64_tr_b16 a[224:225], v18 offset:24576
    ds_read_b64_tr_b16 a[226:227], v18 offset:25344
    v_mfma_f32_16x16x32_bf16 v[116:119], a[228:231], a[140:143], v[116:119]
    buffer_load_dwordx4 v2, s[8:11], s62 offen offset:0 lds
    v_mfma_f32_16x16x32_bf16 v[124:127], a[232:235], a[140:143], v[124:127]
    ds_read_b64_tr_b16 a[228:229], v18 offset:30720
    ds_read_b64_tr_b16 a[230:231], v18 offset:31488
    v_mfma_f32_16x16x32_bf16 v[120:123], a[232:235], a[136:139], v[120:123]
    buffer_load_dwordx4 v3, s[8:11], s62 offen offset:1024 lds
    v_mfma_f32_16x16x32_bf16 v[128:131], a[236:239], a[136:139], v[128:131]
    s_waitcnt lgkmcnt(8)
    ds_read_b64_tr_b16 a[232:233], v17 offset:24640
    ds_read_b64_tr_b16 a[234:235], v17 offset:25408
    v_mfma_f32_16x16x32_bf16 v[132:135], a[236:239], a[140:143], v[132:135]
    buffer_load_dwordx4 v4, s[8:11], s62 offen offset:2048 lds
    v_mfma_f32_16x16x32_bf16 v[140:143], a[240:243], a[140:143], v[140:143]
    ds_read_b64_tr_b16 a[236:237], v17 offset:30784
    ds_read_b64_tr_b16 a[238:239], v17 offset:31552
    v_mfma_f32_16x16x32_bf16 v[136:139], a[240:243], a[136:139], v[136:139]
    v_mfma_f32_16x16x32_bf16 v[144:147], a[244:247], a[136:139], v[144:147]
    ds_read_b64_tr_b16 a[240:241], v18 offset:24640
    ds_read_b64_tr_b16 a[242:243], v18 offset:25408
    v_mfma_f32_16x16x32_bf16 v[148:151], a[244:247], a[140:143], v[148:151]
    s_add_u32 m0, s23, 86016
    v_mfma_f32_16x16x32_bf16 v[156:159], a[248:251], a[140:143], v[156:159]
    s_waitcnt lgkmcnt(8)
    ds_read_b64_tr_b16 a[244:245], v18 offset:30784
    ds_read_b64_tr_b16 a[246:247], v18 offset:31552
    v_mfma_f32_16x16x32_bf16 v[152:155], a[248:251], a[136:139], v[152:155]
    buffer_load_dwordx4 v5, s[8:11], s62 offen offset:0 lds
    v_mfma_f32_16x16x32_bf16 v[160:163], a[216:219], a[0:3], 0
    ds_read_b64_tr_b16 a[248:249], v17 offset:24704
    ds_read_b64_tr_b16 a[250:251], v17 offset:25472
    v_mfma_f32_16x16x32_bf16 v[164:167], a[216:219], a[4:7], 0
    buffer_load_dwordx4 v6, s[8:11], s62 offen offset:1024 lds
    v_mfma_f32_16x16x32_bf16 v[172:175], a[220:223], a[4:7], 0
    ds_read_b64_tr_b16 a[216:217], v17 offset:30848
    ds_read_b64_tr_b16 a[218:219], v17 offset:31616
    v_mfma_f32_16x16x32_bf16 v[168:171], a[220:223], a[0:3], 0
    buffer_load_dwordx4 v7, s[8:11], s62 offen offset:2048 lds
    v_mfma_f32_16x16x32_bf16 v[176:179], a[224:227], a[0:3], 0
    s_waitcnt lgkmcnt(8)
    ds_read_b64_tr_b16 a[220:221], v18 offset:24704
    ds_read_b64_tr_b16 a[222:223], v18 offset:25472
    v_mfma_f32_16x16x32_bf16 v[180:183], a[224:227], a[4:7], 0
    v_mfma_f32_16x16x32_bf16 v[188:191], a[228:231], a[4:7], 0
    ds_read_b64_tr_b16 a[224:225], v18 offset:30848
    ds_read_b64_tr_b16 a[226:227], v18 offset:31616
    v_mfma_f32_16x16x32_bf16 v[184:187], a[228:231], a[0:3], 0
    v_mul_f32 v72, v64, v72
    v_mul_f32 v88, v80, v88
    v_mfma_f32_16x16x32_bf16 v[192:195], a[232:235], a[0:3], 0
    ds_read_b64_tr_b16 a[228:229], v17 offset:36864
    ds_read_b64_tr_b16 a[230:231], v17 offset:37632
    v_mfma_f32_16x16x32_bf16 v[196:199], a[232:235], a[4:7], 0
    s_add_u32 m0, s23, 98304
    v_mul_f32 v73, v65, v73
    v_mfma_f32_16x16x32_bf16 v[204:207], a[236:239], a[4:7], 0
    s_waitcnt lgkmcnt(8)
    ds_read_b64_tr_b16 a[232:233], v17 offset:43008
    ds_read_b64_tr_b16 a[234:235], v17 offset:43776
    v_mfma_f32_16x16x32_bf16 v[200:203], a[236:239], a[0:3], 0
    buffer_load_dwordx4 v2, s[8:11], s63 offen offset:0 lds
    v_mfma_f32_16x16x32_bf16 v[208:211], a[240:243], a[0:3], 0
    ds_read_b64_tr_b16 a[236:237], v18 offset:36864
    ds_read_b64_tr_b16 a[238:239], v18 offset:37632
    v_mfma_f32_16x16x32_bf16 v[212:215], a[240:243], a[4:7], 0
    buffer_load_dwordx4 v3, s[8:11], s63 offen offset:1024 lds
    v_mul_f32 v89, v81, v89
    v_mfma_f32_16x16x32_bf16 v[220:223], a[244:247], a[4:7], 0
    ds_read_b64_tr_b16 a[240:241], v18 offset:43008
    ds_read_b64_tr_b16 a[242:243], v18 offset:43776
    v_mfma_f32_16x16x32_bf16 v[216:219], a[244:247], a[0:3], 0
    buffer_load_dwordx4 v4, s[8:11], s63 offen offset:2048 lds
    v_mul_f32 v74, v66, v74
    v_mfma_f32_16x16x32_bf16 v[224:227], a[248:251], a[0:3], 0
    s_waitcnt lgkmcnt(8)
    ds_read_b64_tr_b16 a[244:245], v17 offset:36928
    ds_read_b64_tr_b16 a[246:247], v17 offset:37696
    v_mfma_f32_16x16x32_bf16 v[228:231], a[248:251], a[4:7], 0
    v_mul_f32 v90, v82, v90
    v_mul_f32 v75, v67, v75
    v_mul_f32 v91, v83, v91
    v_mfma_f32_16x16x32_bf16 v[236:239], a[216:219], a[4:7], 0
    ds_read_b64_tr_b16 a[248:249], v17 offset:43072
    ds_read_b64_tr_b16 a[250:251], v17 offset:43840
    v_mfma_f32_16x16x32_bf16 v[232:235], a[216:219], a[0:3], 0
    v_mul_f32 v64, s34, v64
    v_mul_f32 v80, s34, v80
    v_mfma_f32_16x16x32_bf16 v[240:243], a[220:223], a[0:3], 0
    ds_read_b64_tr_b16 a[216:217], v18 offset:36928
    ds_read_b64_tr_b16 a[218:219], v18 offset:37696
    v_mfma_f32_16x16x32_bf16 v[244:247], a[220:223], a[4:7], 0
    v_mul_f32 v65, s34, v65
    v_mul_f32 v81, s34, v81
    v_mfma_f32_16x16x32_bf16 v[252:255], a[224:227], a[4:7], 0
    s_waitcnt lgkmcnt(8)
    ds_read_b64_tr_b16 a[220:221], v18 offset:43072
    ds_read_b64_tr_b16 a[222:223], v18 offset:43840
    v_mfma_f32_16x16x32_bf16 v[248:251], a[224:227], a[0:3], 0
    s_add_u32 m0, s23, 110592
    v_mul_f32 v66, s34, v66
    v_mul_f32 v82, s34, v82
    v_mfma_f32_16x16x32_bf16 v[160:163], a[228:231], a[8:11], v[160:163]
    ds_read_b64_tr_b16 a[224:225], v17 offset:36992
    ds_read_b64_tr_b16 a[226:227], v17 offset:37760
    v_mfma_f32_16x16x32_bf16 v[164:167], a[228:231], a[12:15], v[164:167]
    buffer_load_dwordx4 v5, s[8:11], s63 offen offset:0 lds
    v_mul_f32 v67, s34, v67
    v_mfma_f32_16x16x32_bf16 v[172:175], a[232:235], a[12:15], v[172:175]
    ds_read_b64_tr_b16 a[228:229], v17 offset:43136
    ds_read_b64_tr_b16 a[230:231], v17 offset:43904
    v_mfma_f32_16x16x32_bf16 v[168:171], a[232:235], a[8:11], v[168:171]
    buffer_load_dwordx4 v6, s[8:11], s63 offen offset:1024 lds
    v_mul_f32 v83, s34, v83
    v_mfma_f32_16x16x32_bf16 v[176:179], a[236:239], a[8:11], v[176:179]
    s_waitcnt lgkmcnt(8)
    ds_read_b64_tr_b16 a[232:233], v18 offset:36992
    ds_read_b64_tr_b16 a[234:235], v18 offset:37760
    v_mfma_f32_16x16x32_bf16 v[180:183], a[236:239], a[12:15], v[180:183]
    buffer_load_dwordx4 v7, s[8:11], s63 offen offset:2048 lds
    v_exp_f32 v64, v64
    v_mfma_f32_16x16x32_bf16 v[188:191], a[240:243], a[12:15], v[188:191]
    s_waitcnt vmcnt(13)
    ds_read_b64_tr_b16 a[236:237], v18 offset:43136
    ds_read_b64_tr_b16 a[238:239], v18 offset:43904
    v_mfma_f32_16x16x32_bf16 v[184:187], a[240:243], a[8:11], v[184:187]
    s_barrier
    v_mfma_f32_16x16x32_bf16 v[192:195], a[244:247], a[8:11], v[192:195]
    ds_read_b64_tr_b16 a[240:241], v17 offset:49152
    ds_read_b64_tr_b16 a[242:243], v17 offset:49920
    v_mfma_f32_16x16x32_bf16 v[196:199], a[244:247], a[12:15], v[196:199]
    v_exp_f32 v80, v80
    v_exp_f32 v65, v65
    v_mfma_f32_16x16x32_bf16 v[204:207], a[248:251], a[12:15], v[204:207]
    s_waitcnt lgkmcnt(8)
    ds_read_b64_tr_b16 a[244:245], v17 offset:55296
    ds_read_b64_tr_b16 a[246:247], v17 offset:56064
    v_mfma_f32_16x16x32_bf16 v[200:203], a[248:251], a[8:11], v[200:203]
    v_exp_f32 v81, v81
    v_exp_f32 v66, v66
    v_mfma_f32_16x16x32_bf16 v[208:211], a[216:219], a[8:11], v[208:211]
    ds_read_b64_tr_b16 a[248:249], v18 offset:49152
    ds_read_b64_tr_b16 a[250:251], v18 offset:49920
    v_mfma_f32_16x16x32_bf16 v[212:215], a[216:219], a[12:15], v[212:215]
    v_exp_f32 v82, v82
    v_mfma_f32_16x16x32_bf16 v[220:223], a[220:223], a[12:15], v[220:223]
    ds_read_b64_tr_b16 a[216:217], v18 offset:55296
    ds_read_b64_tr_b16 a[218:219], v18 offset:56064
    v_mfma_f32_16x16x32_bf16 v[216:219], a[220:223], a[8:11], v[216:219]
    s_add_u32 m0, s23, 122880
    s_mul_i32 s30, s20, 331776
    v_exp_f32 v67, v67
    v_mfma_f32_16x16x32_bf16 v[224:227], a[224:227], a[8:11], v[224:227]
    s_waitcnt lgkmcnt(8)
    ds_read_b64_tr_b16 a[220:221], v17 offset:49216
    ds_read_b64_tr_b16 a[222:223], v17 offset:49984
    v_mfma_f32_16x16x32_bf16 v[228:231], a[224:227], a[12:15], v[228:231]
    buffer_load_dwordx4 v2, s[8:11], s64 offen offset:0 lds
    v_exp_f32 v83, v83
    v_mfma_f32_16x16x32_bf16 v[236:239], a[228:231], a[12:15], v[236:239]
    ds_read_b64_tr_b16 a[224:225], v17 offset:55360
    ds_read_b64_tr_b16 a[226:227], v17 offset:56128
    v_mfma_f32_16x16x32_bf16 v[232:235], a[228:231], a[8:11], v[232:235]
    buffer_load_dwordx4 v3, s[8:11], s64 offen offset:1024 lds
    v_add_f32 v64, 1.0, v64
    v_mfma_f32_16x16x32_bf16 v[240:243], a[232:235], a[8:11], v[240:243]
    ds_read_b64_tr_b16 a[228:229], v18 offset:49216
    ds_read_b64_tr_b16 a[230:231], v18 offset:49984
    v_mfma_f32_16x16x32_bf16 v[244:247], a[232:235], a[12:15], v[244:247]
    buffer_load_dwordx4 v4, s[8:11], s64 offen offset:2048 lds
    v_add_f32 v80, 1.0, v80
    v_mfma_f32_16x16x32_bf16 v[252:255], a[236:239], a[12:15], v[252:255]
    s_waitcnt lgkmcnt(8)
    ds_read_b64_tr_b16 a[232:233], v18 offset:55360
    ds_read_b64_tr_b16 a[234:235], v18 offset:56128
    v_mfma_f32_16x16x32_bf16 v[248:251], a[236:239], a[8:11], v[248:251]
    v_add_f32 v65, 1.0, v65
    v_add_f32 v81, 1.0, v81
    v_add_f32 v66, 1.0, v66
    v_mfma_f32_16x16x32_bf16 v[160:163], a[240:243], a[16:19], v[160:163]
    ds_read_b64_tr_b16 a[236:237], v17 offset:49280
    ds_read_b64_tr_b16 a[238:239], v17 offset:50048
    v_mfma_f32_16x16x32_bf16 v[164:167], a[240:243], a[20:23], v[164:167]
    v_add_f32 v82, 1.0, v82
    v_add_f32 v67, 1.0, v67
    v_add_f32 v83, 1.0, v83
    v_mfma_f32_16x16x32_bf16 v[172:175], a[244:247], a[20:23], v[172:175]
    ds_read_b64_tr_b16 a[240:241], v17 offset:55424
    ds_read_b64_tr_b16 a[242:243], v17 offset:56192
    v_mfma_f32_16x16x32_bf16 v[168:171], a[244:247], a[16:19], v[168:171]
    s_add_u32 m0, s23, 135168
    v_rcp_f32 v64, v64
    v_mfma_f32_16x16x32_bf16 v[176:179], a[248:251], a[16:19], v[176:179]
    s_waitcnt lgkmcnt(8)
    ds_read_b64_tr_b16 a[244:245], v18 offset:49280
    ds_read_b64_tr_b16 a[246:247], v18 offset:50048
    v_mfma_f32_16x16x32_bf16 v[180:183], a[248:251], a[20:23], v[180:183]
    buffer_load_dwordx4 v5, s[8:11], s64 offen offset:0 lds
    v_rcp_f32 v80, v80
    v_mfma_f32_16x16x32_bf16 v[188:191], a[216:219], a[20:23], v[188:191]
    ds_read_b64_tr_b16 a[248:249], v18 offset:55424
    ds_read_b64_tr_b16 a[250:251], v18 offset:56192
    v_mfma_f32_16x16x32_bf16 v[184:187], a[216:219], a[16:19], v[184:187]
    buffer_load_dwordx4 v6, s[8:11], s64 offen offset:1024 lds
    v_rcp_f32 v65, v65
    v_mfma_f32_16x16x32_bf16 v[192:195], a[220:223], a[16:19], v[192:195]
    ds_read_b64_tr_b16 a[216:217], v17 offset:61440
    ds_read_b64_tr_b16 a[218:219], v17 offset:62208
    v_mfma_f32_16x16x32_bf16 v[196:199], a[220:223], a[20:23], v[196:199]
    v_add_u32 v17, 61440, v17
    v_add_u32 v18, 61440, v18
    v_rcp_f32 v81, v81
    v_mfma_f32_16x16x32_bf16 v[204:207], a[224:227], a[20:23], v[204:207]
    s_waitcnt lgkmcnt(8)
    ds_read_b64_tr_b16 a[220:221], v17 offset:6144
    ds_read_b64_tr_b16 a[222:223], v17 offset:6912
    v_mfma_f32_16x16x32_bf16 v[200:203], a[224:227], a[16:19], v[200:203]
    buffer_load_dwordx4 v7, s[8:11], s64 offen offset:2048 lds
    v_rcp_f32 v66, v66
    v_mfma_f32_16x16x32_bf16 v[208:211], a[228:231], a[16:19], v[208:211]
    ds_read_b64_tr_b16 a[224:225], v18 offset:0
    ds_read_b64_tr_b16 a[226:227], v18 offset:768
    v_mfma_f32_16x16x32_bf16 v[212:215], a[228:231], a[20:23], v[212:215]
    v_rcp_f32 v82, v82
    s_add_u32 m0, s23, 0
    v_mfma_f32_16x16x32_bf16 v[220:223], a[232:235], a[20:23], v[220:223]
    ds_read_b64_tr_b16 a[228:229], v18 offset:6144
    ds_read_b64_tr_b16 a[230:231], v18 offset:6912
    v_mfma_f32_16x16x32_bf16 v[216:219], a[232:235], a[16:19], v[216:219]
    buffer_load_dwordx4 v2, s[8:11], s65 offen offset:0 lds
    v_rcp_f32 v67, v67
    v_mfma_f32_16x16x32_bf16 v[224:227], a[236:239], a[16:19], v[224:227]
    s_waitcnt lgkmcnt(8)
    ds_read_b64_tr_b16 a[232:233], v17 offset:64
    ds_read_b64_tr_b16 a[234:235], v17 offset:832
    v_mfma_f32_16x16x32_bf16 v[228:231], a[236:239], a[20:23], v[228:231]
    buffer_load_dwordx4 v3, s[8:11], s65 offen offset:1024 lds
    v_rcp_f32 v83, v83
    v_mfma_f32_16x16x32_bf16 v[236:239], a[240:243], a[20:23], v[236:239]
    ds_read_b64_tr_b16 a[236:237], v17 offset:6208
    ds_read_b64_tr_b16 a[238:239], v17 offset:6976
    v_mfma_f32_16x16x32_bf16 v[232:235], a[240:243], a[16:19], v[232:235]
    buffer_load_dwordx4 v4, s[8:11], s65 offen offset:2048 lds
    v_mul_f32 v72, v72, v64
    v_mfma_f32_16x16x32_bf16 v[240:243], a[244:247], a[16:19], v[240:243]
    ds_read_b64_tr_b16 a[240:241], v18 offset:64
    ds_read_b64_tr_b16 a[242:243], v18 offset:832
    v_mfma_f32_16x16x32_bf16 v[244:247], a[244:247], a[20:23], v[244:247]
    v_mul_f32 v88, v88, v80
    v_mul_f32 v73, v73, v65
    v_mul_f32 v89, v89, v81
    v_mfma_f32_16x16x32_bf16 v[252:255], a[248:251], a[20:23], v[252:255]
    s_waitcnt lgkmcnt(8)
    ds_read_b64_tr_b16 a[244:245], v18 offset:6208
    ds_read_b64_tr_b16 a[246:247], v18 offset:6976
    v_mfma_f32_16x16x32_bf16 v[248:251], a[248:251], a[16:19], v[248:251]
    v_mul_f32 v74, v74, v66
    v_mul_f32 v90, v90, v82
    s_mul_i32 s69, s51, 128
    s_add_u32 s69, s69, s30
    s_add_u32 s29, s30, 1152
    v_mfma_f32_16x16x32_bf16 v[160:163], a[216:219], a[24:27], v[160:163]
    ds_read_b64_tr_b16 a[248:249], v17 offset:128
    ds_read_b64_tr_b16 a[250:251], v17 offset:896
    v_mfma_f32_16x16x32_bf16 v[164:167], a[216:219], a[28:31], v[164:167]
    s_add_u32 m0, s23, 12288
    v_mul_f32 v75, v75, v67
    v_mul_f32 v91, v91, v83
    v_mfma_f32_16x16x32_bf16 v[172:175], a[220:223], a[28:31], v[172:175]
    ds_read_b64_tr_b16 a[216:217], v17 offset:6272
    ds_read_b64_tr_b16 a[218:219], v17 offset:7040
    v_mfma_f32_16x16x32_bf16 v[168:171], a[220:223], a[24:27], v[168:171]
    buffer_load_dwordx4 v5, s[8:11], s65 offen offset:0 lds
    v_cvt_pk_bf16_f32 v64, v72, v73
    v_mfma_f32_16x16x32_bf16 v[176:179], a[224:227], a[24:27], v[176:179]
    s_waitcnt lgkmcnt(8)
    ds_read_b64_tr_b16 a[220:221], v18 offset:128
    ds_read_b64_tr_b16 a[222:223], v18 offset:896
    v_mfma_f32_16x16x32_bf16 v[180:183], a[224:227], a[28:31], v[180:183]
    buffer_load_dwordx4 v6, s[8:11], s65 offen offset:1024 lds
    v_cvt_pk_bf16_f32 v80, v88, v89
    v_mfma_f32_16x16x32_bf16 v[188:191], a[228:231], a[28:31], v[188:191]
    s_waitcnt vmcnt(17)
    ds_read_b64_tr_b16 a[224:225], v18 offset:6272
    ds_read_b64_tr_b16 a[226:227], v18 offset:7040
    v_mfma_f32_16x16x32_bf16 v[184:187], a[228:231], a[24:27], v[184:187]
    s_barrier
    v_mfma_f32_16x16x32_bf16 v[192:195], a[232:235], a[24:27], v[192:195]
    ds_read_b64_tr_b16 a[228:229], v17 offset:12288
    ds_read_b64_tr_b16 a[230:231], v17 offset:13056
    v_mfma_f32_16x16x32_bf16 v[196:199], a[232:235], a[28:31], v[196:199]
    buffer_load_dwordx4 v7, s[8:11], s65 offen offset:2048 lds
    v_cvt_pk_bf16_f32 v65, v74, v75
    v_mfma_f32_16x16x32_bf16 v[204:207], a[236:239], a[28:31], v[204:207]
    s_waitcnt lgkmcnt(8)
    ds_read_b64_tr_b16 a[232:233], v17 offset:18432
    ds_read_b64_tr_b16 a[234:235], v17 offset:19200
    v_mfma_f32_16x16x32_bf16 v[200:203], a[236:239], a[24:27], v[200:203]
    v_cvt_pk_bf16_f32 v81, v90, v91
    v_accvgpr_write_b32 a144, v64
    v_accvgpr_write_b32 a146, v80
    v_mfma_f32_16x16x32_bf16 v[208:211], a[240:243], a[24:27], v[208:211]
    ds_read_b64_tr_b16 a[236:237], v18 offset:12288
    ds_read_b64_tr_b16 a[238:239], v18 offset:13056
    v_mfma_f32_16x16x32_bf16 v[212:215], a[240:243], a[28:31], v[212:215]
    v_accvgpr_write_b32 a145, v65
    v_accvgpr_write_b32 a147, v81
    v_mul_f32 v76, v68, v76
    v_mfma_f32_16x16x32_bf16 v[220:223], a[244:247], a[28:31], v[220:223]
    ds_read_b64_tr_b16 a[240:241], v18 offset:18432
    ds_read_b64_tr_b16 a[242:243], v18 offset:19200
    v_mfma_f32_16x16x32_bf16 v[216:219], a[244:247], a[24:27], v[216:219]
    v_mul_f32 v92, v84, v92
    v_mul_f32 v77, v69, v77
    v_mul_f32 v93, v85, v93
    v_mfma_f32_16x16x32_bf16 v[224:227], a[248:251], a[24:27], v[224:227]
    s_waitcnt lgkmcnt(8)
    ds_read_b64_tr_b16 a[244:245], v17 offset:12352
    ds_read_b64_tr_b16 a[246:247], v17 offset:13120
    v_mfma_f32_16x16x32_bf16 v[228:231], a[248:251], a[28:31], v[228:231]
    v_mul_f32 v78, v70, v78
    v_mul_f32 v94, v86, v94
    v_mul_f32 v79, v71, v79
    v_mfma_f32_16x16x32_bf16 v[236:239], a[216:219], a[28:31], v[236:239]
    ds_read_b64_tr_b16 a[248:249], v17 offset:18496
    ds_read_b64_tr_b16 a[250:251], v17 offset:19264
    v_mfma_f32_16x16x32_bf16 v[232:235], a[216:219], a[24:27], v[232:235]
    v_mul_f32 v95, v87, v95
    v_mul_f32 v68, s34, v68
    v_mul_f32 v84, s34, v84
    v_mfma_f32_16x16x32_bf16 v[240:243], a[220:223], a[24:27], v[240:243]
    ds_read_b64_tr_b16 a[216:217], v18 offset:12352
    ds_read_b64_tr_b16 a[218:219], v18 offset:13120
    v_mfma_f32_16x16x32_bf16 v[244:247], a[220:223], a[28:31], v[244:247]
    v_mul_f32 v69, s34, v69
    v_mul_f32 v85, s34, v85
    s_add_u32 m0, s23, 24576
    v_mfma_f32_16x16x32_bf16 v[252:255], a[224:227], a[28:31], v[252:255]
    s_waitcnt lgkmcnt(8)
    ds_read_b64_tr_b16 a[220:221], v18 offset:18496
    ds_read_b64_tr_b16 a[222:223], v18 offset:19264
    v_mfma_f32_16x16x32_bf16 v[248:251], a[224:227], a[24:27], v[248:251]
    buffer_load_dwordx4 v2, s[8:11], s66 offen offset:0 lds
    v_mul_f32 v70, s34, v70
    v_mfma_f32_16x16x32_bf16 v[160:163], a[228:231], a[32:35], v[160:163]
    ds_read_b64_tr_b16 a[224:225], v17 offset:12416
    ds_read_b64_tr_b16 a[226:227], v17 offset:13184
    v_mfma_f32_16x16x32_bf16 v[164:167], a[228:231], a[36:39], v[164:167]
    v_mul_f32 v86, s34, v86
    v_mul_f32 v71, s34, v71
    v_mul_f32 v87, s34, v87
    v_mfma_f32_16x16x32_bf16 v[172:175], a[232:235], a[36:39], v[172:175]
    ds_read_b64_tr_b16 a[228:229], v17 offset:18560
    ds_read_b64_tr_b16 a[230:231], v17 offset:19328
    v_mfma_f32_16x16x32_bf16 v[168:171], a[232:235], a[32:35], v[168:171]
    v_exp_f32 v68, v68
    v_exp_f32 v84, v84
    v_mfma_f32_16x16x32_bf16 v[176:179], a[236:239], a[32:35], v[176:179]
    s_waitcnt lgkmcnt(8)
    ds_read_b64_tr_b16 a[232:233], v18 offset:12416
    ds_read_b64_tr_b16 a[234:235], v18 offset:13184
    v_mfma_f32_16x16x32_bf16 v[180:183], a[236:239], a[36:39], v[180:183]
    buffer_load_dwordx4 v3, s[8:11], s66 offen offset:1024 lds
    v_exp_f32 v69, v69
    v_mfma_f32_16x16x32_bf16 v[188:191], a[240:243], a[36:39], v[188:191]
    ds_read_b64_tr_b16 a[236:237], v18 offset:18560
    ds_read_b64_tr_b16 a[238:239], v18 offset:19328
    v_mfma_f32_16x16x32_bf16 v[184:187], a[240:243], a[32:35], v[184:187]
    buffer_load_dwordx4 v4, s[8:11], s66 offen offset:2048 lds
    v_exp_f32 v85, v85
    v_mfma_f32_16x16x32_bf16 v[192:195], a[244:247], a[32:35], v[192:195]
    ds_read_b64_tr_b16 a[240:241], v17 offset:24576
    ds_read_b64_tr_b16 a[242:243], v17 offset:25344
    v_mfma_f32_16x16x32_bf16 v[196:199], a[244:247], a[36:39], v[196:199]
    v_exp_f32 v70, v70
    v_exp_f32 v86, v86
    v_mfma_f32_16x16x32_bf16 v[204:207], a[248:251], a[36:39], v[204:207]
    s_waitcnt lgkmcnt(8)
    ds_read_b64_tr_b16 a[244:245], v17 offset:30720
    ds_read_b64_tr_b16 a[246:247], v17 offset:31488
    v_mfma_f32_16x16x32_bf16 v[200:203], a[248:251], a[32:35], v[200:203]
    v_exp_f32 v71, v71
    s_add_u32 s70, s69, 128
    s_cmp_eq_u32 s70, s29
    s_cselect_b32 s70, s30, s70
    v_mfma_f32_16x16x32_bf16 v[208:211], a[216:219], a[32:35], v[208:211]
    ds_read_b64_tr_b16 a[248:249], v18 offset:24576
    ds_read_b64_tr_b16 a[250:251], v18 offset:25344
    v_mfma_f32_16x16x32_bf16 v[212:215], a[216:219], a[36:39], v[212:215]
    v_exp_f32 v87, v87
    v_mfma_f32_16x16x32_bf16 v[220:223], a[220:223], a[36:39], v[220:223]
    ds_read_b64_tr_b16 a[216:217], v18 offset:30720
    ds_read_b64_tr_b16 a[218:219], v18 offset:31488
    v_mfma_f32_16x16x32_bf16 v[216:219], a[220:223], a[32:35], v[216:219]
    v_add_f32 v68, 1.0, v68
    v_add_f32 v84, 1.0, v84
    v_mfma_f32_16x16x32_bf16 v[224:227], a[224:227], a[32:35], v[224:227]
    s_waitcnt lgkmcnt(8)
    ds_read_b64_tr_b16 a[220:221], v17 offset:24640
    ds_read_b64_tr_b16 a[222:223], v17 offset:25408
    v_mfma_f32_16x16x32_bf16 v[228:231], a[224:227], a[36:39], v[228:231]
    s_add_u32 m0, s23, 36864
    v_add_f32 v69, 1.0, v69
    v_add_f32 v85, 1.0, v85
    v_mfma_f32_16x16x32_bf16 v[236:239], a[228:231], a[36:39], v[236:239]
    ds_read_b64_tr_b16 a[224:225], v17 offset:30784
    ds_read_b64_tr_b16 a[226:227], v17 offset:31552
    v_mfma_f32_16x16x32_bf16 v[232:235], a[228:231], a[32:35], v[232:235]
    buffer_load_dwordx4 v5, s[8:11], s66 offen offset:0 lds
    v_add_f32 v70, 1.0, v70
    v_mfma_f32_16x16x32_bf16 v[240:243], a[232:235], a[32:35], v[240:243]
    ds_read_b64_tr_b16 a[228:229], v18 offset:24640
    ds_read_b64_tr_b16 a[230:231], v18 offset:25408
    v_mfma_f32_16x16x32_bf16 v[244:247], a[232:235], a[36:39], v[244:247]
    v_add_f32 v86, 1.0, v86
    v_add_f32 v71, 1.0, v71
    v_add_f32 v87, 1.0, v87
    v_mfma_f32_16x16x32_bf16 v[252:255], a[236:239], a[36:39], v[252:255]
    s_waitcnt lgkmcnt(8)
    ds_read_b64_tr_b16 a[232:233], v18 offset:30784
    ds_read_b64_tr_b16 a[234:235], v18 offset:31552
    v_mfma_f32_16x16x32_bf16 v[248:251], a[236:239], a[32:35], v[248:251]
    buffer_load_dwordx4 v6, s[8:11], s66 offen offset:1024 lds
    v_rcp_f32 v68, v68
    v_mfma_f32_16x16x32_bf16 v[160:163], a[240:243], a[40:43], v[160:163]
    ds_read_b64_tr_b16 a[236:237], v17 offset:24704
    ds_read_b64_tr_b16 a[238:239], v17 offset:25472
    v_mfma_f32_16x16x32_bf16 v[164:167], a[240:243], a[44:47], v[164:167]
    v_rcp_f32 v84, v84
    v_mfma_f32_16x16x32_bf16 v[172:175], a[244:247], a[44:47], v[172:175]
    ds_read_b64_tr_b16 a[240:241], v17 offset:30848
    ds_read_b64_tr_b16 a[242:243], v17 offset:31616
    v_mfma_f32_16x16x32_bf16 v[168:171], a[244:247], a[40:43], v[168:171]
    buffer_load_dwordx4 v7, s[8:11], s66 offen offset:2048 lds
    v_rcp_f32 v69, v69
    v_mfma_f32_16x16x32_bf16 v[176:179], a[248:251], a[40:43], v[176:179]
    s_waitcnt lgkmcnt(8)
    ds_read_b64_tr_b16 a[244:245], v18 offset:24704
    ds_read_b64_tr_b16 a[246:247], v18 offset:25472
    v_mfma_f32_16x16x32_bf16 v[180:183], a[248:251], a[44:47], v[180:183]
    v_rcp_f32 v85, v85
    v_mfma_f32_16x16x32_bf16 v[188:191], a[216:219], a[44:47], v[188:191]
    s_waitcnt vmcnt(18)
    ds_read_b64_tr_b16 a[248:249], v18 offset:30848
    ds_read_b64_tr_b16 a[250:251], v18 offset:31616
    v_mfma_f32_16x16x32_bf16 v[184:187], a[216:219], a[40:43], v[184:187]
    s_barrier
    v_mfma_f32_16x16x32_bf16 v[192:195], a[220:223], a[40:43], v[192:195]
    ds_read_b64_tr_b16 a[216:217], v17 offset:36864
    ds_read_b64_tr_b16 a[218:219], v17 offset:37632
    v_mfma_f32_16x16x32_bf16 v[196:199], a[220:223], a[44:47], v[196:199]
    v_rcp_f32 v70, v70
    v_rcp_f32 v86, v86
    v_mfma_f32_16x16x32_bf16 v[204:207], a[224:227], a[44:47], v[204:207]
    s_waitcnt lgkmcnt(8)
    ds_read_b64_tr_b16 a[220:221], v17 offset:43008
    ds_read_b64_tr_b16 a[222:223], v17 offset:43776
    v_mfma_f32_16x16x32_bf16 v[200:203], a[224:227], a[40:43], v[200:203]
    v_rcp_f32 v71, v71
    v_rcp_f32 v87, v87
    v_mfma_f32_16x16x32_bf16 v[208:211], a[228:231], a[40:43], v[208:211]
    ds_read_b64_tr_b16 a[224:225], v18 offset:36864
    ds_read_b64_tr_b16 a[226:227], v18 offset:37632
    v_mfma_f32_16x16x32_bf16 v[212:215], a[228:231], a[44:47], v[212:215]
    v_mul_f32 v76, v76, v68
    v_mul_f32 v92, v92, v84
    v_mfma_f32_16x16x32_bf16 v[220:223], a[232:235], a[44:47], v[220:223]
    ds_read_b64_tr_b16 a[228:229], v18 offset:43008
    ds_read_b64_tr_b16 a[230:231], v18 offset:43776
    v_mfma_f32_16x16x32_bf16 v[216:219], a[232:235], a[40:43], v[216:219]
    v_mul_f32 v77, v77, v69
    v_mul_f32 v93, v93, v85
    v_mfma_f32_16x16x32_bf16 v[224:227], a[236:239], a[40:43], v[224:227]
    s_waitcnt lgkmcnt(8)
    ds_read_b64_tr_b16 a[232:233], v17 offset:36928
    ds_read_b64_tr_b16 a[234:235], v17 offset:37696
    v_mfma_f32_16x16x32_bf16 v[228:231], a[236:239], a[44:47], v[228:231]
    s_add_u32 m0, s23, 49152
    v_mul_f32 v78, v78, v70
    s_add_u32 s71, s70, 128
    s_cmp_eq_u32 s71, s29
    s_cselect_b32 s71, s30, s71
    v_mfma_f32_16x16x32_bf16 v[236:239], a[240:243], a[44:47], v[236:239]
    ds_read_b64_tr_b16 a[236:237], v17 offset:43072
    ds_read_b64_tr_b16 a[238:239], v17 offset:43840
    v_mfma_f32_16x16x32_bf16 v[232:235], a[240:243], a[40:43], v[232:235]
    buffer_load_dwordx4 v2, s[8:11], s67 offen offset:0 lds
    v_mul_f32 v94, v94, v86
    v_mfma_f32_16x16x32_bf16 v[240:243], a[244:247], a[40:43], v[240:243]
    ds_read_b64_tr_b16 a[240:241], v18 offset:36928
    ds_read_b64_tr_b16 a[242:243], v18 offset:37696
    v_mfma_f32_16x16x32_bf16 v[244:247], a[244:247], a[44:47], v[244:247]
    v_mul_f32 v79, v79, v71
    v_mul_f32 v95, v95, v87
    v_mfma_f32_16x16x32_bf16 v[252:255], a[248:251], a[44:47], v[252:255]
    s_waitcnt lgkmcnt(8)
    ds_read_b64_tr_b16 a[244:245], v18 offset:43072
    ds_read_b64_tr_b16 a[246:247], v18 offset:43840
    v_mfma_f32_16x16x32_bf16 v[248:251], a[248:251], a[40:43], v[248:251]
    v_cvt_pk_bf16_f32 v68, v76, v77
    v_cvt_pk_bf16_f32 v84, v92, v93
    v_mfma_f32_16x16x32_bf16 v[160:163], a[216:219], a[48:51], v[160:163]
    ds_read_b64_tr_b16 a[248:249], v17 offset:36992
    ds_read_b64_tr_b16 a[250:251], v17 offset:37760
    v_mfma_f32_16x16x32_bf16 v[164:167], a[216:219], a[52:55], v[164:167]
    buffer_load_dwordx4 v3, s[8:11], s67 offen offset:1024 lds
    v_cvt_pk_bf16_f32 v69, v78, v79
    v_mfma_f32_16x16x32_bf16 v[172:175], a[220:223], a[52:55], v[172:175]
    ds_read_b64_tr_b16 a[216:217], v17 offset:43136
    ds_read_b64_tr_b16 a[218:219], v17 offset:43904
    v_mfma_f32_16x16x32_bf16 v[168:171], a[220:223], a[48:51], v[168:171]
    v_cvt_pk_bf16_f32 v85, v94, v95
    v_accvgpr_write_b32 a148, v68
    v_accvgpr_write_b32 a150, v84
    v_mfma_f32_16x16x32_bf16 v[176:179], a[224:227], a[48:51], v[176:179]
    s_waitcnt lgkmcnt(8)
    ds_read_b64_tr_b16 a[220:221], v18 offset:36992
    ds_read_b64_tr_b16 a[222:223], v18 offset:37760
    v_mfma_f32_16x16x32_bf16 v[180:183], a[224:227], a[52:55], v[180:183]
    buffer_load_dwordx4 v4, s[8:11], s67 offen offset:2048 lds
    v_accvgpr_write_b32 a149, v69
    v_mfma_f32_16x16x32_bf16 v[188:191], a[228:231], a[52:55], v[188:191]
    ds_read_b64_tr_b16 a[224:225], v18 offset:43136
    ds_read_b64_tr_b16 a[226:227], v18 offset:43904
    v_mfma_f32_16x16x32_bf16 v[184:187], a[228:231], a[48:51], v[184:187]
    v_accvgpr_write_b32 a151, v85
    v_mul_f32 v104, v96, v104
    v_mul_f32 v120, v112, v120
    v_mfma_f32_16x16x32_bf16 v[192:195], a[232:235], a[48:51], v[192:195]
    ds_read_b64_tr_b16 a[228:229], v17 offset:49152
    ds_read_b64_tr_b16 a[230:231], v17 offset:49920
    v_mfma_f32_16x16x32_bf16 v[196:199], a[232:235], a[52:55], v[196:199]
    v_mul_f32 v105, v97, v105
    v_mul_f32 v121, v113, v121
    v_mfma_f32_16x16x32_bf16 v[204:207], a[236:239], a[52:55], v[204:207]
    s_waitcnt lgkmcnt(8)
    ds_read_b64_tr_b16 a[232:233], v17 offset:55296
    ds_read_b64_tr_b16 a[234:235], v17 offset:56064
    v_mfma_f32_16x16x32_bf16 v[200:203], a[236:239], a[48:51], v[200:203]
    v_mul_f32 v106, v98, v106
    v_mul_f32 v122, v114, v122
    v_mfma_f32_16x16x32_bf16 v[208:211], a[240:243], a[48:51], v[208:211]
    ds_read_b64_tr_b16 a[236:237], v18 offset:49152
    ds_read_b64_tr_b16 a[238:239], v18 offset:49920
    v_mfma_f32_16x16x32_bf16 v[212:215], a[240:243], a[52:55], v[212:215]
    v_mul_f32 v107, v99, v107
    v_mul_f32 v123, v115, v123
    v_mfma_f32_16x16x32_bf16 v[220:223], a[244:247], a[52:55], v[220:223]
    ds_read_b64_tr_b16 a[240:241], v18 offset:55296
    ds_read_b64_tr_b16 a[242:243], v18 offset:56064
    v_mfma_f32_16x16x32_bf16 v[216:219], a[244:247], a[48:51], v[216:219]
    v_mul_f32 v96, s34, v96
    v_mul_f32 v112, s34, v112
    v_mfma_f32_16x16x32_bf16 v[224:227], a[248:251], a[48:51], v[224:227]
    s_waitcnt lgkmcnt(8)
    ds_read_b64_tr_b16 a[244:245], v17 offset:49216
    ds_read_b64_tr_b16 a[246:247], v17 offset:49984
    v_mfma_f32_16x16x32_bf16 v[228:231], a[248:251], a[52:55], v[228:231]
    v_mul_f32 v97, s34, v97
    v_mul_f32 v113, s34, v113
    s_add_u32 m0, s23, 61440
    v_mfma_f32_16x16x32_bf16 v[236:239], a[216:219], a[52:55], v[236:239]
    ds_read_b64_tr_b16 a[248:249], v17 offset:55360
    ds_read_b64_tr_b16 a[250:251], v17 offset:56128
    v_mfma_f32_16x16x32_bf16 v[232:235], a[216:219], a[48:51], v[232:235]
    buffer_load_dwordx4 v5, s[8:11], s67 offen offset:0 lds
    v_mul_f32 v98, s34, v98
    v_mfma_f32_16x16x32_bf16 v[240:243], a[220:223], a[48:51], v[240:243]
    ds_read_b64_tr_b16 a[216:217], v18 offset:49216
    ds_read_b64_tr_b16 a[218:219], v18 offset:49984
    v_mfma_f32_16x16x32_bf16 v[244:247], a[220:223], a[52:55], v[244:247]
    v_mul_f32 v114, s34, v114
    v_mul_f32 v99, s34, v99
    v_mul_f32 v115, s34, v115
    v_mfma_f32_16x16x32_bf16 v[252:255], a[224:227], a[52:55], v[252:255]
    s_waitcnt lgkmcnt(8)
    ds_read_b64_tr_b16 a[220:221], v18 offset:55360
    ds_read_b64_tr_b16 a[222:223], v18 offset:56128
    v_mfma_f32_16x16x32_bf16 v[248:251], a[224:227], a[48:51], v[248:251]
    v_exp_f32 v96, v96
    v_exp_f32 v112, v112
    v_mfma_f32_16x16x32_bf16 v[160:163], a[228:231], a[56:59], v[160:163]
    ds_read_b64_tr_b16 a[224:225], v17 offset:49280
    ds_read_b64_tr_b16 a[226:227], v17 offset:50048
    v_mfma_f32_16x16x32_bf16 v[164:167], a[228:231], a[60:63], v[164:167]
    buffer_load_dwordx4 v6, s[8:11], s67 offen offset:1024 lds
    v_exp_f32 v97, v97
    v_mfma_f32_16x16x32_bf16 v[172:175], a[232:235], a[60:63], v[172:175]
    ds_read_b64_tr_b16 a[228:229], v17 offset:55424
    ds_read_b64_tr_b16 a[230:231], v17 offset:56192
    v_mfma_f32_16x16x32_bf16 v[168:171], a[232:235], a[56:59], v[168:171]
    buffer_load_dwordx4 v7, s[8:11], s67 offen offset:2048 lds
    v_exp_f32 v113, v113
    v_mfma_f32_16x16x32_bf16 v[176:179], a[236:239], a[56:59], v[176:179]
    s_waitcnt lgkmcnt(8)
    ds_read_b64_tr_b16 a[232:233], v18 offset:49280
    ds_read_b64_tr_b16 a[234:235], v18 offset:50048
    v_mfma_f32_16x16x32_bf16 v[180:183], a[236:239], a[60:63], v[180:183]
    v_exp_f32 v98, v98
    v_exp_f32 v114, v114
    v_mfma_f32_16x16x32_bf16 v[188:191], a[240:243], a[60:63], v[188:191]
    s_waitcnt vmcnt(18)
    ds_read_b64_tr_b16 a[236:237], v18 offset:55424
    ds_read_b64_tr_b16 a[238:239], v18 offset:56192
    v_mfma_f32_16x16x32_bf16 v[184:187], a[240:243], a[56:59], v[184:187]
    s_barrier
    v_mfma_f32_16x16x32_bf16 v[192:195], a[244:247], a[56:59], v[192:195]
    ds_read_b64_tr_b16 a[240:241], v17 offset:61440
    ds_read_b64_tr_b16 a[242:243], v17 offset:62208
    v_mfma_f32_16x16x32_bf16 v[196:199], a[244:247], a[60:63], v[196:199]
    v_add_u32 v17, 61440, v17
    v_add_u32 v18, 61440, v18
    v_exp_f32 v99, v99
    v_mfma_f32_16x16x32_bf16 v[204:207], a[248:251], a[60:63], v[204:207]
    s_waitcnt lgkmcnt(8)
    ds_read_b64_tr_b16 a[244:245], v17 offset:6144
    ds_read_b64_tr_b16 a[246:247], v17 offset:6912
    v_mfma_f32_16x16x32_bf16 v[200:203], a[248:251], a[56:59], v[200:203]
    v_exp_f32 v115, v115
    s_add_u32 s72, s71, 128
    s_cmp_eq_u32 s72, s29
    s_cselect_b32 s72, s30, s72
    v_mfma_f32_16x16x32_bf16 v[208:211], a[216:219], a[56:59], v[208:211]
    ds_read_b64_tr_b16 a[248:249], v18 offset:0
    ds_read_b64_tr_b16 a[250:251], v18 offset:768
    v_mfma_f32_16x16x32_bf16 v[212:215], a[216:219], a[60:63], v[212:215]
    v_add_f32 v96, 1.0, v96
    v_add_f32 v112, 1.0, v112
    v_mfma_f32_16x16x32_bf16 v[220:223], a[220:223], a[60:63], v[220:223]
    ds_read_b64_tr_b16 a[216:217], v18 offset:6144
    ds_read_b64_tr_b16 a[218:219], v18 offset:6912
    v_mfma_f32_16x16x32_bf16 v[216:219], a[220:223], a[56:59], v[216:219]
    v_add_f32 v97, 1.0, v97
    v_add_f32 v113, 1.0, v113
    v_mfma_f32_16x16x32_bf16 v[224:227], a[224:227], a[56:59], v[224:227]
    s_waitcnt lgkmcnt(8)
    ds_read_b64_tr_b16 a[220:221], v17 offset:64
    ds_read_b64_tr_b16 a[222:223], v17 offset:832
    v_mfma_f32_16x16x32_bf16 v[228:231], a[224:227], a[60:63], v[228:231]
    v_add_f32 v98, 1.0, v98
    v_add_f32 v114, 1.0, v114
    v_mfma_f32_16x16x32_bf16 v[236:239], a[228:231], a[60:63], v[236:239]
    ds_read_b64_tr_b16 a[224:225], v17 offset:6208
    ds_read_b64_tr_b16 a[226:227], v17 offset:6976
    v_mfma_f32_16x16x32_bf16 v[232:235], a[228:231], a[56:59], v[232:235]
    v_add_f32 v99, 1.0, v99
    v_add_f32 v115, 1.0, v115
    s_add_u32 m0, s23, 73728
    v_mfma_f32_16x16x32_bf16 v[240:243], a[232:235], a[56:59], v[240:243]
    ds_read_b64_tr_b16 a[228:229], v18 offset:64
    ds_read_b64_tr_b16 a[230:231], v18 offset:832
    v_mfma_f32_16x16x32_bf16 v[244:247], a[232:235], a[60:63], v[244:247]
    buffer_load_dwordx4 v2, s[8:11], s68 offen offset:0 lds
    v_rcp_f32 v96, v96
    v_mfma_f32_16x16x32_bf16 v[252:255], a[236:239], a[60:63], v[252:255]
    s_waitcnt lgkmcnt(8)
    ds_read_b64_tr_b16 a[232:233], v18 offset:6208
    ds_read_b64_tr_b16 a[234:235], v18 offset:6976
    v_mfma_f32_16x16x32_bf16 v[248:251], a[236:239], a[56:59], v[248:251]
    v_rcp_f32 v112, v112
    v_mfma_f32_16x16x32_bf16 v[160:163], a[240:243], a[64:67], v[160:163]
    ds_read_b64_tr_b16 a[236:237], v17 offset:128
    ds_read_b64_tr_b16 a[238:239], v17 offset:896
    v_mfma_f32_16x16x32_bf16 v[164:167], a[240:243], a[68:71], v[164:167]
    buffer_load_dwordx4 v3, s[8:11], s68 offen offset:1024 lds
    v_rcp_f32 v97, v97
    v_mfma_f32_16x16x32_bf16 v[172:175], a[244:247], a[68:71], v[172:175]
    ds_read_b64_tr_b16 a[240:241], v17 offset:6272
    ds_read_b64_tr_b16 a[242:243], v17 offset:7040
    v_mfma_f32_16x16x32_bf16 v[168:171], a[244:247], a[64:67], v[168:171]
    v_rcp_f32 v113, v113
    v_mfma_f32_16x16x32_bf16 v[176:179], a[248:251], a[64:67], v[176:179]
    s_waitcnt lgkmcnt(8)
    ds_read_b64_tr_b16 a[244:245], v18 offset:128
    ds_read_b64_tr_b16 a[246:247], v18 offset:896
    v_mfma_f32_16x16x32_bf16 v[180:183], a[248:251], a[68:71], v[180:183]
    buffer_load_dwordx4 v4, s[8:11], s68 offen offset:2048 lds
    v_rcp_f32 v98, v98
    v_mfma_f32_16x16x32_bf16 v[188:191], a[216:219], a[68:71], v[188:191]
    ds_read_b64_tr_b16 a[248:249], v18 offset:6272
    ds_read_b64_tr_b16 a[250:251], v18 offset:7040
    v_mfma_f32_16x16x32_bf16 v[184:187], a[216:219], a[64:67], v[184:187]
    v_rcp_f32 v114, v114
    v_mfma_f32_16x16x32_bf16 v[192:195], a[220:223], a[64:67], v[192:195]
    ds_read_b64_tr_b16 a[216:217], v17 offset:12288
    ds_read_b64_tr_b16 a[218:219], v17 offset:13056
    v_mfma_f32_16x16x32_bf16 v[196:199], a[220:223], a[68:71], v[196:199]
    v_rcp_f32 v99, v99
    v_rcp_f32 v115, v115
    v_mfma_f32_16x16x32_bf16 v[204:207], a[224:227], a[68:71], v[204:207]
    s_waitcnt lgkmcnt(8)
    ds_read_b64_tr_b16 a[220:221], v17 offset:18432
    ds_read_b64_tr_b16 a[222:223], v17 offset:19200
    v_mfma_f32_16x16x32_bf16 v[200:203], a[224:227], a[64:67], v[200:203]
    v_mul_f32 v104, v104, v96
    v_mul_f32 v120, v120, v112
    v_mfma_f32_16x16x32_bf16 v[208:211], a[228:231], a[64:67], v[208:211]
    ds_read_b64_tr_b16 a[224:225], v18 offset:12288
    ds_read_b64_tr_b16 a[226:227], v18 offset:13056
    v_mfma_f32_16x16x32_bf16 v[212:215], a[228:231], a[68:71], v[212:215]
    v_mul_f32 v105, v105, v97
    v_mul_f32 v121, v121, v113
    v_mfma_f32_16x16x32_bf16 v[220:223], a[232:235], a[68:71], v[220:223]
    ds_read_b64_tr_b16 a[228:229], v18 offset:18432
    ds_read_b64_tr_b16 a[230:231], v18 offset:19200
    v_mfma_f32_16x16x32_bf16 v[216:219], a[232:235], a[64:67], v[216:219]
    v_mul_f32 v106, v106, v98
    v_mul_f32 v122, v122, v114
    v_mfma_f32_16x16x32_bf16 v[224:227], a[236:239], a[64:67], v[224:227]
    s_waitcnt lgkmcnt(8)
    ds_read_b64_tr_b16 a[232:233], v17 offset:12352
    ds_read_b64_tr_b16 a[234:235], v17 offset:13120
    v_mfma_f32_16x16x32_bf16 v[228:231], a[236:239], a[68:71], v[228:231]
    s_add_u32 m0, s23, 86016
    v_mul_f32 v107, v107, v99
    v_mfma_f32_16x16x32_bf16 v[236:239], a[240:243], a[68:71], v[236:239]
    ds_read_b64_tr_b16 a[236:237], v17 offset:18496
    ds_read_b64_tr_b16 a[238:239], v17 offset:19264
    v_mfma_f32_16x16x32_bf16 v[232:235], a[240:243], a[64:67], v[232:235]
    buffer_load_dwordx4 v5, s[8:11], s68 offen offset:0 lds
    v_mul_f32 v123, v123, v115
    v_mfma_f32_16x16x32_bf16 v[240:243], a[244:247], a[64:67], v[240:243]
    ds_read_b64_tr_b16 a[240:241], v18 offset:12352
    ds_read_b64_tr_b16 a[242:243], v18 offset:13120
    v_mfma_f32_16x16x32_bf16 v[244:247], a[244:247], a[68:71], v[244:247]
    v_cvt_pk_bf16_f32 v96, v104, v105
    v_cvt_pk_bf16_f32 v112, v120, v121
    s_add_u32 s73, s72, 128
    s_cmp_eq_u32 s73, s29
    s_cselect_b32 s73, s30, s73
    v_mfma_f32_16x16x32_bf16 v[252:255], a[248:251], a[68:71], v[252:255]
    s_waitcnt lgkmcnt(8)
    ds_read_b64_tr_b16 a[244:245], v18 offset:18496
    ds_read_b64_tr_b16 a[246:247], v18 offset:19264
    v_mfma_f32_16x16x32_bf16 v[248:251], a[248:251], a[64:67], v[248:251]
    buffer_load_dwordx4 v6, s[8:11], s68 offen offset:1024 lds
    v_cvt_pk_bf16_f32 v97, v106, v107
    v_mfma_f32_16x16x32_bf16 v[160:163], a[216:219], a[72:75], v[160:163]
    ds_read_b64_tr_b16 a[248:249], v17 offset:12416
    ds_read_b64_tr_b16 a[250:251], v17 offset:13184
    v_mfma_f32_16x16x32_bf16 v[164:167], a[216:219], a[76:79], v[164:167]
    v_cvt_pk_bf16_f32 v113, v122, v123
    v_accvgpr_write_b32 a152, v96
    v_accvgpr_write_b32 a154, v112
    v_mfma_f32_16x16x32_bf16 v[172:175], a[220:223], a[76:79], v[172:175]
    ds_read_b64_tr_b16 a[216:217], v17 offset:18560
    ds_read_b64_tr_b16 a[218:219], v17 offset:19328
    v_mfma_f32_16x16x32_bf16 v[168:171], a[220:223], a[72:75], v[168:171]
    buffer_load_dwordx4 v7, s[8:11], s68 offen offset:2048 lds
    v_accvgpr_write_b32 a153, v97
    v_mfma_f32_16x16x32_bf16 v[176:179], a[224:227], a[72:75], v[176:179]
    s_waitcnt lgkmcnt(8)
    ds_read_b64_tr_b16 a[220:221], v18 offset:12416
    ds_read_b64_tr_b16 a[222:223], v18 offset:13184
    v_mfma_f32_16x16x32_bf16 v[180:183], a[224:227], a[76:79], v[180:183]
    v_accvgpr_write_b32 a155, v113
    v_mul_f32 v108, v100, v108
    v_mul_f32 v124, v116, v124
    v_mfma_f32_16x16x32_bf16 v[188:191], a[228:231], a[76:79], v[188:191]
    s_waitcnt vmcnt(18)
    ds_read_b64_tr_b16 a[224:225], v18 offset:18560
    ds_read_b64_tr_b16 a[226:227], v18 offset:19328
    v_mfma_f32_16x16x32_bf16 v[184:187], a[228:231], a[72:75], v[184:187]
    s_barrier
    v_subrev_u32 v17, 122880, v17
    v_subrev_u32 v18, 122880, v18
    v_mfma_f32_16x16x32_bf16 v[192:195], a[232:235], a[72:75], v[192:195]
    ds_read_b64_tr_b16 a[228:229], v17 offset:0
    ds_read_b64_tr_b16 a[230:231], v17 offset:768
    v_mfma_f32_16x16x32_bf16 v[196:199], a[232:235], a[76:79], v[196:199]
    v_mul_f32 v109, v101, v109
    v_mul_f32 v125, v117, v125
    v_mul_f32 v110, v102, v110
    v_mfma_f32_16x16x32_bf16 v[204:207], a[236:239], a[76:79], v[204:207]
    s_waitcnt lgkmcnt(8)
    ds_read_b64_tr_b16 a[232:233], v17 offset:6144
    ds_read_b64_tr_b16 a[234:235], v17 offset:6912
    v_mfma_f32_16x16x32_bf16 v[200:203], a[236:239], a[72:75], v[200:203]
    v_mul_f32 v126, v118, v126
    v_mul_f32 v111, v103, v111
    v_mul_f32 v127, v119, v127
    v_mfma_f32_16x16x32_bf16 v[208:211], a[240:243], a[72:75], v[208:211]
    ds_read_b64_tr_b16 a[236:237], v18 offset:0
    ds_read_b64_tr_b16 a[238:239], v18 offset:768
    v_mfma_f32_16x16x32_bf16 v[212:215], a[240:243], a[76:79], v[212:215]
    v_mul_f32 v100, s34, v100
    v_mul_f32 v116, s34, v116
    s_cmp_eq_u32 s3, 1
    s_cselect_b32 s35, -2, 1
    s_mul_i32 s35, s35, 192
    v_mfma_f32_16x16x32_bf16 v[220:223], a[244:247], a[76:79], v[220:223]
    ds_read_b64_tr_b16 a[240:241], v18 offset:6144
    ds_read_b64_tr_b16 a[242:243], v18 offset:6912
    v_mfma_f32_16x16x32_bf16 v[216:219], a[244:247], a[72:75], v[216:219]
    v_mul_f32 v101, s34, v101
    v_mul_f32 v117, s34, v117
    v_mul_f32 v102, s34, v102
    v_mfma_f32_16x16x32_bf16 v[224:227], a[248:251], a[72:75], v[224:227]
    s_waitcnt lgkmcnt(8)
    ds_read_b64_tr_b16 a[244:245], v17 offset:64
    ds_read_b64_tr_b16 a[246:247], v17 offset:832
    v_mfma_f32_16x16x32_bf16 v[228:231], a[248:251], a[76:79], v[228:231]
    v_mul_f32 v118, s34, v118
    s_add_u32 s60, s60, s35
    v_mul_f32 v103, s34, v103
    v_mfma_f32_16x16x32_bf16 v[236:239], a[216:219], a[76:79], v[236:239]
    ds_read_b64_tr_b16 a[248:249], v17 offset:6208
    ds_read_b64_tr_b16 a[250:251], v17 offset:6976
    v_mfma_f32_16x16x32_bf16 v[232:235], a[216:219], a[72:75], v[232:235]
    s_add_u32 s61, s61, s35
    v_mul_f32 v119, s34, v119
    s_add_u32 s62, s62, s35
    v_mfma_f32_16x16x32_bf16 v[240:243], a[220:223], a[72:75], v[240:243]
    ds_read_b64_tr_b16 a[216:217], v18 offset:64
    ds_read_b64_tr_b16 a[218:219], v18 offset:832
    v_mfma_f32_16x16x32_bf16 v[244:247], a[220:223], a[76:79], v[244:247]
    v_exp_f32 v100, v100
    v_exp_f32 v116, v116
    v_mfma_f32_16x16x32_bf16 v[252:255], a[224:227], a[76:79], v[252:255]
    s_waitcnt lgkmcnt(8)
    ds_read_b64_tr_b16 a[220:221], v18 offset:6208
    ds_read_b64_tr_b16 a[222:223], v18 offset:6976
    v_mfma_f32_16x16x32_bf16 v[248:251], a[224:227], a[72:75], v[248:251]
    s_add_u32 s63, s63, s35
    s_add_u32 s64, s64, s35
    s_add_u32 s65, s65, s35
    v_mfma_f32_16x16x32_bf16 v[160:163], a[228:231], a[80:83], v[160:163]
    ds_read_b64_tr_b16 a[224:225], v17 offset:128
    ds_read_b64_tr_b16 a[226:227], v17 offset:896
    v_mfma_f32_16x16x32_bf16 v[164:167], a[228:231], a[84:87], v[164:167]
    s_add_u32 s66, s66, s35
    s_add_u32 s67, s67, s35
    v_exp_f32 v101, v101
    v_mfma_f32_16x16x32_bf16 v[172:175], a[232:235], a[84:87], v[172:175]
    ds_read_b64_tr_b16 a[228:229], v17 offset:6272
    ds_read_b64_tr_b16 a[230:231], v17 offset:7040
    v_mfma_f32_16x16x32_bf16 v[168:171], a[232:235], a[80:83], v[168:171]
    v_exp_f32 v117, v117
    s_add_u32 s68, s68, s35
    v_mfma_f32_16x16x32_bf16 v[176:179], a[236:239], a[80:83], v[176:179]
    s_waitcnt lgkmcnt(8)
    ds_read_b64_tr_b16 a[232:233], v18 offset:128
    ds_read_b64_tr_b16 a[234:235], v18 offset:896
    v_mfma_f32_16x16x32_bf16 v[180:183], a[236:239], a[84:87], v[180:183]
    s_add_u32 m0, s23, 98304
    v_exp_f32 v102, v102
    v_mfma_f32_16x16x32_bf16 v[188:191], a[240:243], a[84:87], v[188:191]
    ds_read_b64_tr_b16 a[236:237], v18 offset:6272
    ds_read_b64_tr_b16 a[238:239], v18 offset:7040
    v_mfma_f32_16x16x32_bf16 v[184:187], a[240:243], a[80:83], v[184:187]
    buffer_load_dwordx4 v2, s[8:11], s60 offen offset:0 lds
    v_exp_f32 v118, v118
    v_mfma_f32_16x16x32_bf16 v[192:195], a[244:247], a[80:83], v[192:195]
    ds_read_b64_tr_b16 a[240:241], v17 offset:12288
    ds_read_b64_tr_b16 a[242:243], v17 offset:13056
    v_mfma_f32_16x16x32_bf16 v[196:199], a[244:247], a[84:87], v[196:199]
    buffer_load_dwordx4 v3, s[8:11], s60 offen offset:1024 lds
    v_exp_f32 v103, v103
    v_mfma_f32_16x16x32_bf16 v[204:207], a[248:251], a[84:87], v[204:207]
    s_waitcnt lgkmcnt(8)
    ds_read_b64_tr_b16 a[244:245], v17 offset:18432
    ds_read_b64_tr_b16 a[246:247], v17 offset:19200
    v_mfma_f32_16x16x32_bf16 v[200:203], a[248:251], a[80:83], v[200:203]
    buffer_load_dwordx4 v4, s[8:11], s60 offen offset:2048 lds
    v_exp_f32 v119, v119
    v_mfma_f32_16x16x32_bf16 v[208:211], a[216:219], a[80:83], v[208:211]
    ds_read_b64_tr_b16 a[248:249], v18 offset:12288
    ds_read_b64_tr_b16 a[250:251], v18 offset:13056
    v_mfma_f32_16x16x32_bf16 v[212:215], a[216:219], a[84:87], v[212:215]
    v_add_f32 v100, 1.0, v100
    v_add_f32 v116, 1.0, v116
    v_add_f32 v101, 1.0, v101
    v_mfma_f32_16x16x32_bf16 v[220:223], a[220:223], a[84:87], v[220:223]
    ds_read_b64_tr_b16 a[216:217], v18 offset:18432
    ds_read_b64_tr_b16 a[218:219], v18 offset:19200
    v_mfma_f32_16x16x32_bf16 v[216:219], a[220:223], a[80:83], v[216:219]
    v_add_f32 v117, 1.0, v117
    v_add_f32 v102, 1.0, v102
    v_add_f32 v118, 1.0, v118
    v_mfma_f32_16x16x32_bf16 v[224:227], a[224:227], a[80:83], v[224:227]
    s_waitcnt lgkmcnt(8)
    ds_read_b64_tr_b16 a[220:221], v17 offset:12352
    ds_read_b64_tr_b16 a[222:223], v17 offset:13120
    v_mfma_f32_16x16x32_bf16 v[228:231], a[224:227], a[84:87], v[228:231]
    v_add_f32 v103, 1.0, v103
    v_add_f32 v119, 1.0, v119
    s_add_u32 s74, s73, 128
    s_cmp_eq_u32 s74, s29
    s_cselect_b32 s74, s30, s74
    v_mfma_f32_16x16x32_bf16 v[236:239], a[228:231], a[84:87], v[236:239]
    ds_read_b64_tr_b16 a[224:225], v17 offset:18496
    ds_read_b64_tr_b16 a[226:227], v17 offset:19264
    v_mfma_f32_16x16x32_bf16 v[232:235], a[228:231], a[80:83], v[232:235]
    v_rcp_f32 v100, v100
    v_rcp_f32 v116, v116
    v_mfma_f32_16x16x32_bf16 v[240:243], a[232:235], a[80:83], v[240:243]
    ds_read_b64_tr_b16 a[228:229], v18 offset:12352
    ds_read_b64_tr_b16 a[230:231], v18 offset:13120
    v_mfma_f32_16x16x32_bf16 v[244:247], a[232:235], a[84:87], v[244:247]
    s_add_u32 m0, s23, 110592
    v_mfma_f32_16x16x32_bf16 v[252:255], a[236:239], a[84:87], v[252:255]
    s_waitcnt lgkmcnt(8)
    ds_read_b64_tr_b16 a[232:233], v18 offset:18496
    ds_read_b64_tr_b16 a[234:235], v18 offset:19264
    v_mfma_f32_16x16x32_bf16 v[248:251], a[236:239], a[80:83], v[248:251]
    buffer_load_dwordx4 v5, s[8:11], s60 offen offset:0 lds
    v_rcp_f32 v101, v101
    v_mfma_f32_16x16x32_bf16 v[160:163], a[240:243], a[88:91], v[160:163]
    ds_read_b64_tr_b16 a[236:237], v17 offset:12416
    ds_read_b64_tr_b16 a[238:239], v17 offset:13184
    v_mfma_f32_16x16x32_bf16 v[164:167], a[240:243], a[92:95], v[164:167]
    v_rcp_f32 v117, v117
    v_rcp_f32 v102, v102
    v_mfma_f32_16x16x32_bf16 v[172:175], a[244:247], a[92:95], v[172:175]
    ds_read_b64_tr_b16 a[240:241], v17 offset:18560
    ds_read_b64_tr_b16 a[242:243], v17 offset:19328
    v_mfma_f32_16x16x32_bf16 v[168:171], a[244:247], a[88:91], v[168:171]
    buffer_load_dwordx4 v6, s[8:11], s60 offen offset:1024 lds
    v_rcp_f32 v118, v118
    v_mfma_f32_16x16x32_bf16 v[176:179], a[248:251], a[88:91], v[176:179]
    s_waitcnt lgkmcnt(8)
    ds_read_b64_tr_b16 a[244:245], v18 offset:12416
    ds_read_b64_tr_b16 a[246:247], v18 offset:13184
    v_mfma_f32_16x16x32_bf16 v[180:183], a[248:251], a[92:95], v[180:183]
    buffer_load_dwordx4 v7, s[8:11], s60 offen offset:2048 lds
    v_rcp_f32 v103, v103
    v_mfma_f32_16x16x32_bf16 v[188:191], a[216:219], a[92:95], v[188:191]
    s_waitcnt vmcnt(18)
    ds_read_b64_tr_b16 a[248:249], v18 offset:18560
    ds_read_b64_tr_b16 a[250:251], v18 offset:19328
    v_mfma_f32_16x16x32_bf16 v[184:187], a[216:219], a[88:91], v[184:187]
    s_barrier
    v_mfma_f32_16x16x32_bf16 v[192:195], a[220:223], a[88:91], v[192:195]
    ds_read_b64_tr_b16 a[216:217], v17 offset:24576
    ds_read_b64_tr_b16 a[218:219], v17 offset:25344
    v_mfma_f32_16x16x32_bf16 v[196:199], a[220:223], a[92:95], v[196:199]
    v_rcp_f32 v119, v119
    v_mul_f32 v108, v108, v100
    v_mfma_f32_16x16x32_bf16 v[204:207], a[224:227], a[92:95], v[204:207]
    s_waitcnt lgkmcnt(8)
    ds_read_b64_tr_b16 a[220:221], v17 offset:30720
    ds_read_b64_tr_b16 a[222:223], v17 offset:31488
    v_mfma_f32_16x16x32_bf16 v[200:203], a[224:227], a[88:91], v[200:203]
    v_mul_f32 v124, v124, v116
    v_mul_f32 v109, v109, v101
    v_mul_f32 v125, v125, v117
    v_mfma_f32_16x16x32_bf16 v[208:211], a[228:231], a[88:91], v[208:211]
    ds_read_b64_tr_b16 a[224:225], v18 offset:24576
    ds_read_b64_tr_b16 a[226:227], v18 offset:25344
    v_mfma_f32_16x16x32_bf16 v[212:215], a[228:231], a[92:95], v[212:215]
    v_mul_f32 v110, v110, v102
    v_mul_f32 v126, v126, v118
    v_mfma_f32_16x16x32_bf16 v[220:223], a[232:235], a[92:95], v[220:223]
    ds_read_b64_tr_b16 a[228:229], v18 offset:30720
    ds_read_b64_tr_b16 a[230:231], v18 offset:31488
    v_mfma_f32_16x16x32_bf16 v[216:219], a[232:235], a[88:91], v[216:219]
    v_mul_f32 v111, v111, v103
    v_mul_f32 v127, v127, v119
    v_mfma_f32_16x16x32_bf16 v[224:227], a[236:239], a[88:91], v[224:227]
    s_waitcnt lgkmcnt(8)
    ds_read_b64_tr_b16 a[232:233], v17 offset:24640
    ds_read_b64_tr_b16 a[234:235], v17 offset:25408
    v_mfma_f32_16x16x32_bf16 v[228:231], a[236:239], a[92:95], v[228:231]
    v_cvt_pk_bf16_f32 v100, v108, v109
    v_cvt_pk_bf16_f32 v116, v124, v125
    v_mfma_f32_16x16x32_bf16 v[236:239], a[240:243], a[92:95], v[236:239]
    ds_read_b64_tr_b16 a[236:237], v17 offset:30784
    ds_read_b64_tr_b16 a[238:239], v17 offset:31552
    v_mfma_f32_16x16x32_bf16 v[232:235], a[240:243], a[88:91], v[232:235]
    v_cvt_pk_bf16_f32 v101, v110, v111
    v_cvt_pk_bf16_f32 v117, v126, v127
    s_add_u32 m0, s23, 122880
    v_mfma_f32_16x16x32_bf16 v[240:243], a[244:247], a[88:91], v[240:243]
    ds_read_b64_tr_b16 a[240:241], v18 offset:24640
    ds_read_b64_tr_b16 a[242:243], v18 offset:25408
    v_mfma_f32_16x16x32_bf16 v[244:247], a[244:247], a[92:95], v[244:247]
    buffer_load_dwordx4 v2, s[8:11], s61 offen offset:0 lds
    v_accvgpr_write_b32 a156, v100
    v_mfma_f32_16x16x32_bf16 v[252:255], a[248:251], a[92:95], v[252:255]
    s_waitcnt lgkmcnt(8)
    ds_read_b64_tr_b16 a[244:245], v18 offset:30784
    ds_read_b64_tr_b16 a[246:247], v18 offset:31552
    v_mfma_f32_16x16x32_bf16 v[248:251], a[248:251], a[88:91], v[248:251]
    v_accvgpr_write_b32 a158, v116
    v_accvgpr_write_b32 a157, v101
    v_accvgpr_write_b32 a159, v117
    v_mfma_f32_16x16x32_bf16 v[160:163], a[216:219], a[96:99], v[160:163]
    ds_read_b64_tr_b16 a[248:249], v17 offset:24704
    ds_read_b64_tr_b16 a[250:251], v17 offset:25472
    v_mfma_f32_16x16x32_bf16 v[164:167], a[216:219], a[100:103], v[164:167]
    buffer_load_dwordx4 v3, s[8:11], s61 offen offset:1024 lds
    v_mul_f32 v136, v128, v136
    v_mfma_f32_16x16x32_bf16 v[172:175], a[220:223], a[100:103], v[172:175]
    ds_read_b64_tr_b16 a[216:217], v17 offset:30848
    ds_read_b64_tr_b16 a[218:219], v17 offset:31616
    v_mfma_f32_16x16x32_bf16 v[168:171], a[220:223], a[96:99], v[168:171]
    v_mul_f32 v152, v144, v152
    v_mul_f32 v137, v129, v137
    v_mul_f32 v153, v145, v153
    v_mfma_f32_16x16x32_bf16 v[176:179], a[224:227], a[96:99], v[176:179]
    s_waitcnt lgkmcnt(8)
    ds_read_b64_tr_b16 a[220:221], v18 offset:24704
    ds_read_b64_tr_b16 a[222:223], v18 offset:25472
    v_mfma_f32_16x16x32_bf16 v[180:183], a[224:227], a[100:103], v[180:183]
    buffer_load_dwordx4 v4, s[8:11], s61 offen offset:2048 lds
    v_mul_f32 v138, v130, v138
    v_mfma_f32_16x16x32_bf16 v[188:191], a[228:231], a[100:103], v[188:191]
    ds_read_b64_tr_b16 a[224:225], v18 offset:30848
    ds_read_b64_tr_b16 a[226:227], v18 offset:31616
    v_mfma_f32_16x16x32_bf16 v[184:187], a[228:231], a[96:99], v[184:187]
    v_mul_f32 v154, v146, v154
    v_mul_f32 v139, v131, v139
    v_mul_f32 v155, v147, v155
    v_mfma_f32_16x16x32_bf16 v[192:195], a[232:235], a[96:99], v[192:195]
    ds_read_b64_tr_b16 a[228:229], v17 offset:36864
    ds_read_b64_tr_b16 a[230:231], v17 offset:37632
    v_mfma_f32_16x16x32_bf16 v[196:199], a[232:235], a[100:103], v[196:199]
    v_mul_f32 v128, s34, v128
    v_mul_f32 v144, s34, v144
    s_add_u32 s75, s74, 128
    s_cmp_eq_u32 s75, s29
    s_cselect_b32 s75, s30, s75
    v_mfma_f32_16x16x32_bf16 v[204:207], a[236:239], a[100:103], v[204:207]
    s_waitcnt lgkmcnt(8)
    ds_read_b64_tr_b16 a[232:233], v17 offset:43008
    ds_read_b64_tr_b16 a[234:235], v17 offset:43776
    v_mfma_f32_16x16x32_bf16 v[200:203], a[236:239], a[96:99], v[200:203]
    v_mul_f32 v129, s34, v129
    v_mul_f32 v145, s34, v145
    v_mfma_f32_16x16x32_bf16 v[208:211], a[240:243], a[96:99], v[208:211]
    ds_read_b64_tr_b16 a[236:237], v18 offset:36864
    ds_read_b64_tr_b16 a[238:239], v18 offset:37632
    v_mfma_f32_16x16x32_bf16 v[212:215], a[240:243], a[100:103], v[212:215]
    v_mul_f32 v130, s34, v130
    v_mul_f32 v146, s34, v146
    v_mfma_f32_16x16x32_bf16 v[220:223], a[244:247], a[100:103], v[220:223]
    ds_read_b64_tr_b16 a[240:241], v18 offset:43008
    ds_read_b64_tr_b16 a[242:243], v18 offset:43776
    v_mfma_f32_16x16x32_bf16 v[216:219], a[244:247], a[96:99], v[216:219]
    v_mul_f32 v131, s34, v131
    v_mul_f32 v147, s34, v147
    v_mfma_f32_16x16x32_bf16 v[224:227], a[248:251], a[96:99], v[224:227]
    s_waitcnt lgkmcnt(8)
    ds_read_b64_tr_b16 a[244:245], v17 offset:36928
    ds_read_b64_tr_b16 a[246:247], v17 offset:37696
    v_mfma_f32_16x16x32_bf16 v[228:231], a[248:251], a[100:103], v[228:231]
    v_exp_f32 v128, v128
    v_exp_f32 v144, v144
    v_mfma_f32_16x16x32_bf16 v[236:239], a[216:219], a[100:103], v[236:239]
    ds_read_b64_tr_b16 a[248:249], v17 offset:43072
    ds_read_b64_tr_b16 a[250:251], v17 offset:43840
    v_mfma_f32_16x16x32_bf16 v[232:235], a[216:219], a[96:99], v[232:235]
    s_add_u32 m0, s23, 135168
    v_mfma_f32_16x16x32_bf16 v[240:243], a[220:223], a[96:99], v[240:243]
    ds_read_b64_tr_b16 a[216:217], v18 offset:36928
    ds_read_b64_tr_b16 a[218:219], v18 offset:37696
    v_mfma_f32_16x16x32_bf16 v[244:247], a[220:223], a[100:103], v[244:247]
    buffer_load_dwordx4 v5, s[8:11], s61 offen offset:0 lds
    v_exp_f32 v129, v129
    v_mfma_f32_16x16x32_bf16 v[252:255], a[224:227], a[100:103], v[252:255]
    s_waitcnt lgkmcnt(8)
    ds_read_b64_tr_b16 a[220:221], v18 offset:43072
    ds_read_b64_tr_b16 a[222:223], v18 offset:43840
    v_mfma_f32_16x16x32_bf16 v[248:251], a[224:227], a[96:99], v[248:251]
    v_exp_f32 v145, v145
    v_mfma_f32_16x16x32_bf16 v[160:163], a[228:231], a[104:107], v[160:163]
    ds_read_b64_tr_b16 a[224:225], v17 offset:36992
    ds_read_b64_tr_b16 a[226:227], v17 offset:37760
    v_mfma_f32_16x16x32_bf16 v[164:167], a[228:231], a[108:111], v[164:167]
    buffer_load_dwordx4 v6, s[8:11], s61 offen offset:1024 lds
    v_exp_f32 v130, v130
    v_mfma_f32_16x16x32_bf16 v[172:175], a[232:235], a[108:111], v[172:175]
    ds_read_b64_tr_b16 a[228:229], v17 offset:43136
    ds_read_b64_tr_b16 a[230:231], v17 offset:43904
    v_mfma_f32_16x16x32_bf16 v[168:171], a[232:235], a[104:107], v[168:171]
    buffer_load_dwordx4 v7, s[8:11], s61 offen offset:2048 lds
    v_exp_f32 v146, v146
    v_mfma_f32_16x16x32_bf16 v[176:179], a[236:239], a[104:107], v[176:179]
    s_waitcnt lgkmcnt(8)
    ds_read_b64_tr_b16 a[232:233], v18 offset:36992
    ds_read_b64_tr_b16 a[234:235], v18 offset:37760
    v_mfma_f32_16x16x32_bf16 v[180:183], a[236:239], a[108:111], v[180:183]
    v_exp_f32 v131, v131
    v_exp_f32 v147, v147
    v_mfma_f32_16x16x32_bf16 v[188:191], a[240:243], a[108:111], v[188:191]
    s_waitcnt vmcnt(18)
    ds_read_b64_tr_b16 a[236:237], v18 offset:43136
    ds_read_b64_tr_b16 a[238:239], v18 offset:43904
    v_mfma_f32_16x16x32_bf16 v[184:187], a[240:243], a[104:107], v[184:187]
    s_barrier
    v_mfma_f32_16x16x32_bf16 v[192:195], a[244:247], a[104:107], v[192:195]
    ds_read_b64_tr_b16 a[240:241], v17 offset:49152
    ds_read_b64_tr_b16 a[242:243], v17 offset:49920
    v_mfma_f32_16x16x32_bf16 v[196:199], a[244:247], a[108:111], v[196:199]
    v_add_f32 v128, 1.0, v128
    v_add_f32 v144, 1.0, v144
    v_add_f32 v129, 1.0, v129
    v_mfma_f32_16x16x32_bf16 v[204:207], a[248:251], a[108:111], v[204:207]
    s_waitcnt lgkmcnt(8)
    ds_read_b64_tr_b16 a[244:245], v17 offset:55296
    ds_read_b64_tr_b16 a[246:247], v17 offset:56064
    v_mfma_f32_16x16x32_bf16 v[200:203], a[248:251], a[104:107], v[200:203]
    v_add_f32 v145, 1.0, v145
    v_add_f32 v130, 1.0, v130
    v_add_f32 v146, 1.0, v146
    v_mfma_f32_16x16x32_bf16 v[208:211], a[216:219], a[104:107], v[208:211]
    ds_read_b64_tr_b16 a[248:249], v18 offset:49152
    ds_read_b64_tr_b16 a[250:251], v18 offset:49920
    v_mfma_f32_16x16x32_bf16 v[212:215], a[216:219], a[108:111], v[212:215]
    v_add_f32 v131, 1.0, v131
    v_add_f32 v147, 1.0, v147
    v_mfma_f32_16x16x32_bf16 v[220:223], a[220:223], a[108:111], v[220:223]
    ds_read_b64_tr_b16 a[216:217], v18 offset:55296
    ds_read_b64_tr_b16 a[218:219], v18 offset:56064
    v_mfma_f32_16x16x32_bf16 v[216:219], a[220:223], a[104:107], v[216:219]
    v_rcp_f32 v128, v128
    v_rcp_f32 v144, v144
    v_mfma_f32_16x16x32_bf16 v[224:227], a[224:227], a[104:107], v[224:227]
    s_waitcnt lgkmcnt(8)
    ds_read_b64_tr_b16 a[220:221], v17 offset:49216
    ds_read_b64_tr_b16 a[222:223], v17 offset:49984
    v_mfma_f32_16x16x32_bf16 v[228:231], a[224:227], a[108:111], v[228:231]
    s_add_u32 m0, s23, 0
    s_add_u32 s76, s75, 128
    s_cmp_eq_u32 s76, s29
    s_cselect_b32 s76, s30, s76
    v_mfma_f32_16x16x32_bf16 v[236:239], a[228:231], a[108:111], v[236:239]
    ds_read_b64_tr_b16 a[224:225], v17 offset:55360
    ds_read_b64_tr_b16 a[226:227], v17 offset:56128
    v_mfma_f32_16x16x32_bf16 v[232:235], a[228:231], a[104:107], v[232:235]
    buffer_load_dwordx4 v2, s[8:11], s62 offen offset:0 lds
    v_rcp_f32 v129, v129
    v_mfma_f32_16x16x32_bf16 v[240:243], a[232:235], a[104:107], v[240:243]
    ds_read_b64_tr_b16 a[228:229], v18 offset:49216
    ds_read_b64_tr_b16 a[230:231], v18 offset:49984
    v_mfma_f32_16x16x32_bf16 v[244:247], a[232:235], a[108:111], v[244:247]
    v_rcp_f32 v145, v145
    v_mfma_f32_16x16x32_bf16 v[252:255], a[236:239], a[108:111], v[252:255]
    s_waitcnt lgkmcnt(8)
    ds_read_b64_tr_b16 a[232:233], v18 offset:55360
    ds_read_b64_tr_b16 a[234:235], v18 offset:56128
    v_mfma_f32_16x16x32_bf16 v[248:251], a[236:239], a[104:107], v[248:251]
    buffer_load_dwordx4 v3, s[8:11], s62 offen offset:1024 lds
    v_rcp_f32 v130, v130
    v_mfma_f32_16x16x32_bf16 v[160:163], a[240:243], a[112:115], v[160:163]
    ds_read_b64_tr_b16 a[236:237], v17 offset:49280
    ds_read_b64_tr_b16 a[238:239], v17 offset:50048
    v_mfma_f32_16x16x32_bf16 v[164:167], a[240:243], a[116:119], v[164:167]
    v_rcp_f32 v146, v146
    v_mfma_f32_16x16x32_bf16 v[172:175], a[244:247], a[116:119], v[172:175]
    ds_read_b64_tr_b16 a[240:241], v17 offset:55424
    ds_read_b64_tr_b16 a[242:243], v17 offset:56192
    v_mfma_f32_16x16x32_bf16 v[168:171], a[244:247], a[112:115], v[168:171]
    v_rcp_f32 v131, v131
    v_rcp_f32 v147, v147
    v_mfma_f32_16x16x32_bf16 v[176:179], a[248:251], a[112:115], v[176:179]
    s_waitcnt lgkmcnt(8)
    ds_read_b64_tr_b16 a[244:245], v18 offset:49280
    ds_read_b64_tr_b16 a[246:247], v18 offset:50048
    v_mfma_f32_16x16x32_bf16 v[180:183], a[248:251], a[116:119], v[180:183]
    buffer_load_dwordx4 v4, s[8:11], s62 offen offset:2048 lds
    v_mfma_f32_16x16x32_bf16 v[188:191], a[216:219], a[116:119], v[188:191]
    ds_read_b64_tr_b16 a[248:249], v18 offset:55424
    ds_read_b64_tr_b16 a[250:251], v18 offset:56192
    v_mfma_f32_16x16x32_bf16 v[184:187], a[216:219], a[112:115], v[184:187]
    v_mul_f32 v136, v136, v128
    v_mul_f32 v152, v152, v144
    v_mfma_f32_16x16x32_bf16 v[192:195], a[220:223], a[112:115], v[192:195]
    ds_read_b64_tr_b16 a[216:217], v17 offset:61440
    ds_read_b64_tr_b16 a[218:219], v17 offset:62208
    v_mfma_f32_16x16x32_bf16 v[196:199], a[220:223], a[116:119], v[196:199]
    v_add_u32 v17, 61440, v17
    v_add_u32 v18, 61440, v18
    v_mul_f32 v137, v137, v129
    v_mfma_f32_16x16x32_bf16 v[204:207], a[224:227], a[116:119], v[204:207]
    s_waitcnt lgkmcnt(8)
    ds_read_b64_tr_b16 a[220:221], v17 offset:6144
    ds_read_b64_tr_b16 a[222:223], v17 offset:6912
    v_mfma_f32_16x16x32_bf16 v[200:203], a[224:227], a[112:115], v[200:203]
    v_mul_f32 v153, v153, v145
    v_mul_f32 v138, v138, v130
    v_mul_f32 v154, v154, v146
    v_mfma_f32_16x16x32_bf16 v[208:211], a[228:231], a[112:115], v[208:211]
    ds_read_b64_tr_b16 a[224:225], v18 offset:0
    ds_read_b64_tr_b16 a[226:227], v18 offset:768
    v_mfma_f32_16x16x32_bf16 v[212:215], a[228:231], a[116:119], v[212:215]
    v_mul_f32 v139, v139, v131
    v_mul_f32 v155, v155, v147
    v_mfma_f32_16x16x32_bf16 v[220:223], a[232:235], a[116:119], v[220:223]
    ds_read_b64_tr_b16 a[228:229], v18 offset:6144
    ds_read_b64_tr_b16 a[230:231], v18 offset:6912
    v_mfma_f32_16x16x32_bf16 v[216:219], a[232:235], a[112:115], v[216:219]
    v_cvt_pk_bf16_f32 v128, v136, v137
    v_cvt_pk_bf16_f32 v144, v152, v153
    v_mfma_f32_16x16x32_bf16 v[224:227], a[236:239], a[112:115], v[224:227]
    s_waitcnt lgkmcnt(8)
    ds_read_b64_tr_b16 a[232:233], v17 offset:64
    ds_read_b64_tr_b16 a[234:235], v17 offset:832
    v_mfma_f32_16x16x32_bf16 v[228:231], a[236:239], a[116:119], v[228:231]
    v_cvt_pk_bf16_f32 v129, v138, v139
    v_cvt_pk_bf16_f32 v145, v154, v155
    s_add_u32 m0, s23, 12288
    v_mfma_f32_16x16x32_bf16 v[236:239], a[240:243], a[116:119], v[236:239]
    ds_read_b64_tr_b16 a[236:237], v17 offset:6208
    ds_read_b64_tr_b16 a[238:239], v17 offset:6976
    v_mfma_f32_16x16x32_bf16 v[232:235], a[240:243], a[112:115], v[232:235]
    buffer_load_dwordx4 v5, s[8:11], s62 offen offset:0 lds
    v_accvgpr_write_b32 a160, v128
    v_mfma_f32_16x16x32_bf16 v[240:243], a[244:247], a[112:115], v[240:243]
    ds_read_b64_tr_b16 a[240:241], v18 offset:64
    ds_read_b64_tr_b16 a[242:243], v18 offset:832
    v_mfma_f32_16x16x32_bf16 v[244:247], a[244:247], a[116:119], v[244:247]
    v_accvgpr_write_b32 a162, v144
    v_accvgpr_write_b32 a161, v129
    v_accvgpr_write_b32 a163, v145
    v_mfma_f32_16x16x32_bf16 v[252:255], a[248:251], a[116:119], v[252:255]
    s_waitcnt lgkmcnt(8)
    ds_read_b64_tr_b16 a[244:245], v18 offset:6208
    ds_read_b64_tr_b16 a[246:247], v18 offset:6976
    v_mfma_f32_16x16x32_bf16 v[248:251], a[248:251], a[112:115], v[248:251]
    buffer_load_dwordx4 v6, s[8:11], s62 offen offset:1024 lds
    v_mul_f32 v140, v132, v140
    v_mfma_f32_16x16x32_bf16 v[160:163], a[216:219], a[120:123], v[160:163]
    ds_read_b64_tr_b16 a[248:249], v17 offset:128
    ds_read_b64_tr_b16 a[250:251], v17 offset:896
    v_mfma_f32_16x16x32_bf16 v[164:167], a[216:219], a[124:127], v[164:167]
    v_mul_f32 v156, v148, v156
    v_mul_f32 v141, v133, v141
    v_mul_f32 v157, v149, v157
    v_mfma_f32_16x16x32_bf16 v[172:175], a[220:223], a[124:127], v[172:175]
    ds_read_b64_tr_b16 a[216:217], v17 offset:6272
    ds_read_b64_tr_b16 a[218:219], v17 offset:7040
    v_mfma_f32_16x16x32_bf16 v[168:171], a[220:223], a[120:123], v[168:171]
    buffer_load_dwordx4 v7, s[8:11], s62 offen offset:2048 lds
    v_mul_f32 v142, v134, v142
    v_mfma_f32_16x16x32_bf16 v[176:179], a[224:227], a[120:123], v[176:179]
    s_waitcnt lgkmcnt(8)
    ds_read_b64_tr_b16 a[220:221], v18 offset:128
    ds_read_b64_tr_b16 a[222:223], v18 offset:896
    v_mfma_f32_16x16x32_bf16 v[180:183], a[224:227], a[124:127], v[180:183]
    v_mul_f32 v158, v150, v158
    v_mul_f32 v143, v135, v143
    v_mul_f32 v159, v151, v159
    v_mfma_f32_16x16x32_bf16 v[188:191], a[228:231], a[124:127], v[188:191]
    s_waitcnt vmcnt(18)
    ds_read_b64_tr_b16 a[224:225], v18 offset:6272
    ds_read_b64_tr_b16 a[226:227], v18 offset:7040
    v_mfma_f32_16x16x32_bf16 v[184:187], a[228:231], a[120:123], v[184:187]
    s_barrier
    v_mfma_f32_16x16x32_bf16 v[192:195], a[232:235], a[120:123], v[192:195]
    ds_read_b64_tr_b16 a[228:229], v17 offset:12288
    ds_read_b64_tr_b16 a[230:231], v17 offset:13056
    v_mfma_f32_16x16x32_bf16 v[196:199], a[232:235], a[124:127], v[196:199]
    v_mul_f32 v132, s34, v132
    v_mul_f32 v148, s34, v148
    s_add_u32 s77, s76, 128
    s_cmp_eq_u32 s77, s29
    s_cselect_b32 s77, s30, s77
    v_mfma_f32_16x16x32_bf16 v[204:207], a[236:239], a[124:127], v[204:207]
    s_waitcnt lgkmcnt(8)
    ds_read_b64_tr_b16 a[232:233], v17 offset:18432
    ds_read_b64_tr_b16 a[234:235], v17 offset:19200
    v_mfma_f32_16x16x32_bf16 v[200:203], a[236:239], a[120:123], v[200:203]
    v_mul_f32 v133, s34, v133
    v_mul_f32 v149, s34, v149
    v_mul_f32 v134, s34, v134
    v_mfma_f32_16x16x32_bf16 v[208:211], a[240:243], a[120:123], v[208:211]
    ds_read_b64_tr_b16 a[236:237], v18 offset:12288
    ds_read_b64_tr_b16 a[238:239], v18 offset:13056
    v_mfma_f32_16x16x32_bf16 v[212:215], a[240:243], a[124:127], v[212:215]
    v_mul_f32 v150, s34, v150
    v_mul_f32 v135, s34, v135
    v_mul_f32 v151, s34, v151
    v_mfma_f32_16x16x32_bf16 v[220:223], a[244:247], a[124:127], v[220:223]
    ds_read_b64_tr_b16 a[240:241], v18 offset:18432
    ds_read_b64_tr_b16 a[242:243], v18 offset:19200
    v_mfma_f32_16x16x32_bf16 v[216:219], a[244:247], a[120:123], v[216:219]
    v_exp_f32 v132, v132
    v_exp_f32 v148, v148
    v_mfma_f32_16x16x32_bf16 v[224:227], a[248:251], a[120:123], v[224:227]
    s_waitcnt lgkmcnt(8)
    ds_read_b64_tr_b16 a[244:245], v17 offset:12352
    ds_read_b64_tr_b16 a[246:247], v17 offset:13120
    v_mfma_f32_16x16x32_bf16 v[228:231], a[248:251], a[124:127], v[228:231]
    v_exp_f32 v133, v133
    v_exp_f32 v149, v149
    v_mov_b32 v44, 1
    v_mfma_f32_16x16x32_bf16 v[236:239], a[216:219], a[124:127], v[236:239]
    ds_read_b64_tr_b16 a[248:249], v17 offset:18496
    ds_read_b64_tr_b16 a[250:251], v17 offset:19264
    v_mfma_f32_16x16x32_bf16 v[232:235], a[216:219], a[120:123], v[232:235]
    buffer_atomic_add v44, v43, s[40:43], 0 offen sc0 sc1
    s_add_u32 m0, s23, 24576
    v_mfma_f32_16x16x32_bf16 v[240:243], a[220:223], a[120:123], v[240:243]
    ds_read_b64_tr_b16 a[216:217], v18 offset:12352
    ds_read_b64_tr_b16 a[218:219], v18 offset:13120
    v_mfma_f32_16x16x32_bf16 v[244:247], a[220:223], a[124:127], v[244:247]
    buffer_load_dwordx4 v2, s[8:11], s63 offen offset:0 lds
    v_exp_f32 v134, v134
    v_mfma_f32_16x16x32_bf16 v[252:255], a[224:227], a[124:127], v[252:255]
    s_waitcnt lgkmcnt(8)
    ds_read_b64_tr_b16 a[220:221], v18 offset:18496
    ds_read_b64_tr_b16 a[222:223], v18 offset:19264
    v_mfma_f32_16x16x32_bf16 v[248:251], a[224:227], a[120:123], v[248:251]
    v_exp_f32 v150, v150
    v_mfma_f32_16x16x32_bf16 v[160:163], a[228:231], a[128:131], v[160:163]
    ds_read_b64_tr_b16 a[224:225], v17 offset:12416
    ds_read_b64_tr_b16 a[226:227], v17 offset:13184
    v_mfma_f32_16x16x32_bf16 v[164:167], a[228:231], a[132:135], v[164:167]
    buffer_load_dwordx4 v3, s[8:11], s63 offen offset:1024 lds
    v_exp_f32 v135, v135
    v_mfma_f32_16x16x32_bf16 v[172:175], a[232:235], a[132:135], v[172:175]
    ds_read_b64_tr_b16 a[228:229], v17 offset:18560
    ds_read_b64_tr_b16 a[230:231], v17 offset:19328
    v_mfma_f32_16x16x32_bf16 v[168:171], a[232:235], a[128:131], v[168:171]
    v_exp_f32 v151, v151
    v_mfma_f32_16x16x32_bf16 v[176:179], a[236:239], a[128:131], v[176:179]
    s_waitcnt lgkmcnt(8)
    ds_read_b64_tr_b16 a[232:233], v18 offset:12416
    ds_read_b64_tr_b16 a[234:235], v18 offset:13184
    v_mfma_f32_16x16x32_bf16 v[180:183], a[236:239], a[132:135], v[180:183]
    buffer_load_dwordx4 v4, s[8:11], s63 offen offset:2048 lds
    v_add_f32 v132, 1.0, v132
    v_mfma_f32_16x16x32_bf16 v[188:191], a[240:243], a[132:135], v[188:191]
    ds_read_b64_tr_b16 a[236:237], v18 offset:18560
    ds_read_b64_tr_b16 a[238:239], v18 offset:19328
    v_mfma_f32_16x16x32_bf16 v[184:187], a[240:243], a[128:131], v[184:187]
    v_add_f32 v148, 1.0, v148
    v_add_f32 v133, 1.0, v133
    v_add_f32 v149, 1.0, v149
    v_mfma_f32_16x16x32_bf16 v[192:195], a[244:247], a[128:131], v[192:195]
    ds_read_b64_tr_b16 a[240:241], v17 offset:24576
    ds_read_b64_tr_b16 a[242:243], v17 offset:25344
    v_mfma_f32_16x16x32_bf16 v[196:199], a[244:247], a[132:135], v[196:199]
    v_add_f32 v134, 1.0, v134
    v_add_f32 v150, 1.0, v150
    v_mfma_f32_16x16x32_bf16 v[204:207], a[248:251], a[132:135], v[204:207]
    s_waitcnt lgkmcnt(8)
    ds_read_b64_tr_b16 a[244:245], v17 offset:30720
    ds_read_b64_tr_b16 a[246:247], v17 offset:31488
    v_mfma_f32_16x16x32_bf16 v[200:203], a[248:251], a[128:131], v[200:203]
    v_add_f32 v135, 1.0, v135
    v_add_f32 v151, 1.0, v151
    v_mfma_f32_16x16x32_bf16 v[208:211], a[216:219], a[128:131], v[208:211]
    ds_read_b64_tr_b16 a[248:249], v18 offset:24576
    ds_read_b64_tr_b16 a[250:251], v18 offset:25344
    v_mfma_f32_16x16x32_bf16 v[212:215], a[216:219], a[132:135], v[212:215]
    v_rcp_f32 v132, v132
    v_rcp_f32 v148, v148
    v_mfma_f32_16x16x32_bf16 v[220:223], a[220:223], a[132:135], v[220:223]
    ds_read_b64_tr_b16 a[216:217], v18 offset:30720
    ds_read_b64_tr_b16 a[218:219], v18 offset:31488
    v_mfma_f32_16x16x32_bf16 v[216:219], a[220:223], a[128:131], v[216:219]
    v_rcp_f32 v133, v133
    v_mfma_f32_16x16x32_bf16 v[224:227], a[224:227], a[128:131], v[224:227]
    s_waitcnt lgkmcnt(8)
    ds_read_b64_tr_b16 a[220:221], v17 offset:24640
    ds_read_b64_tr_b16 a[222:223], v17 offset:25408
    v_mfma_f32_16x16x32_bf16 v[228:231], a[224:227], a[132:135], v[228:231]
    v_rcp_f32 v149, v149
    s_add_u32 m0, s23, 36864
    v_mfma_f32_16x16x32_bf16 v[236:239], a[228:231], a[132:135], v[236:239]
    ds_read_b64_tr_b16 a[224:225], v17 offset:30784
    ds_read_b64_tr_b16 a[226:227], v17 offset:31552
    v_mfma_f32_16x16x32_bf16 v[232:235], a[228:231], a[128:131], v[232:235]
    buffer_load_dwordx4 v5, s[8:11], s63 offen offset:0 lds
    v_mfma_f32_16x16x32_bf16 v[240:243], a[232:235], a[128:131], v[240:243]
    ds_read_b64_tr_b16 a[228:229], v18 offset:24640
    ds_read_b64_tr_b16 a[230:231], v18 offset:25408
    v_mfma_f32_16x16x32_bf16 v[244:247], a[232:235], a[132:135], v[244:247]
    v_rcp_f32 v134, v134
    v_rcp_f32 v150, v150
    v_mfma_f32_16x16x32_bf16 v[252:255], a[236:239], a[132:135], v[252:255]
    s_waitcnt lgkmcnt(8)
    ds_read_b64_tr_b16 a[232:233], v18 offset:30784
    ds_read_b64_tr_b16 a[234:235], v18 offset:31552
    v_mfma_f32_16x16x32_bf16 v[248:251], a[236:239], a[128:131], v[248:251]
    buffer_load_dwordx4 v6, s[8:11], s63 offen offset:1024 lds
    v_mfma_f32_16x16x32_bf16 v[160:163], a[240:243], a[136:139], v[160:163]
    ds_read_b64_tr_b16 a[236:237], v17 offset:24704
    ds_read_b64_tr_b16 a[238:239], v17 offset:25472
    v_mfma_f32_16x16x32_bf16 v[164:167], a[240:243], a[140:143], v[164:167]
    v_rcp_f32 v135, v135
    v_rcp_f32 v151, v151
    v_mfma_f32_16x16x32_bf16 v[172:175], a[244:247], a[140:143], v[172:175]
    ds_read_b64_tr_b16 a[240:241], v17 offset:30848
    ds_read_b64_tr_b16 a[242:243], v17 offset:31616
    v_mfma_f32_16x16x32_bf16 v[168:171], a[244:247], a[136:139], v[168:171]
    buffer_load_dwordx4 v7, s[8:11], s63 offen offset:2048 lds
    v_mfma_f32_16x16x32_bf16 v[176:179], a[248:251], a[136:139], v[176:179]
    s_waitcnt lgkmcnt(8)
    ds_read_b64_tr_b16 a[244:245], v18 offset:24704
    ds_read_b64_tr_b16 a[246:247], v18 offset:25472
    v_mfma_f32_16x16x32_bf16 v[180:183], a[248:251], a[140:143], v[180:183]
    v_mul_f32 v140, v140, v132
    v_mul_f32 v156, v156, v148
    v_mfma_f32_16x16x32_bf16 v[188:191], a[216:219], a[140:143], v[188:191]
    s_waitcnt vmcnt(19)
    ds_read_b64_tr_b16 a[248:249], v18 offset:30848
    ds_read_b64_tr_b16 a[250:251], v18 offset:31616
    v_mfma_f32_16x16x32_bf16 v[184:187], a[216:219], a[136:139], v[184:187]
    s_barrier
    v_mfma_f32_16x16x32_bf16 v[192:195], a[220:223], a[136:139], v[192:195]
    ds_read_b64_tr_b16 a[216:217], v17 offset:36864
    ds_read_b64_tr_b16 a[218:219], v17 offset:37632
    v_mfma_f32_16x16x32_bf16 v[196:199], a[220:223], a[140:143], v[196:199]
    v_mul_f32 v141, v141, v133
    v_mul_f32 v157, v157, v149
    v_mul_f32 v142, v142, v134
    v_mfma_f32_16x16x32_bf16 v[204:207], a[224:227], a[140:143], v[204:207]
    s_waitcnt lgkmcnt(8)
    ds_read_b64_tr_b16 a[220:221], v17 offset:43008
    ds_read_b64_tr_b16 a[222:223], v17 offset:43776
    v_mfma_f32_16x16x32_bf16 v[200:203], a[224:227], a[136:139], v[200:203]
    v_mul_f32 v158, v158, v150
    v_mul_f32 v143, v143, v135
    v_mul_f32 v159, v159, v151
    v_mfma_f32_16x16x32_bf16 v[208:211], a[228:231], a[136:139], v[208:211]
    ds_read_b64_tr_b16 a[224:225], v18 offset:36864
    ds_read_b64_tr_b16 a[226:227], v18 offset:37632
    v_mfma_f32_16x16x32_bf16 v[212:215], a[228:231], a[140:143], v[212:215]
    v_cvt_pk_bf16_f32 v132, v140, v141
    v_cvt_pk_bf16_f32 v148, v156, v157
    v_cvt_pk_bf16_f32 v133, v142, v143
    v_cvt_pk_bf16_f32 v149, v158, v159
    v_accvgpr_write_b32 a164, v132
    v_accvgpr_write_b32 a166, v148
    v_accvgpr_write_b32 a165, v133
    v_accvgpr_write_b32 a167, v149
    v_mfma_f32_16x16x32_bf16 v[220:223], a[232:235], a[140:143], v[220:223]
    ds_read_b64_tr_b16 a[228:229], v18 offset:43008
    ds_read_b64_tr_b16 a[230:231], v18 offset:43776
    v_mfma_f32_16x16x32_bf16 v[216:219], a[232:235], a[136:139], v[216:219]
    s_add_u32 m0, s23, 49152
    v_mfma_f32_16x16x32_bf16 v[224:227], a[236:239], a[136:139], v[224:227]
    s_waitcnt lgkmcnt(8)
    ds_read_b64_tr_b16 a[232:233], v17 offset:36928
    ds_read_b64_tr_b16 a[234:235], v17 offset:37696
    v_mfma_f32_16x16x32_bf16 v[228:231], a[236:239], a[140:143], v[228:231]
    buffer_load_dwordx4 v2, s[8:11], s64 offen offset:0 lds
    v_mfma_f32_16x16x32_bf16 v[236:239], a[240:243], a[140:143], v[236:239]
    ds_read_b64_tr_b16 a[236:237], v17 offset:43072
    ds_read_b64_tr_b16 a[238:239], v17 offset:43840
    v_mfma_f32_16x16x32_bf16 v[232:235], a[240:243], a[136:139], v[232:235]
    buffer_load_dwordx4 v3, s[8:11], s64 offen offset:1024 lds
    v_mfma_f32_16x16x32_bf16 v[240:243], a[244:247], a[136:139], v[240:243]
    ds_read_b64_tr_b16 a[240:241], v18 offset:36928
    ds_read_b64_tr_b16 a[242:243], v18 offset:37696
    v_mfma_f32_16x16x32_bf16 v[244:247], a[244:247], a[140:143], v[244:247]
    buffer_load_dwordx4 v4, s[8:11], s64 offen offset:2048 lds
    v_mfma_f32_16x16x32_bf16 v[252:255], a[248:251], a[140:143], v[252:255]
    s_waitcnt lgkmcnt(8)
    ds_read_b64_tr_b16 a[244:245], v18 offset:43072
    ds_read_b64_tr_b16 a[246:247], v18 offset:43840
    v_mfma_f32_16x16x32_bf16 v[248:251], a[248:251], a[136:139], v[248:251]
    v_mfma_f32_16x16x32_bf16 v[64:67], a[216:219], a[0:3], 0
    ds_read_b64_tr_b16 a[248:249], v17 offset:36992
    ds_read_b64_tr_b16 a[250:251], v17 offset:37760
    v_mfma_f32_16x16x32_bf16 v[68:71], a[216:219], a[4:7], 0
    v_mfma_f32_16x16x32_bf16 v[76:79], a[220:223], a[4:7], 0
    ds_read_b64_tr_b16 a[216:217], v17 offset:43136
    ds_read_b64_tr_b16 a[218:219], v17 offset:43904
    v_mfma_f32_16x16x32_bf16 v[72:75], a[220:223], a[0:3], 0
    v_mfma_f32_16x16x32_bf16 v[80:83], a[224:227], a[0:3], 0
    s_waitcnt lgkmcnt(8)
    ds_read_b64_tr_b16 a[220:221], v18 offset:36992
    ds_read_b64_tr_b16 a[222:223], v18 offset:37760
    v_mfma_f32_16x16x32_bf16 v[84:87], a[224:227], a[4:7], 0
    v_mfma_f32_16x16x32_bf16 v[92:95], a[228:231], a[4:7], 0
    ds_read_b64_tr_b16 a[224:225], v18 offset:43136
    ds_read_b64_tr_b16 a[226:227], v18 offset:43904
    v_mfma_f32_16x16x32_bf16 v[88:91], a[228:231], a[0:3], 0
    v_mul_f32 v168, v160, v168
    v_mul_f32 v184, v176, v184
    v_mfma_f32_16x16x32_bf16 v[96:99], a[232:235], a[0:3], 0
    ds_read_b64_tr_b16 a[228:229], v17 offset:49152
    ds_read_b64_tr_b16 a[230:231], v17 offset:49920
    v_mfma_f32_16x16x32_bf16 v[100:103], a[232:235], a[4:7], 0
    v_mul_f32 v169, v161, v169
    v_mul_f32 v185, v177, v185
    v_mfma_f32_16x16x32_bf16 v[108:111], a[236:239], a[4:7], 0
    s_waitcnt lgkmcnt(8)
    ds_read_b64_tr_b16 a[232:233], v17 offset:55296
    ds_read_b64_tr_b16 a[234:235], v17 offset:56064
    v_mfma_f32_16x16x32_bf16 v[104:107], a[236:239], a[0:3], 0
    s_add_u32 m0, s23, 61440
    v_mul_f32 v170, v162, v170
    v_mfma_f32_16x16x32_bf16 v[112:115], a[240:243], a[0:3], 0
    ds_read_b64_tr_b16 a[236:237], v18 offset:49152
    ds_read_b64_tr_b16 a[238:239], v18 offset:49920
    v_mfma_f32_16x16x32_bf16 v[116:119], a[240:243], a[4:7], 0
    buffer_load_dwordx4 v5, s[8:11], s64 offen offset:0 lds
    v_mfma_f32_16x16x32_bf16 v[124:127], a[244:247], a[4:7], 0
    ds_read_b64_tr_b16 a[240:241], v18 offset:55296
    ds_read_b64_tr_b16 a[242:243], v18 offset:56064
    v_mfma_f32_16x16x32_bf16 v[120:123], a[244:247], a[0:3], 0
    v_mul_f32 v186, v178, v186
    v_mul_f32 v171, v163, v171
    v_mfma_f32_16x16x32_bf16 v[128:131], a[248:251], a[0:3], 0
    s_waitcnt lgkmcnt(8)
    ds_read_b64_tr_b16 a[244:245], v17 offset:49216
    ds_read_b64_tr_b16 a[246:247], v17 offset:49984
    v_mfma_f32_16x16x32_bf16 v[132:135], a[248:251], a[4:7], 0
    v_mul_f32 v187, v179, v187
    v_mul_f32 v160, s34, v160
    v_mfma_f32_16x16x32_bf16 v[140:143], a[216:219], a[4:7], 0
    ds_read_b64_tr_b16 a[248:249], v17 offset:55360
    ds_read_b64_tr_b16 a[250:251], v17 offset:56128
    v_mfma_f32_16x16x32_bf16 v[136:139], a[216:219], a[0:3], 0
    v_mul_f32 v176, s34, v176
    v_mul_f32 v161, s34, v161
    v_mfma_f32_16x16x32_bf16 v[144:147], a[220:223], a[0:3], 0
    ds_read_b64_tr_b16 a[216:217], v18 offset:49216
    ds_read_b64_tr_b16 a[218:219], v18 offset:49984
    v_mfma_f32_16x16x32_bf16 v[148:151], a[220:223], a[4:7], 0
    buffer_load_dwordx4 v6, s[8:11], s64 offen offset:1024 lds
    v_mul_f32 v177, s34, v177
    v_mfma_f32_16x16x32_bf16 v[156:159], a[224:227], a[4:7], 0
    s_waitcnt lgkmcnt(8)
    ds_read_b64_tr_b16 a[220:221], v18 offset:55360
    ds_read_b64_tr_b16 a[222:223], v18 offset:56128
    v_mfma_f32_16x16x32_bf16 v[152:155], a[224:227], a[0:3], 0
    v_mul_f32 v162, s34, v162
    v_mul_f32 v178, s34, v178
    v_mfma_f32_16x16x32_bf16 v[64:67], a[228:231], a[8:11], v[64:67]
    ds_read_b64_tr_b16 a[224:225], v17 offset:49280
    ds_read_b64_tr_b16 a[226:227], v17 offset:50048
    v_mfma_f32_16x16x32_bf16 v[68:71], a[228:231], a[12:15], v[68:71]
    v_mul_f32 v163, s34, v163
    v_mul_f32 v179, s34, v179
    v_mfma_f32_16x16x32_bf16 v[76:79], a[232:235], a[12:15], v[76:79]
    ds_read_b64_tr_b16 a[228:229], v17 offset:55424
    ds_read_b64_tr_b16 a[230:231], v17 offset:56192
    v_mfma_f32_16x16x32_bf16 v[72:75], a[232:235], a[8:11], v[72:75]
    buffer_load_dwordx4 v7, s[8:11], s64 offen offset:2048 lds
    v_exp_f32 v160, v160
    v_mfma_f32_16x16x32_bf16 v[80:83], a[236:239], a[8:11], v[80:83]
    s_waitcnt lgkmcnt(8)
    ds_read_b64_tr_b16 a[232:233], v18 offset:49280
    ds_read_b64_tr_b16 a[234:235], v18 offset:50048
    v_mfma_f32_16x16x32_bf16 v[84:87], a[236:239], a[12:15], v[84:87]
    v_exp_f32 v176, v176
    v_mfma_f32_16x16x32_bf16 v[92:95], a[240:243], a[12:15], v[92:95]
    s_waitcnt vmcnt(19)
    ds_read_b64_tr_b16 a[236:237], v18 offset:55424
    ds_read_b64_tr_b16 a[238:239], v18 offset:56192
    v_mfma_f32_16x16x32_bf16 v[88:91], a[240:243], a[8:11], v[88:91]
    s_barrier
    v_mfma_f32_16x16x32_bf16 v[96:99], a[244:247], a[8:11], v[96:99]
    ds_read_b64_tr_b16 a[240:241], v17 offset:61440
    ds_read_b64_tr_b16 a[242:243], v17 offset:62208
    v_mfma_f32_16x16x32_bf16 v[100:103], a[244:247], a[12:15], v[100:103]
    v_add_u32 v17, 61440, v17
    v_add_u32 v18, 61440, v18
    v_exp_f32 v161, v161
    v_mfma_f32_16x16x32_bf16 v[108:111], a[248:251], a[12:15], v[108:111]
    s_waitcnt lgkmcnt(8)
    ds_read_b64_tr_b16 a[244:245], v17 offset:6144
    ds_read_b64_tr_b16 a[246:247], v17 offset:6912
    v_mfma_f32_16x16x32_bf16 v[104:107], a[248:251], a[8:11], v[104:107]
    v_exp_f32 v177, v177
    v_exp_f32 v162, v162
    v_mfma_f32_16x16x32_bf16 v[112:115], a[216:219], a[8:11], v[112:115]
    ds_read_b64_tr_b16 a[248:249], v18 offset:0
    ds_read_b64_tr_b16 a[250:251], v18 offset:768
    v_mfma_f32_16x16x32_bf16 v[116:119], a[216:219], a[12:15], v[116:119]
    v_exp_f32 v178, v178
    v_mfma_f32_16x16x32_bf16 v[124:127], a[220:223], a[12:15], v[124:127]
    ds_read_b64_tr_b16 a[216:217], v18 offset:6144
    ds_read_b64_tr_b16 a[218:219], v18 offset:6912
    v_mfma_f32_16x16x32_bf16 v[120:123], a[220:223], a[8:11], v[120:123]
    v_exp_f32 v163, v163
    v_exp_f32 v179, v179
    v_mfma_f32_16x16x32_bf16 v[128:131], a[224:227], a[8:11], v[128:131]
    s_waitcnt lgkmcnt(8)
    ds_read_b64_tr_b16 a[220:221], v17 offset:64
    ds_read_b64_tr_b16 a[222:223], v17 offset:832
    v_mfma_f32_16x16x32_bf16 v[132:135], a[224:227], a[12:15], v[132:135]
    v_add_f32 v160, 1.0, v160
    v_add_f32 v176, 1.0, v176
    v_mfma_f32_16x16x32_bf16 v[140:143], a[228:231], a[12:15], v[140:143]
    ds_read_b64_tr_b16 a[224:225], v17 offset:6208
    ds_read_b64_tr_b16 a[226:227], v17 offset:6976
    v_mfma_f32_16x16x32_bf16 v[136:139], a[228:231], a[8:11], v[136:139]
    s_add_u32 m0, s23, 73728
    v_add_f32 v161, 1.0, v161
    v_mfma_f32_16x16x32_bf16 v[144:147], a[232:235], a[8:11], v[144:147]
    ds_read_b64_tr_b16 a[228:229], v18 offset:64
    ds_read_b64_tr_b16 a[230:231], v18 offset:832
    v_mfma_f32_16x16x32_bf16 v[148:151], a[232:235], a[12:15], v[148:151]
    buffer_load_dwordx4 v2, s[8:11], s65 offen offset:0 lds
    v_add_f32 v177, 1.0, v177
    v_mfma_f32_16x16x32_bf16 v[156:159], a[236:239], a[12:15], v[156:159]
    s_waitcnt lgkmcnt(8)
    ds_read_b64_tr_b16 a[232:233], v18 offset:6208
    ds_read_b64_tr_b16 a[234:235], v18 offset:6976
    v_mfma_f32_16x16x32_bf16 v[152:155], a[236:239], a[8:11], v[152:155]
    v_add_f32 v162, 1.0, v162
    v_add_f32 v178, 1.0, v178
    v_mfma_f32_16x16x32_bf16 v[64:67], a[240:243], a[16:19], v[64:67]
    ds_read_b64_tr_b16 a[236:237], v17 offset:128
    ds_read_b64_tr_b16 a[238:239], v17 offset:896
    v_mfma_f32_16x16x32_bf16 v[68:71], a[240:243], a[20:23], v[68:71]
    buffer_load_dwordx4 v3, s[8:11], s65 offen offset:1024 lds
    v_add_f32 v163, 1.0, v163
    v_mfma_f32_16x16x32_bf16 v[76:79], a[244:247], a[20:23], v[76:79]
    ds_read_b64_tr_b16 a[240:241], v17 offset:6272
    ds_read_b64_tr_b16 a[242:243], v17 offset:7040
    v_mfma_f32_16x16x32_bf16 v[72:75], a[244:247], a[16:19], v[72:75]
    v_add_f32 v179, 1.0, v179
    v_rcp_f32 v160, v160
    v_mfma_f32_16x16x32_bf16 v[80:83], a[248:251], a[16:19], v[80:83]
    s_waitcnt lgkmcnt(8)
    ds_read_b64_tr_b16 a[244:245], v18 offset:128
    ds_read_b64_tr_b16 a[246:247], v18 offset:896
    v_mfma_f32_16x16x32_bf16 v[84:87], a[248:251], a[20:23], v[84:87]
    buffer_load_dwordx4 v4, s[8:11], s65 offen offset:2048 lds
    v_rcp_f32 v176, v176
    v_mfma_f32_16x16x32_bf16 v[92:95], a[216:219], a[20:23], v[92:95]
    ds_read_b64_tr_b16 a[248:249], v18 offset:6272
    ds_read_b64_tr_b16 a[250:251], v18 offset:7040
    v_mfma_f32_16x16x32_bf16 v[88:91], a[216:219], a[16:19], v[88:91]
    v_rcp_f32 v161, v161
    v_rcp_f32 v177, v177
    v_mfma_f32_16x16x32_bf16 v[96:99], a[220:223], a[16:19], v[96:99]
    ds_read_b64_tr_b16 a[216:217], v17 offset:12288
    ds_read_b64_tr_b16 a[218:219], v17 offset:13056
    v_mfma_f32_16x16x32_bf16 v[100:103], a[220:223], a[20:23], v[100:103]
    v_rcp_f32 v162, v162
    v_rcp_f32 v178, v178
    v_mfma_f32_16x16x32_bf16 v[108:111], a[224:227], a[20:23], v[108:111]
    s_waitcnt lgkmcnt(8)
    ds_read_b64_tr_b16 a[220:221], v17 offset:18432
    ds_read_b64_tr_b16 a[222:223], v17 offset:19200
    v_mfma_f32_16x16x32_bf16 v[104:107], a[224:227], a[16:19], v[104:107]
    v_rcp_f32 v163, v163
    v_mfma_f32_16x16x32_bf16 v[112:115], a[228:231], a[16:19], v[112:115]
    ds_read_b64_tr_b16 a[224:225], v18 offset:12288
    ds_read_b64_tr_b16 a[226:227], v18 offset:13056
    v_mfma_f32_16x16x32_bf16 v[116:119], a[228:231], a[20:23], v[116:119]
    v_rcp_f32 v179, v179
    v_mfma_f32_16x16x32_bf16 v[124:127], a[232:235], a[20:23], v[124:127]
    ds_read_b64_tr_b16 a[228:229], v18 offset:18432
    ds_read_b64_tr_b16 a[230:231], v18 offset:19200
    v_mfma_f32_16x16x32_bf16 v[120:123], a[232:235], a[16:19], v[120:123]
    s_add_u32 m0, s23, 86016
    v_mul_f32 v168, v168, v160
    v_mfma_f32_16x16x32_bf16 v[128:131], a[236:239], a[16:19], v[128:131]
    s_waitcnt lgkmcnt(8)
    ds_read_b64_tr_b16 a[232:233], v17 offset:12352
    ds_read_b64_tr_b16 a[234:235], v17 offset:13120
    v_mfma_f32_16x16x32_bf16 v[132:135], a[236:239], a[20:23], v[132:135]
    buffer_load_dwordx4 v5, s[8:11], s65 offen offset:0 lds
    v_mul_f32 v184, v184, v176
    v_mfma_f32_16x16x32_bf16 v[140:143], a[240:243], a[20:23], v[140:143]
    ds_read_b64_tr_b16 a[236:237], v17 offset:18496
    ds_read_b64_tr_b16 a[238:239], v17 offset:19264
    v_mfma_f32_16x16x32_bf16 v[136:139], a[240:243], a[16:19], v[136:139]
    v_mul_f32 v169, v169, v161
    v_mul_f32 v185, v185, v177
    v_mfma_f32_16x16x32_bf16 v[144:147], a[244:247], a[16:19], v[144:147]
    ds_read_b64_tr_b16 a[240:241], v18 offset:12352
    ds_read_b64_tr_b16 a[242:243], v18 offset:13120
    v_mfma_f32_16x16x32_bf16 v[148:151], a[244:247], a[20:23], v[148:151]
    buffer_load_dwordx4 v6, s[8:11], s65 offen offset:1024 lds
    v_mul_f32 v170, v170, v162
    v_mfma_f32_16x16x32_bf16 v[156:159], a[248:251], a[20:23], v[156:159]
    s_waitcnt lgkmcnt(8)
    ds_read_b64_tr_b16 a[244:245], v18 offset:18496
    ds_read_b64_tr_b16 a[246:247], v18 offset:19264
    v_mfma_f32_16x16x32_bf16 v[152:155], a[248:251], a[16:19], v[152:155]
    v_mul_f32 v186, v186, v178
    v_mul_f32 v171, v171, v163
    v_mul_f32 v187, v187, v179
    v_mfma_f32_16x16x32_bf16 v[64:67], a[216:219], a[24:27], v[64:67]
    ds_read_b64_tr_b16 a[248:249], v17 offset:12416
    ds_read_b64_tr_b16 a[250:251], v17 offset:13184
    v_mfma_f32_16x16x32_bf16 v[68:71], a[216:219], a[28:31], v[68:71]
    v_cvt_pk_bf16_f32 v160, v168, v169
    v_cvt_pk_bf16_f32 v176, v184, v185
    v_mfma_f32_16x16x32_bf16 v[76:79], a[220:223], a[28:31], v[76:79]
    ds_read_b64_tr_b16 a[216:217], v17 offset:18560
    ds_read_b64_tr_b16 a[218:219], v17 offset:19328
    v_mfma_f32_16x16x32_bf16 v[72:75], a[220:223], a[24:27], v[72:75]
    buffer_load_dwordx4 v7, s[8:11], s65 offen offset:2048 lds
    v_cvt_pk_bf16_f32 v161, v170, v171
    v_mfma_f32_16x16x32_bf16 v[80:83], a[224:227], a[24:27], v[80:83]
    s_waitcnt lgkmcnt(8)
    ds_read_b64_tr_b16 a[220:221], v18 offset:12416
    ds_read_b64_tr_b16 a[222:223], v18 offset:13184
    v_mfma_f32_16x16x32_bf16 v[84:87], a[224:227], a[28:31], v[84:87]
    v_cvt_pk_bf16_f32 v177, v186, v187
    v_accvgpr_write_b32 a168, v160
    v_accvgpr_write_b32 a170, v176
    v_mfma_f32_16x16x32_bf16 v[92:95], a[228:231], a[28:31], v[92:95]
    s_waitcnt vmcnt(19)
    ds_read_b64_tr_b16 a[224:225], v18 offset:18560
    ds_read_b64_tr_b16 a[226:227], v18 offset:19328
    v_mfma_f32_16x16x32_bf16 v[88:91], a[228:231], a[24:27], v[88:91]
    s_barrier
    v_subrev_u32 v17, 122880, v17
    v_subrev_u32 v18, 122880, v18
    v_mfma_f32_16x16x32_bf16 v[96:99], a[232:235], a[24:27], v[96:99]
    ds_read_b64_tr_b16 a[228:229], v17 offset:0
    ds_read_b64_tr_b16 a[230:231], v17 offset:768
    v_mfma_f32_16x16x32_bf16 v[100:103], a[232:235], a[28:31], v[100:103]
    v_accvgpr_write_b32 a169, v161
    v_accvgpr_write_b32 a171, v177
    v_mul_f32 v172, v164, v172
    v_mfma_f32_16x16x32_bf16 v[108:111], a[236:239], a[28:31], v[108:111]
    s_waitcnt lgkmcnt(8)
    ds_read_b64_tr_b16 a[232:233], v17 offset:6144
    ds_read_b64_tr_b16 a[234:235], v17 offset:6912
    v_mfma_f32_16x16x32_bf16 v[104:107], a[236:239], a[24:27], v[104:107]
    v_mul_f32 v188, v180, v188
    v_mul_f32 v173, v165, v173
    v_mul_f32 v189, v181, v189
    v_mfma_f32_16x16x32_bf16 v[112:115], a[240:243], a[24:27], v[112:115]
    ds_read_b64_tr_b16 a[236:237], v18 offset:0
    ds_read_b64_tr_b16 a[238:239], v18 offset:768
    v_mfma_f32_16x16x32_bf16 v[116:119], a[240:243], a[28:31], v[116:119]
    v_mul_f32 v174, v166, v174
    v_mul_f32 v190, v182, v190
    v_mfma_f32_16x16x32_bf16 v[124:127], a[244:247], a[28:31], v[124:127]
    ds_read_b64_tr_b16 a[240:241], v18 offset:6144
    ds_read_b64_tr_b16 a[242:243], v18 offset:6912
    v_mfma_f32_16x16x32_bf16 v[120:123], a[244:247], a[24:27], v[120:123]
    v_mul_f32 v175, v167, v175
    v_mul_f32 v191, v183, v191
    v_mfma_f32_16x16x32_bf16 v[128:131], a[248:251], a[24:27], v[128:131]
    s_waitcnt lgkmcnt(8)
    ds_read_b64_tr_b16 a[244:245], v17 offset:64
    ds_read_b64_tr_b16 a[246:247], v17 offset:832
    v_mfma_f32_16x16x32_bf16 v[132:135], a[248:251], a[28:31], v[132:135]
    v_mul_f32 v164, s34, v164
    v_mul_f32 v180, s34, v180
    v_mfma_f32_16x16x32_bf16 v[140:143], a[216:219], a[28:31], v[140:143]
    ds_read_b64_tr_b16 a[248:249], v17 offset:6208
    ds_read_b64_tr_b16 a[250:251], v17 offset:6976
    v_mfma_f32_16x16x32_bf16 v[136:139], a[216:219], a[24:27], v[136:139]
    v_mul_f32 v165, s34, v165
    v_mul_f32 v181, s34, v181
    s_add_u32 m0, s23, 98304
    v_mfma_f32_16x16x32_bf16 v[144:147], a[220:223], a[24:27], v[144:147]
    ds_read_b64_tr_b16 a[216:217], v18 offset:64
    ds_read_b64_tr_b16 a[218:219], v18 offset:832
    v_mfma_f32_16x16x32_bf16 v[148:151], a[220:223], a[28:31], v[148:151]
    buffer_load_dwordx4 v2, s[8:11], s66 offen offset:0 lds
    v_mul_f32 v166, s34, v166
    v_mfma_f32_16x16x32_bf16 v[156:159], a[224:227], a[28:31], v[156:159]
    s_waitcnt lgkmcnt(8)
    ds_read_b64_tr_b16 a[220:221], v18 offset:6208
    ds_read_b64_tr_b16 a[222:223], v18 offset:6976
    v_mfma_f32_16x16x32_bf16 v[152:155], a[224:227], a[24:27], v[152:155]
    v_mul_f32 v182, s34, v182
    v_mul_f32 v167, s34, v167
    v_mul_f32 v183, s34, v183
    v_mfma_f32_16x16x32_bf16 v[64:67], a[228:231], a[32:35], v[64:67]
    ds_read_b64_tr_b16 a[224:225], v17 offset:128
    ds_read_b64_tr_b16 a[226:227], v17 offset:896
    v_mfma_f32_16x16x32_bf16 v[68:71], a[228:231], a[36:39], v[68:71]
    buffer_load_dwordx4 v3, s[8:11], s66 offen offset:1024 lds
    v_exp_f32 v164, v164
    v_mfma_f32_16x16x32_bf16 v[76:79], a[232:235], a[36:39], v[76:79]
    ds_read_b64_tr_b16 a[228:229], v17 offset:6272
    ds_read_b64_tr_b16 a[230:231], v17 offset:7040
    v_mfma_f32_16x16x32_bf16 v[72:75], a[232:235], a[32:35], v[72:75]
    v_exp_f32 v180, v180
    v_mfma_f32_16x16x32_bf16 v[80:83], a[236:239], a[32:35], v[80:83]
    s_waitcnt lgkmcnt(8)
    ds_read_b64_tr_b16 a[232:233], v18 offset:128
    ds_read_b64_tr_b16 a[234:235], v18 offset:896
    v_mfma_f32_16x16x32_bf16 v[84:87], a[236:239], a[36:39], v[84:87]
    buffer_load_dwordx4 v4, s[8:11], s66 offen offset:2048 lds
    v_exp_f32 v165, v165
    v_mfma_f32_16x16x32_bf16 v[92:95], a[240:243], a[36:39], v[92:95]
    ds_read_b64_tr_b16 a[236:237], v18 offset:6272
    ds_read_b64_tr_b16 a[238:239], v18 offset:7040
    v_mfma_f32_16x16x32_bf16 v[88:91], a[240:243], a[32:35], v[88:91]
    v_exp_f32 v181, v181
    v_mfma_f32_16x16x32_bf16 v[96:99], a[244:247], a[32:35], v[96:99]
    ds_read_b64_tr_b16 a[240:241], v17 offset:12288
    ds_read_b64_tr_b16 a[242:243], v17 offset:13056
    v_mfma_f32_16x16x32_bf16 v[100:103], a[244:247], a[36:39], v[100:103]
    v_exp_f32 v166, v166
    v_exp_f32 v182, v182
    v_mfma_f32_16x16x32_bf16 v[108:111], a[248:251], a[36:39], v[108:111]
    s_waitcnt lgkmcnt(8)
    ds_read_b64_tr_b16 a[244:245], v17 offset:18432
    ds_read_b64_tr_b16 a[246:247], v17 offset:19200
    v_mfma_f32_16x16x32_bf16 v[104:107], a[248:251], a[32:35], v[104:107]
    v_exp_f32 v167, v167
    v_mfma_f32_16x16x32_bf16 v[112:115], a[216:219], a[32:35], v[112:115]
    ds_read_b64_tr_b16 a[248:249], v18 offset:12288
    ds_read_b64_tr_b16 a[250:251], v18 offset:13056
    v_mfma_f32_16x16x32_bf16 v[116:119], a[216:219], a[36:39], v[116:119]
    v_exp_f32 v183, v183
    v_mfma_f32_16x16x32_bf16 v[124:127], a[220:223], a[36:39], v[124:127]
    ds_read_b64_tr_b16 a[216:217], v18 offset:18432
    ds_read_b64_tr_b16 a[218:219], v18 offset:19200
    v_mfma_f32_16x16x32_bf16 v[120:123], a[220:223], a[32:35], v[120:123]
    v_add_f32 v164, 1.0, v164
    v_add_f32 v180, 1.0, v180
    v_mfma_f32_16x16x32_bf16 v[128:131], a[224:227], a[32:35], v[128:131]
    s_waitcnt lgkmcnt(8)
    ds_read_b64_tr_b16 a[220:221], v17 offset:12352
    ds_read_b64_tr_b16 a[222:223], v17 offset:13120
    v_mfma_f32_16x16x32_bf16 v[132:135], a[224:227], a[36:39], v[132:135]
    s_add_u32 m0, s23, 110592
    v_add_f32 v165, 1.0, v165
    v_add_f32 v181, 1.0, v181
    v_mfma_f32_16x16x32_bf16 v[140:143], a[228:231], a[36:39], v[140:143]
    ds_read_b64_tr_b16 a[224:225], v17 offset:18496
    ds_read_b64_tr_b16 a[226:227], v17 offset:19264
    v_mfma_f32_16x16x32_bf16 v[136:139], a[228:231], a[32:35], v[136:139]
    buffer_load_dwordx4 v5, s[8:11], s66 offen offset:0 lds
    v_add_f32 v166, 1.0, v166
    v_mfma_f32_16x16x32_bf16 v[144:147], a[232:235], a[32:35], v[144:147]
    ds_read_b64_tr_b16 a[228:229], v18 offset:12352
    ds_read_b64_tr_b16 a[230:231], v18 offset:13120
    v_mfma_f32_16x16x32_bf16 v[148:151], a[232:235], a[36:39], v[148:151]
    v_add_f32 v182, 1.0, v182
    v_add_f32 v167, 1.0, v167
    v_add_f32 v183, 1.0, v183
    v_mfma_f32_16x16x32_bf16 v[156:159], a[236:239], a[36:39], v[156:159]
    s_waitcnt lgkmcnt(8)
    ds_read_b64_tr_b16 a[232:233], v18 offset:18496
    ds_read_b64_tr_b16 a[234:235], v18 offset:19264
    v_mfma_f32_16x16x32_bf16 v[152:155], a[236:239], a[32:35], v[152:155]
    buffer_load_dwordx4 v6, s[8:11], s66 offen offset:1024 lds
    v_rcp_f32 v164, v164
    v_mfma_f32_16x16x32_bf16 v[64:67], a[240:243], a[40:43], v[64:67]
    ds_read_b64_tr_b16 a[236:237], v17 offset:12416
    ds_read_b64_tr_b16 a[238:239], v17 offset:13184
    v_mfma_f32_16x16x32_bf16 v[68:71], a[240:243], a[44:47], v[68:71]
    v_rcp_f32 v180, v180
    v_mfma_f32_16x16x32_bf16 v[76:79], a[244:247], a[44:47], v[76:79]
    ds_read_b64_tr_b16 a[240:241], v17 offset:18560
    ds_read_b64_tr_b16 a[242:243], v17 offset:19328
    v_mfma_f32_16x16x32_bf16 v[72:75], a[244:247], a[40:43], v[72:75]
    buffer_load_dwordx4 v7, s[8:11], s66 offen offset:2048 lds
    v_rcp_f32 v165, v165
    v_mfma_f32_16x16x32_bf16 v[80:83], a[248:251], a[40:43], v[80:83]
    s_waitcnt lgkmcnt(8)
    ds_read_b64_tr_b16 a[244:245], v18 offset:12416
    ds_read_b64_tr_b16 a[246:247], v18 offset:13184
    v_mfma_f32_16x16x32_bf16 v[84:87], a[248:251], a[44:47], v[84:87]
    v_rcp_f32 v181, v181
    v_mfma_f32_16x16x32_bf16 v[92:95], a[216:219], a[44:47], v[92:95]
    s_waitcnt vmcnt(18)
    ds_read_b64_tr_b16 a[248:249], v18 offset:18560
    ds_read_b64_tr_b16 a[250:251], v18 offset:19328
    v_mfma_f32_16x16x32_bf16 v[88:91], a[216:219], a[40:43], v[88:91]
    s_barrier
    v_mfma_f32_16x16x32_bf16 v[96:99], a[220:223], a[40:43], v[96:99]
    ds_read_b64_tr_b16 a[216:217], v17 offset:24576
    ds_read_b64_tr_b16 a[218:219], v17 offset:25344
    v_mfma_f32_16x16x32_bf16 v[100:103], a[220:223], a[44:47], v[100:103]
    v_rcp_f32 v166, v166
    v_rcp_f32 v182, v182
    v_mfma_f32_16x16x32_bf16 v[108:111], a[224:227], a[44:47], v[108:111]
    s_waitcnt lgkmcnt(8)
    ds_read_b64_tr_b16 a[220:221], v17 offset:30720
    ds_read_b64_tr_b16 a[222:223], v17 offset:31488
    v_mfma_f32_16x16x32_bf16 v[104:107], a[224:227], a[40:43], v[104:107]
    v_rcp_f32 v167, v167
    v_rcp_f32 v183, v183
    v_mfma_f32_16x16x32_bf16 v[112:115], a[228:231], a[40:43], v[112:115]
    ds_read_b64_tr_b16 a[224:225], v18 offset:24576
    ds_read_b64_tr_b16 a[226:227], v18 offset:25344
    v_mfma_f32_16x16x32_bf16 v[116:119], a[228:231], a[44:47], v[116:119]
    v_mul_f32 v172, v172, v164
    v_mul_f32 v188, v188, v180
    v_mfma_f32_16x16x32_bf16 v[124:127], a[232:235], a[44:47], v[124:127]
    ds_read_b64_tr_b16 a[228:229], v18 offset:30720
    ds_read_b64_tr_b16 a[230:231], v18 offset:31488
    v_mfma_f32_16x16x32_bf16 v[120:123], a[232:235], a[40:43], v[120:123]
    v_mul_f32 v173, v173, v165
    v_mul_f32 v189, v189, v181
    v_mfma_f32_16x16x32_bf16 v[128:131], a[236:239], a[40:43], v[128:131]
    s_waitcnt lgkmcnt(8)
    ds_read_b64_tr_b16 a[232:233], v17 offset:24640
    ds_read_b64_tr_b16 a[234:235], v17 offset:25408
    v_mfma_f32_16x16x32_bf16 v[132:135], a[236:239], a[44:47], v[132:135]
    s_add_u32 m0, s23, 122880
    v_mul_f32 v174, v174, v166
    v_mfma_f32_16x16x32_bf16 v[140:143], a[240:243], a[44:47], v[140:143]
    ds_read_b64_tr_b16 a[236:237], v17 offset:30784
    ds_read_b64_tr_b16 a[238:239], v17 offset:31552
    v_mfma_f32_16x16x32_bf16 v[136:139], a[240:243], a[40:43], v[136:139]
    buffer_load_dwordx4 v2, s[8:11], s67 offen offset:0 lds
    v_mul_f32 v190, v190, v182
    v_mfma_f32_16x16x32_bf16 v[144:147], a[244:247], a[40:43], v[144:147]
    ds_read_b64_tr_b16 a[240:241], v18 offset:24640
    ds_read_b64_tr_b16 a[242:243], v18 offset:25408
    v_mfma_f32_16x16x32_bf16 v[148:151], a[244:247], a[44:47], v[148:151]
    v_mul_f32 v175, v175, v167
    v_mul_f32 v191, v191, v183
    v_mfma_f32_16x16x32_bf16 v[156:159], a[248:251], a[44:47], v[156:159]
    s_waitcnt lgkmcnt(8)
    ds_read_b64_tr_b16 a[244:245], v18 offset:30784
    ds_read_b64_tr_b16 a[246:247], v18 offset:31552
    v_mfma_f32_16x16x32_bf16 v[152:155], a[248:251], a[40:43], v[152:155]
    v_cvt_pk_bf16_f32 v164, v172, v173
    v_cvt_pk_bf16_f32 v180, v188, v189
    v_mfma_f32_16x16x32_bf16 v[64:67], a[216:219], a[48:51], v[64:67]
    ds_read_b64_tr_b16 a[248:249], v17 offset:24704
    ds_read_b64_tr_b16 a[250:251], v17 offset:25472
    v_mfma_f32_16x16x32_bf16 v[68:71], a[216:219], a[52:55], v[68:71]
    buffer_load_dwordx4 v3, s[8:11], s67 offen offset:1024 lds
    v_cvt_pk_bf16_f32 v165, v174, v175
    v_mfma_f32_16x16x32_bf16 v[76:79], a[220:223], a[52:55], v[76:79]
    ds_read_b64_tr_b16 a[216:217], v17 offset:30848
    ds_read_b64_tr_b16 a[218:219], v17 offset:31616
    v_mfma_f32_16x16x32_bf16 v[72:75], a[220:223], a[48:51], v[72:75]
    v_cvt_pk_bf16_f32 v181, v190, v191
    v_accvgpr_write_b32 a172, v164
    v_accvgpr_write_b32 a174, v180
    v_mfma_f32_16x16x32_bf16 v[80:83], a[224:227], a[48:51], v[80:83]
    s_waitcnt lgkmcnt(8)
    ds_read_b64_tr_b16 a[220:221], v18 offset:24704
    ds_read_b64_tr_b16 a[222:223], v18 offset:25472
    v_mfma_f32_16x16x32_bf16 v[84:87], a[224:227], a[52:55], v[84:87]
    buffer_load_dwordx4 v4, s[8:11], s67 offen offset:2048 lds
    v_accvgpr_write_b32 a173, v165
    v_mfma_f32_16x16x32_bf16 v[92:95], a[228:231], a[52:55], v[92:95]
    ds_read_b64_tr_b16 a[224:225], v18 offset:30848
    ds_read_b64_tr_b16 a[226:227], v18 offset:31616
    v_mfma_f32_16x16x32_bf16 v[88:91], a[228:231], a[48:51], v[88:91]
    v_accvgpr_write_b32 a175, v181
    v_mul_f32 v200, v192, v200
    v_mul_f32 v216, v208, v216
    v_mfma_f32_16x16x32_bf16 v[96:99], a[232:235], a[48:51], v[96:99]
    ds_read_b64_tr_b16 a[228:229], v17 offset:36864
    ds_read_b64_tr_b16 a[230:231], v17 offset:37632
    v_mfma_f32_16x16x32_bf16 v[100:103], a[232:235], a[52:55], v[100:103]
    v_mul_f32 v201, v193, v201
    v_mul_f32 v217, v209, v217
    v_mfma_f32_16x16x32_bf16 v[108:111], a[236:239], a[52:55], v[108:111]
    s_waitcnt lgkmcnt(8)
    ds_read_b64_tr_b16 a[232:233], v17 offset:43008
    ds_read_b64_tr_b16 a[234:235], v17 offset:43776
    v_mfma_f32_16x16x32_bf16 v[104:107], a[236:239], a[48:51], v[104:107]
    v_mul_f32 v202, v194, v202
    v_mul_f32 v218, v210, v218
    v_mfma_f32_16x16x32_bf16 v[112:115], a[240:243], a[48:51], v[112:115]
    ds_read_b64_tr_b16 a[236:237], v18 offset:36864
    ds_read_b64_tr_b16 a[238:239], v18 offset:37632
    v_mfma_f32_16x16x32_bf16 v[116:119], a[240:243], a[52:55], v[116:119]
    v_mul_f32 v203, v195, v203
    v_mul_f32 v219, v211, v219
    v_mfma_f32_16x16x32_bf16 v[124:127], a[244:247], a[52:55], v[124:127]
    ds_read_b64_tr_b16 a[240:241], v18 offset:43008
    ds_read_b64_tr_b16 a[242:243], v18 offset:43776
    v_mfma_f32_16x16x32_bf16 v[120:123], a[244:247], a[48:51], v[120:123]
    v_mul_f32 v192, s34, v192
    v_mul_f32 v208, s34, v208
    v_mfma_f32_16x16x32_bf16 v[128:131], a[248:251], a[48:51], v[128:131]
    s_waitcnt lgkmcnt(8)
    ds_read_b64_tr_b16 a[244:245], v17 offset:36928
    ds_read_b64_tr_b16 a[246:247], v17 offset:37696
    v_mfma_f32_16x16x32_bf16 v[132:135], a[248:251], a[52:55], v[132:135]
    v_mul_f32 v193, s34, v193
    v_mul_f32 v209, s34, v209
    s_add_u32 m0, s23, 135168
    v_mfma_f32_16x16x32_bf16 v[140:143], a[216:219], a[52:55], v[140:143]
    ds_read_b64_tr_b16 a[248:249], v17 offset:43072
    ds_read_b64_tr_b16 a[250:251], v17 offset:43840
    v_mfma_f32_16x16x32_bf16 v[136:139], a[216:219], a[48:51], v[136:139]
    buffer_load_dwordx4 v5, s[8:11], s67 offen offset:0 lds
    v_mul_f32 v194, s34, v194
    v_mfma_f32_16x16x32_bf16 v[144:147], a[220:223], a[48:51], v[144:147]
    ds_read_b64_tr_b16 a[216:217], v18 offset:36928
    ds_read_b64_tr_b16 a[218:219], v18 offset:37696
    v_mfma_f32_16x16x32_bf16 v[148:151], a[220:223], a[52:55], v[148:151]
    v_mul_f32 v210, s34, v210
    v_mul_f32 v195, s34, v195
    v_mul_f32 v211, s34, v211
    v_mfma_f32_16x16x32_bf16 v[156:159], a[224:227], a[52:55], v[156:159]
    s_waitcnt lgkmcnt(8)
    ds_read_b64_tr_b16 a[220:221], v18 offset:43072
    ds_read_b64_tr_b16 a[222:223], v18 offset:43840
    v_mfma_f32_16x16x32_bf16 v[152:155], a[224:227], a[48:51], v[152:155]
    v_exp_f32 v192, v192
    v_exp_f32 v208, v208
    v_mfma_f32_16x16x32_bf16 v[64:67], a[228:231], a[56:59], v[64:67]
    ds_read_b64_tr_b16 a[224:225], v17 offset:36992
    ds_read_b64_tr_b16 a[226:227], v17 offset:37760
    v_mfma_f32_16x16x32_bf16 v[68:71], a[228:231], a[60:63], v[68:71]
    buffer_load_dwordx4 v6, s[8:11], s67 offen offset:1024 lds
    v_exp_f32 v193, v193
    v_mfma_f32_16x16x32_bf16 v[76:79], a[232:235], a[60:63], v[76:79]
    ds_read_b64_tr_b16 a[228:229], v17 offset:43136
    ds_read_b64_tr_b16 a[230:231], v17 offset:43904
    v_mfma_f32_16x16x32_bf16 v[72:75], a[232:235], a[56:59], v[72:75]
    buffer_load_dwordx4 v7, s[8:11], s67 offen offset:2048 lds
    v_exp_f32 v209, v209
    v_mfma_f32_16x16x32_bf16 v[80:83], a[236:239], a[56:59], v[80:83]
    s_waitcnt lgkmcnt(8)
    ds_read_b64_tr_b16 a[232:233], v18 offset:36992
    ds_read_b64_tr_b16 a[234:235], v18 offset:37760
    v_mfma_f32_16x16x32_bf16 v[84:87], a[236:239], a[60:63], v[84:87]
    v_exp_f32 v194, v194
    v_exp_f32 v210, v210
    v_mfma_f32_16x16x32_bf16 v[92:95], a[240:243], a[60:63], v[92:95]
    s_waitcnt vmcnt(18)
    ds_read_b64_tr_b16 a[236:237], v18 offset:43136
    ds_read_b64_tr_b16 a[238:239], v18 offset:43904
    v_mfma_f32_16x16x32_bf16 v[88:91], a[240:243], a[56:59], v[88:91]
    s_barrier
    v_mfma_f32_16x16x32_bf16 v[96:99], a[244:247], a[56:59], v[96:99]
    ds_read_b64_tr_b16 a[240:241], v17 offset:49152
    ds_read_b64_tr_b16 a[242:243], v17 offset:49920
    v_mfma_f32_16x16x32_bf16 v[100:103], a[244:247], a[60:63], v[100:103]
    v_exp_f32 v195, v195
    v_exp_f32 v211, v211
    v_mfma_f32_16x16x32_bf16 v[108:111], a[248:251], a[60:63], v[108:111]
    s_waitcnt lgkmcnt(8)
    ds_read_b64_tr_b16 a[244:245], v17 offset:55296
    ds_read_b64_tr_b16 a[246:247], v17 offset:56064
    v_mfma_f32_16x16x32_bf16 v[104:107], a[248:251], a[56:59], v[104:107]
    v_add_f32 v192, 1.0, v192
    v_add_f32 v208, 1.0, v208
    v_mfma_f32_16x16x32_bf16 v[112:115], a[216:219], a[56:59], v[112:115]
    ds_read_b64_tr_b16 a[248:249], v18 offset:49152
    ds_read_b64_tr_b16 a[250:251], v18 offset:49920
    v_mfma_f32_16x16x32_bf16 v[116:119], a[216:219], a[60:63], v[116:119]
    v_add_f32 v193, 1.0, v193
    v_add_f32 v209, 1.0, v209
    v_mfma_f32_16x16x32_bf16 v[124:127], a[220:223], a[60:63], v[124:127]
    ds_read_b64_tr_b16 a[216:217], v18 offset:55296
    ds_read_b64_tr_b16 a[218:219], v18 offset:56064
    v_mfma_f32_16x16x32_bf16 v[120:123], a[220:223], a[56:59], v[120:123]
    v_add_f32 v194, 1.0, v194
    v_add_f32 v210, 1.0, v210
    v_mfma_f32_16x16x32_bf16 v[128:131], a[224:227], a[56:59], v[128:131]
    s_waitcnt lgkmcnt(8)
    ds_read_b64_tr_b16 a[220:221], v17 offset:49216
    ds_read_b64_tr_b16 a[222:223], v17 offset:49984
    v_mfma_f32_16x16x32_bf16 v[132:135], a[224:227], a[60:63], v[132:135]
    s_add_u32 m0, s23, 0
    v_add_f32 v195, 1.0, v195
    v_mfma_f32_16x16x32_bf16 v[140:143], a[228:231], a[60:63], v[140:143]
    ds_read_b64_tr_b16 a[224:225], v17 offset:55360
    ds_read_b64_tr_b16 a[226:227], v17 offset:56128
    v_mfma_f32_16x16x32_bf16 v[136:139], a[228:231], a[56:59], v[136:139]
    buffer_load_dwordx4 v2, s[8:11], s68 offen offset:0 lds
    v_add_f32 v211, 1.0, v211
    v_mfma_f32_16x16x32_bf16 v[144:147], a[232:235], a[56:59], v[144:147]
    ds_read_b64_tr_b16 a[228:229], v18 offset:49216
    ds_read_b64_tr_b16 a[230:231], v18 offset:49984
    v_mfma_f32_16x16x32_bf16 v[148:151], a[232:235], a[60:63], v[148:151]
    v_rcp_f32 v192, v192
    v_rcp_f32 v208, v208
    v_mfma_f32_16x16x32_bf16 v[156:159], a[236:239], a[60:63], v[156:159]
    s_waitcnt lgkmcnt(8)
    ds_read_b64_tr_b16 a[232:233], v18 offset:55360
    ds_read_b64_tr_b16 a[234:235], v18 offset:56128
    v_mfma_f32_16x16x32_bf16 v[152:155], a[236:239], a[56:59], v[152:155]
    buffer_load_dwordx4 v3, s[8:11], s68 offen offset:1024 lds
    v_mfma_f32_16x16x32_bf16 v[64:67], a[240:243], a[64:67], v[64:67]
    ds_read_b64_tr_b16 a[236:237], v17 offset:49280
    ds_read_b64_tr_b16 a[238:239], v17 offset:50048
    v_mfma_f32_16x16x32_bf16 v[68:71], a[240:243], a[68:71], v[68:71]
    v_rcp_f32 v193, v193
    v_rcp_f32 v209, v209
    v_mfma_f32_16x16x32_bf16 v[76:79], a[244:247], a[68:71], v[76:79]
    ds_read_b64_tr_b16 a[240:241], v17 offset:55424
    ds_read_b64_tr_b16 a[242:243], v17 offset:56192
    v_mfma_f32_16x16x32_bf16 v[72:75], a[244:247], a[64:67], v[72:75]
    buffer_load_dwordx4 v4, s[8:11], s68 offen offset:2048 lds
    v_mfma_f32_16x16x32_bf16 v[80:83], a[248:251], a[64:67], v[80:83]
    s_waitcnt lgkmcnt(8)
    ds_read_b64_tr_b16 a[244:245], v18 offset:49280
    ds_read_b64_tr_b16 a[246:247], v18 offset:50048
    v_mfma_f32_16x16x32_bf16 v[84:87], a[248:251], a[68:71], v[84:87]
    v_rcp_f32 v194, v194
    v_rcp_f32 v210, v210
    v_mfma_f32_16x16x32_bf16 v[92:95], a[216:219], a[68:71], v[92:95]
    ds_read_b64_tr_b16 a[248:249], v18 offset:55424
    ds_read_b64_tr_b16 a[250:251], v18 offset:56192
    v_mfma_f32_16x16x32_bf16 v[88:91], a[216:219], a[64:67], v[88:91]
    v_rcp_f32 v195, v195
    v_mfma_f32_16x16x32_bf16 v[96:99], a[220:223], a[64:67], v[96:99]
    ds_read_b64_tr_b16 a[216:217], v17 offset:61440
    ds_read_b64_tr_b16 a[218:219], v17 offset:62208
    v_mfma_f32_16x16x32_bf16 v[100:103], a[220:223], a[68:71], v[100:103]
    v_add_u32 v17, 61440, v17
    v_add_u32 v18, 61440, v18
    v_rcp_f32 v211, v211
    v_mfma_f32_16x16x32_bf16 v[108:111], a[224:227], a[68:71], v[108:111]
    s_waitcnt lgkmcnt(8)
    ds_read_b64_tr_b16 a[220:221], v17 offset:6144
    ds_read_b64_tr_b16 a[222:223], v17 offset:6912
    v_mfma_f32_16x16x32_bf16 v[104:107], a[224:227], a[64:67], v[104:107]
    v_mul_f32 v200, v200, v192
    v_mul_f32 v216, v216, v208
    v_mfma_f32_16x16x32_bf16 v[112:115], a[228:231], a[64:67], v[112:115]
    ds_read_b64_tr_b16 a[224:225], v18 offset:0
    ds_read_b64_tr_b16 a[226:227], v18 offset:768
    v_mfma_f32_16x16x32_bf16 v[116:119], a[228:231], a[68:71], v[116:119]
    v_mul_f32 v201, v201, v193
    v_mul_f32 v217, v217, v209
    v_mfma_f32_16x16x32_bf16 v[124:127], a[232:235], a[68:71], v[124:127]
    ds_read_b64_tr_b16 a[228:229], v18 offset:6144
    ds_read_b64_tr_b16 a[230:231], v18 offset:6912
    v_mfma_f32_16x16x32_bf16 v[120:123], a[232:235], a[64:67], v[120:123]
    v_mul_f32 v202, v202, v194
    v_mul_f32 v218, v218, v210
    v_mfma_f32_16x16x32_bf16 v[128:131], a[236:239], a[64:67], v[128:131]
    s_waitcnt lgkmcnt(8)
    ds_read_b64_tr_b16 a[232:233], v17 offset:64
    ds_read_b64_tr_b16 a[234:235], v17 offset:832
    v_mfma_f32_16x16x32_bf16 v[132:135], a[236:239], a[68:71], v[132:135]
    s_add_u32 m0, s23, 12288
    v_mul_f32 v203, v203, v195
    v_mfma_f32_16x16x32_bf16 v[140:143], a[240:243], a[68:71], v[140:143]
    ds_read_b64_tr_b16 a[236:237], v17 offset:6208
    ds_read_b64_tr_b16 a[238:239], v17 offset:6976
    v_mfma_f32_16x16x32_bf16 v[136:139], a[240:243], a[64:67], v[136:139]
    buffer_load_dwordx4 v5, s[8:11], s68 offen offset:0 lds
    v_mul_f32 v219, v219, v211
    v_mfma_f32_16x16x32_bf16 v[144:147], a[244:247], a[64:67], v[144:147]
    ds_read_b64_tr_b16 a[240:241], v18 offset:64
    ds_read_b64_tr_b16 a[242:243], v18 offset:832
    v_mfma_f32_16x16x32_bf16 v[148:151], a[244:247], a[68:71], v[148:151]
    v_cvt_pk_bf16_f32 v192, v200, v201
    v_cvt_pk_bf16_f32 v208, v216, v217
    v_cvt_pk_bf16_f32 v193, v202, v203
    v_mfma_f32_16x16x32_bf16 v[156:159], a[248:251], a[68:71], v[156:159]
    s_waitcnt lgkmcnt(8)
    ds_read_b64_tr_b16 a[244:245], v18 offset:6208
    ds_read_b64_tr_b16 a[246:247], v18 offset:6976
    v_mfma_f32_16x16x32_bf16 v[152:155], a[248:251], a[64:67], v[152:155]
    buffer_load_dwordx4 v6, s[8:11], s68 offen offset:1024 lds
    v_cvt_pk_bf16_f32 v209, v218, v219
    v_mfma_f32_16x16x32_bf16 v[64:67], a[216:219], a[72:75], v[64:67]
    ds_read_b64_tr_b16 a[248:249], v17 offset:128
    ds_read_b64_tr_b16 a[250:251], v17 offset:896
    v_mfma_f32_16x16x32_bf16 v[68:71], a[216:219], a[76:79], v[68:71]
    v_accvgpr_write_b32 a176, v192
    v_accvgpr_write_b32 a178, v208
    v_accvgpr_write_b32 a177, v193
    v_mfma_f32_16x16x32_bf16 v[76:79], a[220:223], a[76:79], v[76:79]
    ds_read_b64_tr_b16 a[216:217], v17 offset:6272
    ds_read_b64_tr_b16 a[218:219], v17 offset:7040
    v_mfma_f32_16x16x32_bf16 v[72:75], a[220:223], a[72:75], v[72:75]
    buffer_load_dwordx4 v7, s[8:11], s68 offen offset:2048 lds
    v_accvgpr_write_b32 a179, v209
    v_mfma_f32_16x16x32_bf16 v[80:83], a[224:227], a[72:75], v[80:83]
    s_waitcnt lgkmcnt(8)
    ds_read_b64_tr_b16 a[220:221], v18 offset:128
    ds_read_b64_tr_b16 a[222:223], v18 offset:896
    v_mfma_f32_16x16x32_bf16 v[84:87], a[224:227], a[76:79], v[84:87]
    v_mul_f32 v204, v196, v204
    v_mul_f32 v220, v212, v220
    v_mul_f32 v205, v197, v205
    v_mfma_f32_16x16x32_bf16 v[92:95], a[228:231], a[76:79], v[92:95]
    s_waitcnt vmcnt(18)
    ds_read_b64_tr_b16 a[224:225], v18 offset:6272
    ds_read_b64_tr_b16 a[226:227], v18 offset:7040
    v_mfma_f32_16x16x32_bf16 v[88:91], a[228:231], a[72:75], v[88:91]
    s_barrier
    v_mfma_f32_16x16x32_bf16 v[96:99], a[232:235], a[72:75], v[96:99]
    ds_read_b64_tr_b16 a[228:229], v17 offset:12288
    ds_read_b64_tr_b16 a[230:231], v17 offset:13056
    v_mfma_f32_16x16x32_bf16 v[100:103], a[232:235], a[76:79], v[100:103]
    v_mul_f32 v221, v213, v221
    v_mul_f32 v206, v198, v206
    v_mul_f32 v222, v214, v222
    v_mfma_f32_16x16x32_bf16 v[108:111], a[236:239], a[76:79], v[108:111]
    s_waitcnt lgkmcnt(8)
    ds_read_b64_tr_b16 a[232:233], v17 offset:18432
    ds_read_b64_tr_b16 a[234:235], v17 offset:19200
    v_mfma_f32_16x16x32_bf16 v[104:107], a[236:239], a[72:75], v[104:107]
    v_mul_f32 v207, v199, v207
    v_mul_f32 v223, v215, v223
    v_mul_f32 v196, s34, v196
    v_mfma_f32_16x16x32_bf16 v[112:115], a[240:243], a[72:75], v[112:115]
    ds_read_b64_tr_b16 a[236:237], v18 offset:12288
    ds_read_b64_tr_b16 a[238:239], v18 offset:13056
    v_mfma_f32_16x16x32_bf16 v[116:119], a[240:243], a[76:79], v[116:119]
    v_mul_f32 v212, s34, v212
    v_mul_f32 v197, s34, v197
    v_mul_f32 v213, s34, v213
    v_mfma_f32_16x16x32_bf16 v[124:127], a[244:247], a[76:79], v[124:127]
    ds_read_b64_tr_b16 a[240:241], v18 offset:18432
    ds_read_b64_tr_b16 a[242:243], v18 offset:19200
    v_mfma_f32_16x16x32_bf16 v[120:123], a[244:247], a[72:75], v[120:123]
    v_mul_f32 v198, s34, v198
    v_mul_f32 v214, s34, v214
    v_mfma_f32_16x16x32_bf16 v[128:131], a[248:251], a[72:75], v[128:131]
    s_waitcnt lgkmcnt(8)
    ds_read_b64_tr_b16 a[244:245], v17 offset:12352
    ds_read_b64_tr_b16 a[246:247], v17 offset:13120
    v_mfma_f32_16x16x32_bf16 v[132:135], a[248:251], a[76:79], v[132:135]
    v_mul_f32 v199, s34, v199
    v_mul_f32 v215, s34, v215
    v_mfma_f32_16x16x32_bf16 v[140:143], a[216:219], a[76:79], v[140:143]
    ds_read_b64_tr_b16 a[248:249], v17 offset:18496
    ds_read_b64_tr_b16 a[250:251], v17 offset:19264
    v_mfma_f32_16x16x32_bf16 v[136:139], a[216:219], a[72:75], v[136:139]
    v_exp_f32 v196, v196
    v_exp_f32 v212, v212
    v_mfma_f32_16x16x32_bf16 v[144:147], a[220:223], a[72:75], v[144:147]
    ds_read_b64_tr_b16 a[216:217], v18 offset:12352
    ds_read_b64_tr_b16 a[218:219], v18 offset:13120
    v_mfma_f32_16x16x32_bf16 v[148:151], a[220:223], a[76:79], v[148:151]
    s_add_u32 m0, s23, 24576
    v_mfma_f32_16x16x32_bf16 v[156:159], a[224:227], a[76:79], v[156:159]
    s_waitcnt lgkmcnt(8)
    ds_read_b64_tr_b16 a[220:221], v18 offset:18496
    ds_read_b64_tr_b16 a[222:223], v18 offset:19264
    v_mfma_f32_16x16x32_bf16 v[152:155], a[224:227], a[72:75], v[152:155]
    buffer_load_dwordx4 v8, s[12:15], s69 offen offset:0 lds
    v_exp_f32 v197, v197
    v_mfma_f32_16x16x32_bf16 v[64:67], a[228:231], a[80:83], v[64:67]
    ds_read_b64_tr_b16 a[224:225], v17 offset:12416
    ds_read_b64_tr_b16 a[226:227], v17 offset:13184
    v_mfma_f32_16x16x32_bf16 v[68:71], a[228:231], a[84:87], v[68:71]
    v_exp_f32 v213, v213
    v_mfma_f32_16x16x32_bf16 v[76:79], a[232:235], a[84:87], v[76:79]
    ds_read_b64_tr_b16 a[228:229], v17 offset:18560
    ds_read_b64_tr_b16 a[230:231], v17 offset:19328
    v_mfma_f32_16x16x32_bf16 v[72:75], a[232:235], a[80:83], v[72:75]
    buffer_load_dwordx4 v9, s[12:15], s69 offen offset:1024 lds
    v_exp_f32 v198, v198
    v_mfma_f32_16x16x32_bf16 v[80:83], a[236:239], a[80:83], v[80:83]
    s_waitcnt lgkmcnt(8)
    ds_read_b64_tr_b16 a[232:233], v18 offset:12416
    ds_read_b64_tr_b16 a[234:235], v18 offset:13184
    v_mfma_f32_16x16x32_bf16 v[84:87], a[236:239], a[84:87], v[84:87]
    buffer_load_dwordx4 v10, s[12:15], s69 offen offset:2048 lds
    v_exp_f32 v214, v214
    v_mfma_f32_16x16x32_bf16 v[92:95], a[240:243], a[84:87], v[92:95]
    ds_read_b64_tr_b16 a[236:237], v18 offset:18560
    ds_read_b64_tr_b16 a[238:239], v18 offset:19328
    v_mfma_f32_16x16x32_bf16 v[88:91], a[240:243], a[80:83], v[88:91]
    v_exp_f32 v199, v199
    v_exp_f32 v215, v215
    v_mfma_f32_16x16x32_bf16 v[96:99], a[244:247], a[80:83], v[96:99]
    ds_read_b64_tr_b16 a[240:241], v17 offset:24576
    ds_read_b64_tr_b16 a[242:243], v17 offset:25344
    v_mfma_f32_16x16x32_bf16 v[100:103], a[244:247], a[84:87], v[100:103]
    v_add_f32 v196, 1.0, v196
    v_add_f32 v212, 1.0, v212
    v_mfma_f32_16x16x32_bf16 v[108:111], a[248:251], a[84:87], v[108:111]
    s_waitcnt lgkmcnt(8)
    ds_read_b64_tr_b16 a[244:245], v17 offset:30720
    ds_read_b64_tr_b16 a[246:247], v17 offset:31488
    v_mfma_f32_16x16x32_bf16 v[104:107], a[248:251], a[80:83], v[104:107]
    v_add_f32 v197, 1.0, v197
    v_add_f32 v213, 1.0, v213
    v_mfma_f32_16x16x32_bf16 v[112:115], a[216:219], a[80:83], v[112:115]
    ds_read_b64_tr_b16 a[248:249], v18 offset:24576
    ds_read_b64_tr_b16 a[250:251], v18 offset:25344
    v_mfma_f32_16x16x32_bf16 v[116:119], a[216:219], a[84:87], v[116:119]
    v_add_f32 v198, 1.0, v198
    v_add_f32 v214, 1.0, v214
    v_mfma_f32_16x16x32_bf16 v[124:127], a[220:223], a[84:87], v[124:127]
    ds_read_b64_tr_b16 a[216:217], v18 offset:30720
    ds_read_b64_tr_b16 a[218:219], v18 offset:31488
    v_mfma_f32_16x16x32_bf16 v[120:123], a[220:223], a[80:83], v[120:123]
    v_add_f32 v199, 1.0, v199
    v_add_f32 v215, 1.0, v215
    v_mfma_f32_16x16x32_bf16 v[128:131], a[224:227], a[80:83], v[128:131]
    s_waitcnt lgkmcnt(8)
    ds_read_b64_tr_b16 a[220:221], v17 offset:24640
    ds_read_b64_tr_b16 a[222:223], v17 offset:25408
    v_mfma_f32_16x16x32_bf16 v[132:135], a[224:227], a[84:87], v[132:135]
    s_add_u32 m0, s23, 36864
    v_mfma_f32_16x16x32_bf16 v[140:143], a[228:231], a[84:87], v[140:143]
    ds_read_b64_tr_b16 a[224:225], v17 offset:30784
    ds_read_b64_tr_b16 a[226:227], v17 offset:31552
    v_mfma_f32_16x16x32_bf16 v[136:139], a[228:231], a[80:83], v[136:139]
    buffer_load_dwordx4 v11, s[12:15], s69 offen offset:0 lds
    v_rcp_f32 v196, v196
    v_mfma_f32_16x16x32_bf16 v[144:147], a[232:235], a[80:83], v[144:147]
    ds_read_b64_tr_b16 a[228:229], v18 offset:24640
    ds_read_b64_tr_b16 a[230:231], v18 offset:25408
    v_mfma_f32_16x16x32_bf16 v[148:151], a[232:235], a[84:87], v[148:151]
    v_rcp_f32 v212, v212
    v_mfma_f32_16x16x32_bf16 v[156:159], a[236:239], a[84:87], v[156:159]
    s_waitcnt lgkmcnt(8)
    ds_read_b64_tr_b16 a[232:233], v18 offset:30784
    ds_read_b64_tr_b16 a[234:235], v18 offset:31552
    v_mfma_f32_16x16x32_bf16 v[152:155], a[236:239], a[80:83], v[152:155]
    buffer_load_dwordx4 v12, s[12:15], s69 offen offset:1024 lds
    v_rcp_f32 v197, v197
    v_mfma_f32_16x16x32_bf16 v[64:67], a[240:243], a[88:91], v[64:67]
    ds_read_b64_tr_b16 a[236:237], v17 offset:24704
    ds_read_b64_tr_b16 a[238:239], v17 offset:25472
    v_mfma_f32_16x16x32_bf16 v[68:71], a[240:243], a[92:95], v[68:71]
    v_rcp_f32 v213, v213
    v_rcp_f32 v198, v198
    v_mfma_f32_16x16x32_bf16 v[76:79], a[244:247], a[92:95], v[76:79]
    ds_read_b64_tr_b16 a[240:241], v17 offset:30848
    ds_read_b64_tr_b16 a[242:243], v17 offset:31616
    v_mfma_f32_16x16x32_bf16 v[72:75], a[244:247], a[88:91], v[72:75]
    buffer_load_dwordx4 v13, s[12:15], s69 offen offset:2048 lds
    v_rcp_f32 v214, v214
    v_mfma_f32_16x16x32_bf16 v[80:83], a[248:251], a[88:91], v[80:83]
    s_waitcnt lgkmcnt(8)
    ds_read_b64_tr_b16 a[244:245], v18 offset:24704
    ds_read_b64_tr_b16 a[246:247], v18 offset:25472
    v_mfma_f32_16x16x32_bf16 v[84:87], a[248:251], a[92:95], v[84:87]
    v_rcp_f32 v199, v199
    v_rcp_f32 v215, v215
    v_mfma_f32_16x16x32_bf16 v[92:95], a[216:219], a[92:95], v[92:95]
    s_waitcnt vmcnt(18)
    ds_read_b64_tr_b16 a[248:249], v18 offset:30848
    ds_read_b64_tr_b16 a[250:251], v18 offset:31616
    v_mfma_f32_16x16x32_bf16 v[88:91], a[216:219], a[88:91], v[88:91]
    s_barrier
    v_mfma_f32_16x16x32_bf16 v[96:99], a[220:223], a[88:91], v[96:99]
    ds_read_b64_tr_b16 a[216:217], v17 offset:36864
    ds_read_b64_tr_b16 a[218:219], v17 offset:37632
    v_mfma_f32_16x16x32_bf16 v[100:103], a[220:223], a[92:95], v[100:103]
    v_mul_f32 v204, v204, v196
    v_mul_f32 v220, v220, v212
    v_mfma_f32_16x16x32_bf16 v[108:111], a[224:227], a[92:95], v[108:111]
    s_waitcnt lgkmcnt(8)
    ds_read_b64_tr_b16 a[220:221], v17 offset:43008
    ds_read_b64_tr_b16 a[222:223], v17 offset:43776
    v_mfma_f32_16x16x32_bf16 v[104:107], a[224:227], a[88:91], v[104:107]
    v_mul_f32 v205, v205, v197
    v_mul_f32 v221, v221, v213
    v_mfma_f32_16x16x32_bf16 v[112:115], a[228:231], a[88:91], v[112:115]
    ds_read_b64_tr_b16 a[224:225], v18 offset:36864
    ds_read_b64_tr_b16 a[226:227], v18 offset:37632
    v_mfma_f32_16x16x32_bf16 v[116:119], a[228:231], a[92:95], v[116:119]
    v_mul_f32 v206, v206, v198
    v_mul_f32 v222, v222, v214
    v_mfma_f32_16x16x32_bf16 v[124:127], a[232:235], a[92:95], v[124:127]
    ds_read_b64_tr_b16 a[228:229], v18 offset:43008
    ds_read_b64_tr_b16 a[230:231], v18 offset:43776
    v_mfma_f32_16x16x32_bf16 v[120:123], a[232:235], a[88:91], v[120:123]
    v_mul_f32 v207, v207, v199
    v_mul_f32 v223, v223, v215
    v_mfma_f32_16x16x32_bf16 v[128:131], a[236:239], a[88:91], v[128:131]
    s_waitcnt lgkmcnt(8)
    ds_read_b64_tr_b16 a[232:233], v17 offset:36928
    ds_read_b64_tr_b16 a[234:235], v17 offset:37696
    v_mfma_f32_16x16x32_bf16 v[132:135], a[236:239], a[92:95], v[132:135]
    v_cvt_pk_bf16_f32 v196, v204, v205
    v_cvt_pk_bf16_f32 v212, v220, v221
    v_mfma_f32_16x16x32_bf16 v[140:143], a[240:243], a[92:95], v[140:143]
    ds_read_b64_tr_b16 a[236:237], v17 offset:43072
    ds_read_b64_tr_b16 a[238:239], v17 offset:43840
    v_mfma_f32_16x16x32_bf16 v[136:139], a[240:243], a[88:91], v[136:139]
    v_cvt_pk_bf16_f32 v197, v206, v207
    v_cvt_pk_bf16_f32 v213, v222, v223
    s_add_u32 m0, s23, 49152
    v_mfma_f32_16x16x32_bf16 v[144:147], a[244:247], a[88:91], v[144:147]
    ds_read_b64_tr_b16 a[240:241], v18 offset:36928
    ds_read_b64_tr_b16 a[242:243], v18 offset:37696
    v_mfma_f32_16x16x32_bf16 v[148:151], a[244:247], a[92:95], v[148:151]
    buffer_load_dwordx4 v8, s[12:15], s70 offen offset:0 lds
    v_accvgpr_write_b32 a180, v196
    v_mfma_f32_16x16x32_bf16 v[156:159], a[248:251], a[92:95], v[156:159]
    s_waitcnt lgkmcnt(8)
    ds_read_b64_tr_b16 a[244:245], v18 offset:43072
    ds_read_b64_tr_b16 a[246:247], v18 offset:43840
    v_mfma_f32_16x16x32_bf16 v[152:155], a[248:251], a[88:91], v[152:155]
    v_accvgpr_write_b32 a182, v212
    v_accvgpr_write_b32 a181, v197
    v_accvgpr_write_b32 a183, v213
    v_mfma_f32_16x16x32_bf16 v[64:67], a[216:219], a[96:99], v[64:67]
    ds_read_b64_tr_b16 a[248:249], v17 offset:36992
    ds_read_b64_tr_b16 a[250:251], v17 offset:37760
    v_mfma_f32_16x16x32_bf16 v[68:71], a[216:219], a[100:103], v[68:71]
    buffer_load_dwordx4 v9, s[12:15], s70 offen offset:1024 lds
    v_mul_f32 v232, v224, v232
    v_mfma_f32_16x16x32_bf16 v[76:79], a[220:223], a[100:103], v[76:79]
    ds_read_b64_tr_b16 a[216:217], v17 offset:43136
    ds_read_b64_tr_b16 a[218:219], v17 offset:43904
    v_mfma_f32_16x16x32_bf16 v[72:75], a[220:223], a[96:99], v[72:75]
    v_mul_f32 v248, v240, v248
    v_mul_f32 v233, v225, v233
    v_mul_f32 v249, v241, v249
    v_mfma_f32_16x16x32_bf16 v[80:83], a[224:227], a[96:99], v[80:83]
    s_waitcnt lgkmcnt(8)
    ds_read_b64_tr_b16 a[220:221], v18 offset:36992
    ds_read_b64_tr_b16 a[222:223], v18 offset:37760
    v_mfma_f32_16x16x32_bf16 v[84:87], a[224:227], a[100:103], v[84:87]
    buffer_load_dwordx4 v10, s[12:15], s70 offen offset:2048 lds
    v_mul_f32 v234, v226, v234
    v_mfma_f32_16x16x32_bf16 v[92:95], a[228:231], a[100:103], v[92:95]
    ds_read_b64_tr_b16 a[224:225], v18 offset:43136
    ds_read_b64_tr_b16 a[226:227], v18 offset:43904
    v_mfma_f32_16x16x32_bf16 v[88:91], a[228:231], a[96:99], v[88:91]
    v_mul_f32 v250, v242, v250
    v_mul_f32 v235, v227, v235
    v_mul_f32 v251, v243, v251
    v_mfma_f32_16x16x32_bf16 v[96:99], a[232:235], a[96:99], v[96:99]
    ds_read_b64_tr_b16 a[228:229], v17 offset:49152
    ds_read_b64_tr_b16 a[230:231], v17 offset:49920
    v_mfma_f32_16x16x32_bf16 v[100:103], a[232:235], a[100:103], v[100:103]
    v_mul_f32 v224, s34, v224
    v_mul_f32 v240, s34, v240
    v_mfma_f32_16x16x32_bf16 v[108:111], a[236:239], a[100:103], v[108:111]
    s_waitcnt lgkmcnt(8)
    ds_read_b64_tr_b16 a[232:233], v17 offset:55296
    ds_read_b64_tr_b16 a[234:235], v17 offset:56064
    v_mfma_f32_16x16x32_bf16 v[104:107], a[236:239], a[96:99], v[104:107]
    v_mul_f32 v225, s34, v225
    v_mul_f32 v241, s34, v241
    v_mfma_f32_16x16x32_bf16 v[112:115], a[240:243], a[96:99], v[112:115]
    ds_read_b64_tr_b16 a[236:237], v18 offset:49152
    ds_read_b64_tr_b16 a[238:239], v18 offset:49920
    v_mfma_f32_16x16x32_bf16 v[116:119], a[240:243], a[100:103], v[116:119]
    v_mul_f32 v226, s34, v226
    v_mul_f32 v242, s34, v242
    v_mfma_f32_16x16x32_bf16 v[124:127], a[244:247], a[100:103], v[124:127]
    ds_read_b64_tr_b16 a[240:241], v18 offset:55296
    ds_read_b64_tr_b16 a[242:243], v18 offset:56064
    v_mfma_f32_16x16x32_bf16 v[120:123], a[244:247], a[96:99], v[120:123]
    v_mul_f32 v227, s34, v227
    v_mul_f32 v243, s34, v243
    v_mfma_f32_16x16x32_bf16 v[128:131], a[248:251], a[96:99], v[128:131]
    s_waitcnt lgkmcnt(8)
    ds_read_b64_tr_b16 a[244:245], v17 offset:49216
    ds_read_b64_tr_b16 a[246:247], v17 offset:49984
    v_mfma_f32_16x16x32_bf16 v[132:135], a[248:251], a[100:103], v[132:135]
    v_exp_f32 v224, v224
    v_exp_f32 v240, v240
    v_mfma_f32_16x16x32_bf16 v[140:143], a[216:219], a[100:103], v[140:143]
    ds_read_b64_tr_b16 a[248:249], v17 offset:55360
    ds_read_b64_tr_b16 a[250:251], v17 offset:56128
    v_mfma_f32_16x16x32_bf16 v[136:139], a[216:219], a[96:99], v[136:139]
    s_add_u32 m0, s23, 61440
    v_mfma_f32_16x16x32_bf16 v[144:147], a[220:223], a[96:99], v[144:147]
    ds_read_b64_tr_b16 a[216:217], v18 offset:49216
    ds_read_b64_tr_b16 a[218:219], v18 offset:49984
    v_mfma_f32_16x16x32_bf16 v[148:151], a[220:223], a[100:103], v[148:151]
    buffer_load_dwordx4 v11, s[12:15], s70 offen offset:0 lds
    v_exp_f32 v225, v225
    v_mfma_f32_16x16x32_bf16 v[156:159], a[224:227], a[100:103], v[156:159]
    s_waitcnt lgkmcnt(8)
    ds_read_b64_tr_b16 a[220:221], v18 offset:55360
    ds_read_b64_tr_b16 a[222:223], v18 offset:56128
    v_mfma_f32_16x16x32_bf16 v[152:155], a[224:227], a[96:99], v[152:155]
    v_exp_f32 v241, v241
    v_mfma_f32_16x16x32_bf16 v[64:67], a[228:231], a[104:107], v[64:67]
    ds_read_b64_tr_b16 a[224:225], v17 offset:49280
    ds_read_b64_tr_b16 a[226:227], v17 offset:50048
    v_mfma_f32_16x16x32_bf16 v[68:71], a[228:231], a[108:111], v[68:71]
    buffer_load_dwordx4 v12, s[12:15], s70 offen offset:1024 lds
    v_exp_f32 v226, v226
    v_mfma_f32_16x16x32_bf16 v[76:79], a[232:235], a[108:111], v[76:79]
    ds_read_b64_tr_b16 a[228:229], v17 offset:55424
    ds_read_b64_tr_b16 a[230:231], v17 offset:56192
    v_mfma_f32_16x16x32_bf16 v[72:75], a[232:235], a[104:107], v[72:75]
    buffer_load_dwordx4 v13, s[12:15], s70 offen offset:2048 lds
    v_exp_f32 v242, v242
    v_mfma_f32_16x16x32_bf16 v[80:83], a[236:239], a[104:107], v[80:83]
    s_waitcnt lgkmcnt(8)
    ds_read_b64_tr_b16 a[232:233], v18 offset:49280
    ds_read_b64_tr_b16 a[234:235], v18 offset:50048
    v_mfma_f32_16x16x32_bf16 v[84:87], a[236:239], a[108:111], v[84:87]
    v_exp_f32 v227, v227
    v_exp_f32 v243, v243
    v_mfma_f32_16x16x32_bf16 v[92:95], a[240:243], a[108:111], v[92:95]
    s_waitcnt vmcnt(18)
    ds_read_b64_tr_b16 a[236:237], v18 offset:55424
    ds_read_b64_tr_b16 a[238:239], v18 offset:56192
    v_mfma_f32_16x16x32_bf16 v[88:91], a[240:243], a[104:107], v[88:91]
    s_barrier
    v_mfma_f32_16x16x32_bf16 v[96:99], a[244:247], a[104:107], v[96:99]
    ds_read_b64_tr_b16 a[240:241], v17 offset:61440
    ds_read_b64_tr_b16 a[242:243], v17 offset:62208
    v_mfma_f32_16x16x32_bf16 v[100:103], a[244:247], a[108:111], v[100:103]
    v_add_u32 v17, 61440, v17
    v_add_u32 v18, 61440, v18
    v_add_f32 v224, 1.0, v224
    v_mfma_f32_16x16x32_bf16 v[108:111], a[248:251], a[108:111], v[108:111]
    s_waitcnt lgkmcnt(8)
    ds_read_b64_tr_b16 a[244:245], v17 offset:6144
    ds_read_b64_tr_b16 a[246:247], v17 offset:6912
    v_mfma_f32_16x16x32_bf16 v[104:107], a[248:251], a[104:107], v[104:107]
    v_add_f32 v240, 1.0, v240
    v_add_f32 v225, 1.0, v225
    v_add_f32 v241, 1.0, v241
    v_mfma_f32_16x16x32_bf16 v[112:115], a[216:219], a[104:107], v[112:115]
    ds_read_b64_tr_b16 a[248:249], v18 offset:0
    ds_read_b64_tr_b16 a[250:251], v18 offset:768
    v_mfma_f32_16x16x32_bf16 v[116:119], a[216:219], a[108:111], v[116:119]
    v_add_f32 v226, 1.0, v226
    v_add_f32 v242, 1.0, v242
    v_add_f32 v227, 1.0, v227
    v_mfma_f32_16x16x32_bf16 v[124:127], a[220:223], a[108:111], v[124:127]
    ds_read_b64_tr_b16 a[216:217], v18 offset:6144
    ds_read_b64_tr_b16 a[218:219], v18 offset:6912
    v_mfma_f32_16x16x32_bf16 v[120:123], a[220:223], a[104:107], v[120:123]
    v_add_f32 v243, 1.0, v243
    s_add_u32 m0, s23, 73728
    v_rcp_f32 v224, v224
    v_mfma_f32_16x16x32_bf16 v[128:131], a[224:227], a[104:107], v[128:131]
    s_waitcnt lgkmcnt(8)
    ds_read_b64_tr_b16 a[220:221], v17 offset:64
    ds_read_b64_tr_b16 a[222:223], v17 offset:832
    v_mfma_f32_16x16x32_bf16 v[132:135], a[224:227], a[108:111], v[132:135]
    v_rcp_f32 v240, v240
    v_mfma_f32_16x16x32_bf16 v[140:143], a[228:231], a[108:111], v[140:143]
    ds_read_b64_tr_b16 a[224:225], v17 offset:6208
    ds_read_b64_tr_b16 a[226:227], v17 offset:6976
    v_mfma_f32_16x16x32_bf16 v[136:139], a[228:231], a[104:107], v[136:139]
    buffer_load_dwordx4 v8, s[12:15], s71 offen offset:0 lds
    v_rcp_f32 v225, v225
    v_mfma_f32_16x16x32_bf16 v[144:147], a[232:235], a[104:107], v[144:147]
    ds_read_b64_tr_b16 a[228:229], v18 offset:64
    ds_read_b64_tr_b16 a[230:231], v18 offset:832
    v_mfma_f32_16x16x32_bf16 v[148:151], a[232:235], a[108:111], v[148:151]
    v_rcp_f32 v241, v241
    v_mfma_f32_16x16x32_bf16 v[156:159], a[236:239], a[108:111], v[156:159]
    s_waitcnt lgkmcnt(8)
    ds_read_b64_tr_b16 a[232:233], v18 offset:6208
    ds_read_b64_tr_b16 a[234:235], v18 offset:6976
    v_mfma_f32_16x16x32_bf16 v[152:155], a[236:239], a[104:107], v[152:155]
    buffer_load_dwordx4 v9, s[12:15], s71 offen offset:1024 lds
    v_rcp_f32 v226, v226
    v_mfma_f32_16x16x32_bf16 v[64:67], a[240:243], a[112:115], v[64:67]
    ds_read_b64_tr_b16 a[236:237], v17 offset:128
    ds_read_b64_tr_b16 a[238:239], v17 offset:896
    v_mfma_f32_16x16x32_bf16 v[68:71], a[240:243], a[116:119], v[68:71]
    v_rcp_f32 v242, v242
    v_mfma_f32_16x16x32_bf16 v[76:79], a[244:247], a[116:119], v[76:79]
    ds_read_b64_tr_b16 a[240:241], v17 offset:6272
    ds_read_b64_tr_b16 a[242:243], v17 offset:7040
    v_mfma_f32_16x16x32_bf16 v[72:75], a[244:247], a[112:115], v[72:75]
    v_rcp_f32 v227, v227
    v_rcp_f32 v243, v243
    v_mfma_f32_16x16x32_bf16 v[80:83], a[248:251], a[112:115], v[80:83]
    s_waitcnt lgkmcnt(8)
    ds_read_b64_tr_b16 a[244:245], v18 offset:128
    ds_read_b64_tr_b16 a[246:247], v18 offset:896
    v_mfma_f32_16x16x32_bf16 v[84:87], a[248:251], a[116:119], v[84:87]
    buffer_load_dwordx4 v10, s[12:15], s71 offen offset:2048 lds
    v_mfma_f32_16x16x32_bf16 v[92:95], a[216:219], a[116:119], v[92:95]
    ds_read_b64_tr_b16 a[248:249], v18 offset:6272
    ds_read_b64_tr_b16 a[250:251], v18 offset:7040
    v_mfma_f32_16x16x32_bf16 v[88:91], a[216:219], a[112:115], v[88:91]
    v_mul_f32 v232, v232, v224
    v_mul_f32 v248, v248, v240
    v_mfma_f32_16x16x32_bf16 v[96:99], a[220:223], a[112:115], v[96:99]
    ds_read_b64_tr_b16 a[216:217], v17 offset:12288
    ds_read_b64_tr_b16 a[218:219], v17 offset:13056
    v_mfma_f32_16x16x32_bf16 v[100:103], a[220:223], a[116:119], v[100:103]
    v_mul_f32 v233, v233, v225
    v_mul_f32 v249, v249, v241
    v_mfma_f32_16x16x32_bf16 v[108:111], a[224:227], a[116:119], v[108:111]
    s_waitcnt lgkmcnt(8)
    ds_read_b64_tr_b16 a[220:221], v17 offset:18432
    ds_read_b64_tr_b16 a[222:223], v17 offset:19200
    v_mfma_f32_16x16x32_bf16 v[104:107], a[224:227], a[112:115], v[104:107]
    v_mul_f32 v234, v234, v226
    v_mul_f32 v250, v250, v242
    v_mfma_f32_16x16x32_bf16 v[112:115], a[228:231], a[112:115], v[112:115]
    ds_read_b64_tr_b16 a[224:225], v18 offset:12288
    ds_read_b64_tr_b16 a[226:227], v18 offset:13056
    v_mfma_f32_16x16x32_bf16 v[116:119], a[228:231], a[116:119], v[116:119]
    v_mul_f32 v235, v235, v227
    v_mul_f32 v251, v251, v243
    v_mfma_f32_16x16x32_bf16 v[124:127], a[232:235], a[116:119], v[124:127]
    ds_read_b64_tr_b16 a[228:229], v18 offset:18432
    ds_read_b64_tr_b16 a[230:231], v18 offset:19200
    v_mfma_f32_16x16x32_bf16 v[120:123], a[232:235], a[112:115], v[120:123]
    v_cvt_pk_bf16_f32 v224, v232, v233
    v_cvt_pk_bf16_f32 v240, v248, v249
    v_mfma_f32_16x16x32_bf16 v[128:131], a[236:239], a[112:115], v[128:131]
    s_waitcnt lgkmcnt(8)
    ds_read_b64_tr_b16 a[232:233], v17 offset:12352
    ds_read_b64_tr_b16 a[234:235], v17 offset:13120
    v_mfma_f32_16x16x32_bf16 v[132:135], a[236:239], a[116:119], v[132:135]
    v_cvt_pk_bf16_f32 v225, v234, v235
    v_cvt_pk_bf16_f32 v241, v250, v251
    s_add_u32 m0, s23, 86016
    v_mfma_f32_16x16x32_bf16 v[140:143], a[240:243], a[116:119], v[140:143]
    ds_read_b64_tr_b16 a[236:237], v17 offset:18496
    ds_read_b64_tr_b16 a[238:239], v17 offset:19264
    v_mfma_f32_16x16x32_bf16 v[136:139], a[240:243], a[112:115], v[136:139]
    buffer_load_dwordx4 v11, s[12:15], s71 offen offset:0 lds
    v_accvgpr_write_b32 a184, v224
    v_mfma_f32_16x16x32_bf16 v[144:147], a[244:247], a[112:115], v[144:147]
    ds_read_b64_tr_b16 a[240:241], v18 offset:12352
    ds_read_b64_tr_b16 a[242:243], v18 offset:13120
    v_mfma_f32_16x16x32_bf16 v[148:151], a[244:247], a[116:119], v[148:151]
    v_accvgpr_write_b32 a186, v240
    v_accvgpr_write_b32 a185, v225
    v_accvgpr_write_b32 a187, v241
    v_mfma_f32_16x16x32_bf16 v[156:159], a[248:251], a[116:119], v[156:159]
    s_waitcnt lgkmcnt(8)
    ds_read_b64_tr_b16 a[244:245], v18 offset:18496
    ds_read_b64_tr_b16 a[246:247], v18 offset:19264
    v_mfma_f32_16x16x32_bf16 v[152:155], a[248:251], a[112:115], v[152:155]
    buffer_load_dwordx4 v12, s[12:15], s71 offen offset:1024 lds
    v_mul_f32 v236, v228, v236
    v_mfma_f32_16x16x32_bf16 v[64:67], a[216:219], a[120:123], v[64:67]
    ds_read_b64_tr_b16 a[248:249], v17 offset:12416
    ds_read_b64_tr_b16 a[250:251], v17 offset:13184
    v_mfma_f32_16x16x32_bf16 v[68:71], a[216:219], a[124:127], v[68:71]
    v_mul_f32 v252, v244, v252
    v_mul_f32 v237, v229, v237
    v_mul_f32 v253, v245, v253
    v_mfma_f32_16x16x32_bf16 v[76:79], a[220:223], a[124:127], v[76:79]
    ds_read_b64_tr_b16 a[216:217], v17 offset:18560
    ds_read_b64_tr_b16 a[218:219], v17 offset:19328
    v_mfma_f32_16x16x32_bf16 v[72:75], a[220:223], a[120:123], v[72:75]
    buffer_load_dwordx4 v13, s[12:15], s71 offen offset:2048 lds
    v_mul_f32 v238, v230, v238
    v_mfma_f32_16x16x32_bf16 v[80:83], a[224:227], a[120:123], v[80:83]
    s_waitcnt lgkmcnt(8)
    ds_read_b64_tr_b16 a[220:221], v18 offset:12416
    ds_read_b64_tr_b16 a[222:223], v18 offset:13184
    v_mfma_f32_16x16x32_bf16 v[84:87], a[224:227], a[124:127], v[84:87]
    v_mul_f32 v254, v246, v254
    v_mul_f32 v239, v231, v239
    v_mul_f32 v255, v247, v255
    v_mfma_f32_16x16x32_bf16 v[92:95], a[228:231], a[124:127], v[92:95]
    s_waitcnt vmcnt(18)
    ds_read_b64_tr_b16 a[224:225], v18 offset:18560
    ds_read_b64_tr_b16 a[226:227], v18 offset:19328
    v_mfma_f32_16x16x32_bf16 v[88:91], a[228:231], a[120:123], v[88:91]
    s_barrier
    v_subrev_u32 v17, 122880, v17
    v_subrev_u32 v18, 122880, v18
    v_mfma_f32_16x16x32_bf16 v[96:99], a[232:235], a[120:123], v[96:99]
    ds_read_b64_tr_b16 a[228:229], v17 offset:0
    ds_read_b64_tr_b16 a[230:231], v17 offset:768
    v_mfma_f32_16x16x32_bf16 v[100:103], a[232:235], a[124:127], v[100:103]
    v_mul_f32 v228, s34, v228
    v_mul_f32 v244, s34, v244
    v_mul_f32 v229, s34, v229
    v_mfma_f32_16x16x32_bf16 v[108:111], a[236:239], a[124:127], v[108:111]
    s_waitcnt lgkmcnt(8)
    ds_read_b64_tr_b16 a[232:233], v17 offset:6144
    ds_read_b64_tr_b16 a[234:235], v17 offset:6912
    v_mfma_f32_16x16x32_bf16 v[104:107], a[236:239], a[120:123], v[104:107]
    v_mul_f32 v245, s34, v245
    v_mul_f32 v230, s34, v230
    v_mul_f32 v246, s34, v246
    v_mfma_f32_16x16x32_bf16 v[112:115], a[240:243], a[120:123], v[112:115]
    ds_read_b64_tr_b16 a[236:237], v18 offset:0
    ds_read_b64_tr_b16 a[238:239], v18 offset:768
    v_mfma_f32_16x16x32_bf16 v[116:119], a[240:243], a[124:127], v[116:119]
    v_mul_f32 v231, s34, v231
    v_mul_f32 v247, s34, v247
    v_exp_f32 v228, v228
    v_mfma_f32_16x16x32_bf16 v[124:127], a[244:247], a[124:127], v[124:127]
    ds_read_b64_tr_b16 a[240:241], v18 offset:6144
    ds_read_b64_tr_b16 a[242:243], v18 offset:6912
    v_mfma_f32_16x16x32_bf16 v[120:123], a[244:247], a[120:123], v[120:123]
    v_exp_f32 v244, v244
    v_mfma_f32_16x16x32_bf16 v[128:131], a[248:251], a[120:123], v[128:131]
    s_waitcnt lgkmcnt(8)
    ds_read_b64_tr_b16 a[244:245], v17 offset:64
    ds_read_b64_tr_b16 a[246:247], v17 offset:832
    v_mfma_f32_16x16x32_bf16 v[132:135], a[248:251], a[124:127], v[132:135]
    v_exp_f32 v229, v229
    v_exp_f32 v245, v245
    v_mfma_f32_16x16x32_bf16 v[140:143], a[216:219], a[124:127], v[140:143]
    ds_read_b64_tr_b16 a[248:249], v17 offset:6208
    ds_read_b64_tr_b16 a[250:251], v17 offset:6976
    v_mfma_f32_16x16x32_bf16 v[136:139], a[216:219], a[120:123], v[136:139]
    s_add_u32 m0, s23, 98304
    v_mfma_f32_16x16x32_bf16 v[144:147], a[220:223], a[120:123], v[144:147]
    ds_read_b64_tr_b16 a[216:217], v18 offset:64
    ds_read_b64_tr_b16 a[218:219], v18 offset:832
    v_mfma_f32_16x16x32_bf16 v[148:151], a[220:223], a[124:127], v[148:151]
    buffer_load_dwordx4 v14, s[12:15], s69 offen offset:0 lds
    v_exp_f32 v230, v230
    v_mfma_f32_16x16x32_bf16 v[156:159], a[224:227], a[124:127], v[156:159]
    s_waitcnt lgkmcnt(8)
    ds_read_b64_tr_b16 a[220:221], v18 offset:6208
    ds_read_b64_tr_b16 a[222:223], v18 offset:6976
    v_mfma_f32_16x16x32_bf16 v[152:155], a[224:227], a[120:123], v[152:155]
    v_exp_f32 v246, v246
    v_mfma_f32_16x16x32_bf16 v[64:67], a[228:231], a[128:131], v[64:67]
    ds_read_b64_tr_b16 a[224:225], v17 offset:128
    ds_read_b64_tr_b16 a[226:227], v17 offset:896
    v_mfma_f32_16x16x32_bf16 v[68:71], a[228:231], a[132:135], v[68:71]
    buffer_load_dwordx4 v15, s[12:15], s69 offen offset:1024 lds
    v_exp_f32 v231, v231
    v_mfma_f32_16x16x32_bf16 v[76:79], a[232:235], a[132:135], v[76:79]
    ds_read_b64_tr_b16 a[228:229], v17 offset:6272
    ds_read_b64_tr_b16 a[230:231], v17 offset:7040
    v_mfma_f32_16x16x32_bf16 v[72:75], a[232:235], a[128:131], v[72:75]
    v_exp_f32 v247, v247
    v_mfma_f32_16x16x32_bf16 v[80:83], a[236:239], a[128:131], v[80:83]
    s_waitcnt lgkmcnt(8)
    ds_read_b64_tr_b16 a[232:233], v18 offset:128
    ds_read_b64_tr_b16 a[234:235], v18 offset:896
    v_mfma_f32_16x16x32_bf16 v[84:87], a[236:239], a[132:135], v[84:87]
    buffer_load_dwordx4 v16, s[12:15], s69 offen offset:2048 lds
    v_add_f32 v228, 1.0, v228
    v_mfma_f32_16x16x32_bf16 v[92:95], a[240:243], a[132:135], v[92:95]
    ds_read_b64_tr_b16 a[236:237], v18 offset:6272
    ds_read_b64_tr_b16 a[238:239], v18 offset:7040
    v_mfma_f32_16x16x32_bf16 v[88:91], a[240:243], a[128:131], v[88:91]
    v_add_f32 v244, 1.0, v244
    v_add_f32 v229, 1.0, v229
    v_add_f32 v245, 1.0, v245
    v_mfma_f32_16x16x32_bf16 v[96:99], a[244:247], a[128:131], v[96:99]
    ds_read_b64_tr_b16 a[240:241], v17 offset:12288
    ds_read_b64_tr_b16 a[242:243], v17 offset:13056
    v_mfma_f32_16x16x32_bf16 v[100:103], a[244:247], a[132:135], v[100:103]
    v_add_f32 v230, 1.0, v230
    v_add_f32 v246, 1.0, v246
    v_mfma_f32_16x16x32_bf16 v[108:111], a[248:251], a[132:135], v[108:111]
    s_waitcnt lgkmcnt(8)
    ds_read_b64_tr_b16 a[244:245], v17 offset:18432
    ds_read_b64_tr_b16 a[246:247], v17 offset:19200
    v_mfma_f32_16x16x32_bf16 v[104:107], a[248:251], a[128:131], v[104:107]
    v_add_f32 v231, 1.0, v231
    v_add_f32 v247, 1.0, v247
    v_mfma_f32_16x16x32_bf16 v[112:115], a[216:219], a[128:131], v[112:115]
    ds_read_b64_tr_b16 a[248:249], v18 offset:12288
    ds_read_b64_tr_b16 a[250:251], v18 offset:13056
    v_mfma_f32_16x16x32_bf16 v[116:119], a[216:219], a[132:135], v[116:119]
    v_rcp_f32 v228, v228
    v_rcp_f32 v244, v244
    v_mfma_f32_16x16x32_bf16 v[124:127], a[220:223], a[132:135], v[124:127]
    ds_read_b64_tr_b16 a[216:217], v18 offset:18432
    ds_read_b64_tr_b16 a[218:219], v18 offset:19200
    v_mfma_f32_16x16x32_bf16 v[120:123], a[220:223], a[128:131], v[120:123]
    v_rcp_f32 v229, v229
    v_mfma_f32_16x16x32_bf16 v[128:131], a[224:227], a[128:131], v[128:131]
    s_waitcnt lgkmcnt(8)
    ds_read_b64_tr_b16 a[220:221], v17 offset:12352
    ds_read_b64_tr_b16 a[222:223], v17 offset:13120
    v_mfma_f32_16x16x32_bf16 v[132:135], a[224:227], a[132:135], v[132:135]
    v_rcp_f32 v245, v245
    s_add_u32 m0, s23, 110592
    v_mfma_f32_16x16x32_bf16 v[140:143], a[228:231], a[132:135], v[140:143]
    ds_read_b64_tr_b16 a[224:225], v17 offset:18496
    ds_read_b64_tr_b16 a[226:227], v17 offset:19264
    v_mfma_f32_16x16x32_bf16 v[136:139], a[228:231], a[128:131], v[136:139]
    buffer_load_dwordx4 v14, s[12:15], s70 offen offset:0 lds
    v_mfma_f32_16x16x32_bf16 v[144:147], a[232:235], a[128:131], v[144:147]
    ds_read_b64_tr_b16 a[228:229], v18 offset:12352
    ds_read_b64_tr_b16 a[230:231], v18 offset:13120
    v_mfma_f32_16x16x32_bf16 v[148:151], a[232:235], a[132:135], v[148:151]
    v_rcp_f32 v230, v230
    v_rcp_f32 v246, v246
    v_mfma_f32_16x16x32_bf16 v[156:159], a[236:239], a[132:135], v[156:159]
    s_waitcnt lgkmcnt(8)
    ds_read_b64_tr_b16 a[232:233], v18 offset:18496
    ds_read_b64_tr_b16 a[234:235], v18 offset:19264
    v_mfma_f32_16x16x32_bf16 v[152:155], a[236:239], a[128:131], v[152:155]
    buffer_load_dwordx4 v15, s[12:15], s70 offen offset:1024 lds
    v_mfma_f32_16x16x32_bf16 v[64:67], a[240:243], a[136:139], v[64:67]
    ds_read_b64_tr_b16 a[236:237], v17 offset:12416
    ds_read_b64_tr_b16 a[238:239], v17 offset:13184
    v_mfma_f32_16x16x32_bf16 v[68:71], a[240:243], a[140:143], v[68:71]
    v_rcp_f32 v231, v231
    v_rcp_f32 v247, v247
    v_mfma_f32_16x16x32_bf16 v[76:79], a[244:247], a[140:143], v[76:79]
    ds_read_b64_tr_b16 a[240:241], v17 offset:18560
    ds_read_b64_tr_b16 a[242:243], v17 offset:19328
    v_mfma_f32_16x16x32_bf16 v[72:75], a[244:247], a[136:139], v[72:75]
    buffer_load_dwordx4 v16, s[12:15], s70 offen offset:2048 lds
    v_mfma_f32_16x16x32_bf16 v[80:83], a[248:251], a[136:139], v[80:83]
    s_waitcnt lgkmcnt(8)
    ds_read_b64_tr_b16 a[244:245], v18 offset:12416
    ds_read_b64_tr_b16 a[246:247], v18 offset:13184
    v_mfma_f32_16x16x32_bf16 v[84:87], a[248:251], a[140:143], v[84:87]
    v_mul_f32 v236, v236, v228
    v_mul_f32 v252, v252, v244
    v_mfma_f32_16x16x32_bf16 v[92:95], a[216:219], a[140:143], v[92:95]
    s_waitcnt vmcnt(18)
    ds_read_b64_tr_b16 a[248:249], v18 offset:18560
    ds_read_b64_tr_b16 a[250:251], v18 offset:19328
    v_mfma_f32_16x16x32_bf16 v[88:91], a[216:219], a[136:139], v[88:91]
    s_barrier
    v_mfma_f32_16x16x32_bf16 v[96:99], a[220:223], a[136:139], v[96:99]
    ds_read_b64_tr_b16 a[216:217], v19 offset:24576
    ds_read_b64_tr_b16 a[218:219], v19 offset:26624
    v_mfma_f32_16x16x32_bf16 v[100:103], a[220:223], a[140:143], v[100:103]
    v_mul_f32 v237, v237, v229
    v_mul_f32 v253, v253, v245
    v_mul_f32 v238, v238, v230
    v_mfma_f32_16x16x32_bf16 v[108:111], a[224:227], a[140:143], v[108:111]
    s_waitcnt lgkmcnt(8)
    ds_read_b64_tr_b16 a[220:221], v20 offset:24576
    ds_read_b64_tr_b16 a[222:223], v20 offset:26624
    v_mfma_f32_16x16x32_bf16 v[104:107], a[224:227], a[136:139], v[104:107]
    v_mul_f32 v254, v254, v246
    v_mul_f32 v239, v239, v231
    v_mul_f32 v255, v255, v247
    v_mfma_f32_16x16x32_bf16 v[112:115], a[228:231], a[136:139], v[112:115]
    ds_read_b64_tr_b16 a[224:225], v21 offset:24576
    ds_read_b64_tr_b16 a[226:227], v21 offset:26624
    v_mfma_f32_16x16x32_bf16 v[116:119], a[228:231], a[140:143], v[116:119]
    v_cvt_pk_bf16_f32 v228, v236, v237
    v_cvt_pk_bf16_f32 v244, v252, v253
    v_cvt_pk_bf16_f32 v229, v238, v239
    v_cvt_pk_bf16_f32 v245, v254, v255
    v_accvgpr_write_b32 a188, v228
    v_accvgpr_write_b32 a190, v244
    v_accvgpr_write_b32 a189, v229
    v_accvgpr_write_b32 a191, v245
    v_mfma_f32_16x16x32_bf16 v[124:127], a[232:235], a[140:143], v[124:127]
    ds_read_b64_tr_b16 a[228:229], v22 offset:24576
    ds_read_b64_tr_b16 a[230:231], v22 offset:26624
    v_mfma_f32_16x16x32_bf16 v[120:123], a[232:235], a[136:139], v[120:123]
    buffer_load_dword v55, v43, s[40:43], 0 offen sc0 sc1
    v_mfma_f32_16x16x32_bf16 v[128:131], a[236:239], a[136:139], v[128:131]
    s_waitcnt lgkmcnt(8)
    ds_read_b64_tr_b16 a[232:233], v19 offset:28672
    ds_read_b64_tr_b16 a[234:235], v19 offset:30720
    v_mfma_f32_16x16x32_bf16 v[132:135], a[236:239], a[140:143], v[132:135]
    s_add_u32 m0, s23, 122880
    v_mfma_f32_16x16x32_bf16 v[140:143], a[240:243], a[140:143], v[140:143]
    ds_read_b64_tr_b16 a[236:237], v20 offset:28672
    ds_read_b64_tr_b16 a[238:239], v20 offset:30720
    v_mfma_f32_16x16x32_bf16 v[136:139], a[240:243], a[136:139], v[136:139]
    buffer_load_dwordx4 v14, s[12:15], s71 offen offset:0 lds
    v_mfma_f32_16x16x32_bf16 v[144:147], a[244:247], a[136:139], v[144:147]
    ds_read_b64_tr_b16 a[240:241], v21 offset:28672
    ds_read_b64_tr_b16 a[242:243], v21 offset:30720
    v_mfma_f32_16x16x32_bf16 v[148:151], a[244:247], a[140:143], v[148:151]
    buffer_load_dwordx4 v15, s[12:15], s71 offen offset:1024 lds
    v_mfma_f32_16x16x32_bf16 v[156:159], a[248:251], a[140:143], v[156:159]
    s_waitcnt lgkmcnt(8)
    ds_read_b64_tr_b16 a[244:245], v22 offset:28672
    ds_read_b64_tr_b16 a[246:247], v22 offset:30720
    v_mfma_f32_16x16x32_bf16 v[152:155], a[248:251], a[136:139], v[152:155]
    buffer_load_dwordx4 v16, s[12:15], s71 offen offset:2048 lds
    v_mfma_f32_16x16x32_bf16 v[160:163], a[216:219], a[144:147], 0
    ds_read_b64_tr_b16 a[248:249], v19 offset:32768
    ds_read_b64_tr_b16 a[250:251], v19 offset:34816
    v_mfma_f32_16x16x32_bf16 v[176:179], a[216:219], a[148:151], 0
    v_mfma_f32_16x16x32_bf16 v[180:183], a[220:223], a[148:151], 0
    ds_read_b64_tr_b16 a[216:217], v20 offset:32768
    ds_read_b64_tr_b16 a[218:219], v20 offset:34816
    v_mfma_f32_16x16x32_bf16 v[164:167], a[220:223], a[144:147], 0
    v_mfma_f32_16x16x32_bf16 v[168:171], a[224:227], a[144:147], 0
    s_waitcnt lgkmcnt(8)
    ds_read_b64_tr_b16 a[220:221], v21 offset:32768
    ds_read_b64_tr_b16 a[222:223], v21 offset:34816
    v_mfma_f32_16x16x32_bf16 v[184:187], a[224:227], a[148:151], 0
    v_mfma_f32_16x16x32_bf16 v[188:191], a[228:231], a[148:151], 0
    ds_read_b64_tr_b16 a[224:225], v22 offset:32768
    ds_read_b64_tr_b16 a[226:227], v22 offset:34816
    v_mfma_f32_16x16x32_bf16 v[172:175], a[228:231], a[144:147], 0
    v_mul_f32 v72, v64, v72
    v_mul_f32 v88, v80, v88
    v_mfma_f32_16x16x32_bf16 v[160:163], a[232:235], a[152:155], v[160:163]
    ds_read_b64_tr_b16 a[228:229], v19 offset:36864
    ds_read_b64_tr_b16 a[230:231], v19 offset:38912
    v_mfma_f32_16x16x32_bf16 v[176:179], a[232:235], a[156:159], v[176:179]
    v_mul_f32 v73, v65, v73
    v_mul_f32 v89, v81, v89
    v_mul_f32 v74, v66, v74
    v_mfma_f32_16x16x32_bf16 v[180:183], a[236:239], a[156:159], v[180:183]
    s_waitcnt lgkmcnt(8)
    ds_read_b64_tr_b16 a[232:233], v20 offset:36864
    ds_read_b64_tr_b16 a[234:235], v20 offset:38912
    v_mfma_f32_16x16x32_bf16 v[164:167], a[236:239], a[152:155], v[164:167]
    v_mul_f32 v90, v82, v90
    v_mul_f32 v75, v67, v75
    v_mul_f32 v91, v83, v91
    v_mfma_f32_16x16x32_bf16 v[168:171], a[240:243], a[152:155], v[168:171]
    ds_read_b64_tr_b16 a[236:237], v21 offset:36864
    ds_read_b64_tr_b16 a[238:239], v21 offset:38912
    v_mfma_f32_16x16x32_bf16 v[184:187], a[240:243], a[156:159], v[184:187]
    v_mul_f32 v64, s34, v64
    v_mul_f32 v80, s34, v80
    v_mul_f32 v65, s34, v65
    v_mfma_f32_16x16x32_bf16 v[188:191], a[244:247], a[156:159], v[188:191]
    ds_read_b64_tr_b16 a[240:241], v22 offset:36864
    ds_read_b64_tr_b16 a[242:243], v22 offset:38912
    v_mfma_f32_16x16x32_bf16 v[172:175], a[244:247], a[152:155], v[172:175]
    v_mul_f32 v81, s34, v81
    v_mul_f32 v66, s34, v66
    v_mul_f32 v82, s34, v82
    v_mfma_f32_16x16x32_bf16 v[160:163], a[248:251], a[160:163], v[160:163]
    s_waitcnt lgkmcnt(8)
    ds_read_b64_tr_b16 a[244:245], v19 offset:40960
    ds_read_b64_tr_b16 a[246:247], v19 offset:43008
    v_mfma_f32_16x16x32_bf16 v[176:179], a[248:251], a[164:167], v[176:179]
    v_mul_f32 v67, s34, v67
    v_mul_f32 v83, s34, v83
    v_exp_f32 v64, v64
    v_mfma_f32_16x16x32_bf16 v[180:183], a[216:219], a[164:167], v[180:183]
    ds_read_b64_tr_b16 a[248:249], v20 offset:40960
    ds_read_b64_tr_b16 a[250:251], v20 offset:43008
    v_mfma_f32_16x16x32_bf16 v[164:167], a[216:219], a[160:163], v[164:167]
    v_exp_f32 v80, v80
    v_exp_f32 v65, v65
    v_mfma_f32_16x16x32_bf16 v[168:171], a[220:223], a[160:163], v[168:171]
    ds_read_b64_tr_b16 a[216:217], v21 offset:40960
    ds_read_b64_tr_b16 a[218:219], v21 offset:43008
    v_mfma_f32_16x16x32_bf16 v[184:187], a[220:223], a[164:167], v[184:187]
    v_exp_f32 v81, v81
    v_exp_f32 v66, v66
    v_mfma_f32_16x16x32_bf16 v[188:191], a[224:227], a[164:167], v[188:191]
    s_waitcnt lgkmcnt(8)
    ds_read_b64_tr_b16 a[220:221], v22 offset:40960
    ds_read_b64_tr_b16 a[222:223], v22 offset:43008
    v_mfma_f32_16x16x32_bf16 v[172:175], a[224:227], a[160:163], v[172:175]
    v_exp_f32 v82, v82
    v_exp_f32 v67, v67
    v_mfma_f32_16x16x32_bf16 v[160:163], a[228:231], a[168:171], v[160:163]
    ds_read_b64_tr_b16 a[224:225], v19 offset:45056
    ds_read_b64_tr_b16 a[226:227], v19 offset:47104
    v_mfma_f32_16x16x32_bf16 v[176:179], a[228:231], a[172:175], v[176:179]
    v_exp_f32 v83, v83
    v_add_f32 v64, 1.0, v64
    v_mfma_f32_16x16x32_bf16 v[180:183], a[232:235], a[172:175], v[180:183]
    ds_read_b64_tr_b16 a[228:229], v20 offset:45056
    ds_read_b64_tr_b16 a[230:231], v20 offset:47104
    v_mfma_f32_16x16x32_bf16 v[164:167], a[232:235], a[168:171], v[164:167]
    s_add_u32 m0, s23, 135168
    v_add_f32 v80, 1.0, v80
    v_add_f32 v65, 1.0, v65
    v_mfma_f32_16x16x32_bf16 v[168:171], a[236:239], a[168:171], v[168:171]
    s_waitcnt lgkmcnt(8)
    ds_read_b64_tr_b16 a[232:233], v21 offset:45056
    ds_read_b64_tr_b16 a[234:235], v21 offset:47104
    v_mfma_f32_16x16x32_bf16 v[184:187], a[236:239], a[172:175], v[184:187]
    buffer_load_dwordx4 v8, s[12:15], s72 offen offset:0 lds
    v_add_f32 v81, 1.0, v81
    v_mfma_f32_16x16x32_bf16 v[188:191], a[240:243], a[172:175], v[188:191]
    s_waitcnt vmcnt(17)
    ds_read_b64_tr_b16 a[236:237], v22 offset:45056
    ds_read_b64_tr_b16 a[238:239], v22 offset:47104
    v_mfma_f32_16x16x32_bf16 v[172:175], a[240:243], a[168:171], v[172:175]
    s_barrier
    v_mfma_f32_16x16x32_bf16 v[160:163], a[244:247], a[176:179], v[160:163]
    ds_read_b64_tr_b16 a[240:241], v19 offset:49152
    ds_read_b64_tr_b16 a[242:243], v19 offset:51200
    v_mfma_f32_16x16x32_bf16 v[176:179], a[244:247], a[180:183], v[176:179]
    buffer_load_dwordx4 v9, s[12:15], s72 offen offset:1024 lds
    v_add_f32 v66, 1.0, v66
    v_mfma_f32_16x16x32_bf16 v[180:183], a[248:251], a[180:183], v[180:183]
    s_waitcnt lgkmcnt(8)
    ds_read_b64_tr_b16 a[244:245], v20 offset:49152
    ds_read_b64_tr_b16 a[246:247], v20 offset:51200
    v_mfma_f32_16x16x32_bf16 v[164:167], a[248:251], a[176:179], v[164:167]
    buffer_load_dwordx4 v10, s[12:15], s72 offen offset:2048 lds
    v_add_f32 v82, 1.0, v82
    v_mfma_f32_16x16x32_bf16 v[168:171], a[216:219], a[176:179], v[168:171]
    ds_read_b64_tr_b16 a[248:249], v21 offset:49152
    ds_read_b64_tr_b16 a[250:251], v21 offset:51200
    v_mfma_f32_16x16x32_bf16 v[184:187], a[216:219], a[180:183], v[184:187]
    v_add_f32 v67, 1.0, v67
    v_add_f32 v83, 1.0, v83
    v_rcp_f32 v64, v64
    v_mfma_f32_16x16x32_bf16 v[188:191], a[220:223], a[180:183], v[188:191]
    ds_read_b64_tr_b16 a[216:217], v22 offset:49152
    ds_read_b64_tr_b16 a[218:219], v22 offset:51200
    v_mfma_f32_16x16x32_bf16 v[172:175], a[220:223], a[176:179], v[172:175]
    v_rcp_f32 v80, v80
    v_rcp_f32 v65, v65
    v_mfma_f32_16x16x32_bf16 v[160:163], a[224:227], a[184:187], v[160:163]
    s_waitcnt lgkmcnt(8)
    ds_read_b64_tr_b16 a[220:221], v19 offset:53248
    ds_read_b64_tr_b16 a[222:223], v19 offset:55296
    v_mfma_f32_16x16x32_bf16 v[176:179], a[224:227], a[188:191], v[176:179]
    v_rcp_f32 v81, v81
    v_rcp_f32 v66, v66
    v_mfma_f32_16x16x32_bf16 v[180:183], a[228:231], a[188:191], v[180:183]
    ds_read_b64_tr_b16 a[224:225], v20 offset:53248
    ds_read_b64_tr_b16 a[226:227], v20 offset:55296
    v_mfma_f32_16x16x32_bf16 v[164:167], a[228:231], a[184:187], v[164:167]
    v_rcp_f32 v82, v82
    v_rcp_f32 v67, v67
    v_mfma_f32_16x16x32_bf16 v[168:171], a[232:235], a[184:187], v[168:171]
    ds_read_b64_tr_b16 a[228:229], v21 offset:53248
    ds_read_b64_tr_b16 a[230:231], v21 offset:55296
    v_mfma_f32_16x16x32_bf16 v[184:187], a[232:235], a[188:191], v[184:187]
    v_rcp_f32 v83, v83
    v_mul_f32 v72, v72, v64
    v_mfma_f32_16x16x32_bf16 v[188:191], a[236:239], a[188:191], v[188:191]
    s_waitcnt lgkmcnt(8)
    ds_read_b64_tr_b16 a[232:233], v22 offset:53248
    ds_read_b64_tr_b16 a[234:235], v22 offset:55296
    v_mfma_f32_16x16x32_bf16 v[172:175], a[236:239], a[184:187], v[172:175]
    v_mul_f32 v88, v88, v80
    v_mul_f32 v73, v73, v65
    v_mul_f32 v89, v89, v81
    v_mfma_f32_16x16x32_bf16 v[192:195], a[240:243], a[144:147], 0
    ds_read_b64_tr_b16 a[236:237], v19 offset:57344
    ds_read_b64_tr_b16 a[238:239], v19 offset:59392
    v_mfma_f32_16x16x32_bf16 v[208:211], a[240:243], a[148:151], 0
    v_mul_f32 v74, v74, v66
    v_mul_f32 v90, v90, v82
    v_mul_f32 v75, v75, v67
    v_mfma_f32_16x16x32_bf16 v[212:215], a[244:247], a[148:151], 0
    ds_read_b64_tr_b16 a[240:241], v20 offset:57344
    ds_read_b64_tr_b16 a[242:243], v20 offset:59392
    v_mfma_f32_16x16x32_bf16 v[196:199], a[244:247], a[144:147], 0
    v_mul_f32 v91, v91, v83
    v_cvt_pk_bf16_f32 v64, v72, v73
    v_cvt_pk_bf16_f32 v80, v88, v89
    v_mfma_f32_16x16x32_bf16 v[200:203], a[248:251], a[144:147], 0
    s_waitcnt lgkmcnt(8)
    ds_read_b64_tr_b16 a[244:245], v21 offset:57344
    ds_read_b64_tr_b16 a[246:247], v21 offset:59392
    v_mfma_f32_16x16x32_bf16 v[216:219], a[248:251], a[148:151], 0
    s_add_u32 m0, s23, 0
    v_cvt_pk_bf16_f32 v65, v74, v75
    v_cvt_pk_bf16_f32 v81, v90, v91
    v_mfma_f32_16x16x32_bf16 v[220:223], a[216:219], a[148:151], 0
    ds_read_b64_tr_b16 a[248:249], v22 offset:57344
    ds_read_b64_tr_b16 a[250:251], v22 offset:59392
    v_mfma_f32_16x16x32_bf16 v[204:207], a[216:219], a[144:147], 0
    buffer_load_dwordx4 v11, s[12:15], s72 offen offset:0 lds
    v_accvgpr_write_b32 a192, v64
    v_mfma_f32_16x16x32_bf16 v[192:195], a[220:223], a[152:155], v[192:195]
    ds_read_b64_tr_b16 a[216:217], v19 offset:61440
    ds_read_b64_tr_b16 a[218:219], v19 offset:63488
    v_mfma_f32_16x16x32_bf16 v[208:211], a[220:223], a[156:159], v[208:211]
    buffer_load_dwordx4 v12, s[12:15], s72 offen offset:1024 lds
    v_accvgpr_write_b32 a194, v80
    v_mfma_f32_16x16x32_bf16 v[212:215], a[224:227], a[156:159], v[212:215]
    s_waitcnt lgkmcnt(8)
    ds_read_b64_tr_b16 a[220:221], v20 offset:61440
    ds_read_b64_tr_b16 a[222:223], v20 offset:63488
    v_mfma_f32_16x16x32_bf16 v[196:199], a[224:227], a[152:155], v[196:199]
    buffer_load_dwordx4 v13, s[12:15], s72 offen offset:2048 lds
    v_accvgpr_write_b32 a193, v65
    v_mfma_f32_16x16x32_bf16 v[200:203], a[228:231], a[152:155], v[200:203]
    ds_read_b64_tr_b16 a[224:225], v21 offset:61440
    ds_read_b64_tr_b16 a[226:227], v21 offset:63488
    v_mfma_f32_16x16x32_bf16 v[216:219], a[228:231], a[156:159], v[216:219]
    v_accvgpr_write_b32 a195, v81
    v_mul_f32 v76, v68, v76
    v_mul_f32 v92, v84, v92
    v_mfma_f32_16x16x32_bf16 v[220:223], a[232:235], a[156:159], v[220:223]
    ds_read_b64_tr_b16 a[228:229], v22 offset:61440
    ds_read_b64_tr_b16 a[230:231], v22 offset:63488
    v_mfma_f32_16x16x32_bf16 v[204:207], a[232:235], a[152:155], v[204:207]
    v_add_u32 v19, 61440, v19
    v_add_u32 v20, 61440, v20
    v_add_u32 v21, 61440, v21
    v_add_u32 v22, 61440, v22
    v_mfma_f32_16x16x32_bf16 v[192:195], a[236:239], a[160:163], v[192:195]
    s_waitcnt lgkmcnt(8)
    ds_read_b64_tr_b16 a[232:233], v19 offset:4096
    ds_read_b64_tr_b16 a[234:235], v19 offset:6144
    v_mfma_f32_16x16x32_bf16 v[208:211], a[236:239], a[164:167], v[208:211]
    v_mul_f32 v77, v69, v77
    v_mul_f32 v93, v85, v93
    v_mul_f32 v78, v70, v78
    v_mfma_f32_16x16x32_bf16 v[212:215], a[240:243], a[164:167], v[212:215]
    ds_read_b64_tr_b16 a[236:237], v20 offset:4096
    ds_read_b64_tr_b16 a[238:239], v20 offset:6144
    v_mfma_f32_16x16x32_bf16 v[196:199], a[240:243], a[160:163], v[196:199]
    v_mul_f32 v94, v86, v94
    v_mul_f32 v79, v71, v79
    v_mul_f32 v95, v87, v95
    v_mfma_f32_16x16x32_bf16 v[200:203], a[244:247], a[160:163], v[200:203]
    ds_read_b64_tr_b16 a[240:241], v21 offset:4096
    ds_read_b64_tr_b16 a[242:243], v21 offset:6144
    v_mfma_f32_16x16x32_bf16 v[216:219], a[244:247], a[164:167], v[216:219]
    v_mul_f32 v68, s34, v68
    v_mul_f32 v84, s34, v84
    v_mul_f32 v69, s34, v69
    v_mfma_f32_16x16x32_bf16 v[220:223], a[248:251], a[164:167], v[220:223]
    s_waitcnt lgkmcnt(8)
    ds_read_b64_tr_b16 a[244:245], v22 offset:4096
    ds_read_b64_tr_b16 a[246:247], v22 offset:6144
    v_mfma_f32_16x16x32_bf16 v[204:207], a[248:251], a[160:163], v[204:207]
    v_mul_f32 v85, s34, v85
    v_mul_f32 v70, s34, v70
    v_mul_f32 v86, s34, v86
    v_mfma_f32_16x16x32_bf16 v[192:195], a[216:219], a[168:171], v[192:195]
    ds_read_b64_tr_b16 a[248:249], v19 offset:8192
    ds_read_b64_tr_b16 a[250:251], v19 offset:10240
    v_mfma_f32_16x16x32_bf16 v[208:211], a[216:219], a[172:175], v[208:211]
    v_mul_f32 v71, s34, v71
    v_mul_f32 v87, s34, v87
    v_exp_f32 v68, v68
    v_mfma_f32_16x16x32_bf16 v[212:215], a[220:223], a[172:175], v[212:215]
    ds_read_b64_tr_b16 a[216:217], v20 offset:8192
    ds_read_b64_tr_b16 a[218:219], v20 offset:10240
    v_mfma_f32_16x16x32_bf16 v[196:199], a[220:223], a[168:171], v[196:199]
    s_add_u32 m0, s23, 12288
    v_exp_f32 v84, v84
    v_mfma_f32_16x16x32_bf16 v[200:203], a[224:227], a[168:171], v[200:203]
    s_waitcnt lgkmcnt(8)
    ds_read_b64_tr_b16 a[220:221], v21 offset:8192
    ds_read_b64_tr_b16 a[222:223], v21 offset:10240
    v_mfma_f32_16x16x32_bf16 v[216:219], a[224:227], a[172:175], v[216:219]
    buffer_load_dwordx4 v14, s[12:15], s72 offen offset:0 lds
    v_exp_f32 v69, v69
    v_mfma_f32_16x16x32_bf16 v[220:223], a[228:231], a[172:175], v[220:223]
    s_waitcnt vmcnt(17)
    ds_read_b64_tr_b16 a[224:225], v22 offset:8192
    ds_read_b64_tr_b16 a[226:227], v22 offset:10240
    v_mfma_f32_16x16x32_bf16 v[204:207], a[228:231], a[168:171], v[204:207]
    s_barrier
    v_mfma_f32_16x16x32_bf16 v[192:195], a[232:235], a[176:179], v[192:195]
    ds_read_b64_tr_b16 a[228:229], v19 offset:12288
    ds_read_b64_tr_b16 a[230:231], v19 offset:14336
    v_mfma_f32_16x16x32_bf16 v[208:211], a[232:235], a[180:183], v[208:211]
    buffer_load_dwordx4 v15, s[12:15], s72 offen offset:1024 lds
    v_exp_f32 v85, v85
    v_mfma_f32_16x16x32_bf16 v[212:215], a[236:239], a[180:183], v[212:215]
    s_waitcnt lgkmcnt(8)
    ds_read_b64_tr_b16 a[232:233], v20 offset:12288
    ds_read_b64_tr_b16 a[234:235], v20 offset:14336
    v_mfma_f32_16x16x32_bf16 v[196:199], a[236:239], a[176:179], v[196:199]
    buffer_load_dwordx4 v16, s[12:15], s72 offen offset:2048 lds
    v_exp_f32 v70, v70
    v_mfma_f32_16x16x32_bf16 v[200:203], a[240:243], a[176:179], v[200:203]
    ds_read_b64_tr_b16 a[236:237], v21 offset:12288
    ds_read_b64_tr_b16 a[238:239], v21 offset:14336
    v_mfma_f32_16x16x32_bf16 v[216:219], a[240:243], a[180:183], v[216:219]
    v_exp_f32 v86, v86
    v_exp_f32 v71, v71
    v_mfma_f32_16x16x32_bf16 v[220:223], a[244:247], a[180:183], v[220:223]
    ds_read_b64_tr_b16 a[240:241], v22 offset:12288
    ds_read_b64_tr_b16 a[242:243], v22 offset:14336
    v_mfma_f32_16x16x32_bf16 v[204:207], a[244:247], a[176:179], v[204:207]
    v_exp_f32 v87, v87
    v_add_f32 v68, 1.0, v68
    v_mfma_f32_16x16x32_bf16 v[192:195], a[248:251], a[184:187], v[192:195]
    s_waitcnt lgkmcnt(8)
    ds_read_b64_tr_b16 a[244:245], v19 offset:16384
    ds_read_b64_tr_b16 a[246:247], v19 offset:18432
    v_mfma_f32_16x16x32_bf16 v[208:211], a[248:251], a[188:191], v[208:211]
    v_add_f32 v84, 1.0, v84
    v_add_f32 v69, 1.0, v69
    v_add_f32 v85, 1.0, v85
    v_mfma_f32_16x16x32_bf16 v[212:215], a[216:219], a[188:191], v[212:215]
    ds_read_b64_tr_b16 a[248:249], v20 offset:16384
    ds_read_b64_tr_b16 a[250:251], v20 offset:18432
    v_mfma_f32_16x16x32_bf16 v[196:199], a[216:219], a[184:187], v[196:199]
    v_add_f32 v70, 1.0, v70
    v_add_f32 v86, 1.0, v86
    v_add_f32 v71, 1.0, v71
    v_mfma_f32_16x16x32_bf16 v[200:203], a[220:223], a[184:187], v[200:203]
    ds_read_b64_tr_b16 a[216:217], v21 offset:16384
    ds_read_b64_tr_b16 a[218:219], v21 offset:18432
    v_mfma_f32_16x16x32_bf16 v[216:219], a[220:223], a[188:191], v[216:219]
    v_add_f32 v87, 1.0, v87
    s_add_u32 m0, s23, 24576
    v_rcp_f32 v68, v68
    v_mfma_f32_16x16x32_bf16 v[220:223], a[224:227], a[188:191], v[220:223]
    s_waitcnt lgkmcnt(8)
    ds_read_b64_tr_b16 a[220:221], v22 offset:16384
    ds_read_b64_tr_b16 a[222:223], v22 offset:18432
    v_mfma_f32_16x16x32_bf16 v[204:207], a[224:227], a[184:187], v[204:207]
    v_rcp_f32 v84, v84
    v_rcp_f32 v69, v69
    v_mfma_f32_16x16x32_bf16 v[224:227], a[228:231], a[144:147], 0
    ds_read_b64_tr_b16 a[224:225], v19 offset:20480
    ds_read_b64_tr_b16 a[226:227], v19 offset:22528
    v_mfma_f32_16x16x32_bf16 v[240:243], a[228:231], a[148:151], 0
    v_rcp_f32 v85, v85
    v_rcp_f32 v70, v70
    v_mfma_f32_16x16x32_bf16 v[244:247], a[232:235], a[148:151], 0
    ds_read_b64_tr_b16 a[228:229], v20 offset:20480
    ds_read_b64_tr_b16 a[230:231], v20 offset:22528
    v_mfma_f32_16x16x32_bf16 v[228:231], a[232:235], a[144:147], 0
    v_rcp_f32 v86, v86
    v_rcp_f32 v71, v71
    v_mfma_f32_16x16x32_bf16 v[232:235], a[236:239], a[144:147], 0
    s_waitcnt lgkmcnt(8)
    ds_read_b64_tr_b16 a[232:233], v21 offset:20480
    ds_read_b64_tr_b16 a[234:235], v21 offset:22528
    v_mfma_f32_16x16x32_bf16 v[248:251], a[236:239], a[148:151], 0
    buffer_load_dwordx4 v8, s[12:15], s73 offen offset:0 lds
    v_rcp_f32 v87, v87
    v_mfma_f32_16x16x32_bf16 v[252:255], a[240:243], a[148:151], 0
    ds_read_b64_tr_b16 a[236:237], v22 offset:20480
    ds_read_b64_tr_b16 a[238:239], v22 offset:22528
    v_mfma_f32_16x16x32_bf16 v[236:239], a[240:243], a[144:147], 0
    buffer_load_dwordx4 v9, s[12:15], s73 offen offset:1024 lds
    v_mul_f32 v76, v76, v68
    v_mfma_f32_16x16x32_bf16 v[224:227], a[244:247], a[152:155], v[224:227]
    ds_read_b64_tr_b16 a[240:241], v19 offset:24576
    ds_read_b64_tr_b16 a[242:243], v19 offset:26624
    v_mfma_f32_16x16x32_bf16 v[240:243], a[244:247], a[156:159], v[240:243]
    buffer_load_dwordx4 v10, s[12:15], s73 offen offset:2048 lds
    v_mul_f32 v92, v92, v84
    v_mfma_f32_16x16x32_bf16 v[244:247], a[248:251], a[156:159], v[244:247]
    s_waitcnt lgkmcnt(8)
    ds_read_b64_tr_b16 a[244:245], v20 offset:24576
    ds_read_b64_tr_b16 a[246:247], v20 offset:26624
    v_mfma_f32_16x16x32_bf16 v[228:231], a[248:251], a[152:155], v[228:231]
    v_mul_f32 v77, v77, v69
    v_mul_f32 v93, v93, v85
    v_mul_f32 v78, v78, v70
    v_mfma_f32_16x16x32_bf16 v[232:235], a[216:219], a[152:155], v[232:235]
    ds_read_b64_tr_b16 a[248:249], v21 offset:24576
    ds_read_b64_tr_b16 a[250:251], v21 offset:26624
    v_mfma_f32_16x16x32_bf16 v[248:251], a[216:219], a[156:159], v[248:251]
    v_mul_f32 v94, v94, v86
    v_mul_f32 v79, v79, v71
    v_mul_f32 v95, v95, v87
    v_mfma_f32_16x16x32_bf16 v[252:255], a[220:223], a[156:159], v[252:255]
    ds_read_b64_tr_b16 a[216:217], v22 offset:24576
    ds_read_b64_tr_b16 a[218:219], v22 offset:26624
    v_mfma_f32_16x16x32_bf16 v[236:239], a[220:223], a[152:155], v[236:239]
    v_cvt_pk_bf16_f32 v68, v76, v77
    v_cvt_pk_bf16_f32 v84, v92, v93
    v_cvt_pk_bf16_f32 v69, v78, v79
    v_mfma_f32_16x16x32_bf16 v[224:227], a[224:227], a[160:163], v[224:227]
    s_waitcnt lgkmcnt(8)
    ds_read_b64_tr_b16 a[220:221], v19 offset:28672
    ds_read_b64_tr_b16 a[222:223], v19 offset:30720
    v_mfma_f32_16x16x32_bf16 v[240:243], a[224:227], a[164:167], v[240:243]
    v_cvt_pk_bf16_f32 v85, v94, v95
    v_accvgpr_write_b32 a196, v68
    v_accvgpr_write_b32 a198, v84
    v_mfma_f32_16x16x32_bf16 v[244:247], a[228:231], a[164:167], v[244:247]
    ds_read_b64_tr_b16 a[224:225], v20 offset:28672
    ds_read_b64_tr_b16 a[226:227], v20 offset:30720
    v_mfma_f32_16x16x32_bf16 v[228:231], a[228:231], a[160:163], v[228:231]
    v_accvgpr_write_b32 a197, v69
    v_accvgpr_write_b32 a199, v85
    v_mul_f32 v104, v96, v104
    v_mfma_f32_16x16x32_bf16 v[232:235], a[232:235], a[160:163], v[232:235]
    ds_read_b64_tr_b16 a[228:229], v21 offset:28672
    ds_read_b64_tr_b16 a[230:231], v21 offset:30720
    v_mfma_f32_16x16x32_bf16 v[248:251], a[232:235], a[164:167], v[248:251]
    v_mul_f32 v120, v112, v120
    v_mul_f32 v105, v97, v105
    v_mul_f32 v121, v113, v121
    v_mfma_f32_16x16x32_bf16 v[252:255], a[236:239], a[164:167], v[252:255]
    s_waitcnt lgkmcnt(8)
    ds_read_b64_tr_b16 a[232:233], v22 offset:28672
    ds_read_b64_tr_b16 a[234:235], v22 offset:30720
    v_mfma_f32_16x16x32_bf16 v[236:239], a[236:239], a[160:163], v[236:239]
    v_mul_f32 v106, v98, v106
    v_mul_f32 v122, v114, v122
    v_mul_f32 v107, v99, v107
    v_mfma_f32_16x16x32_bf16 v[224:227], a[240:243], a[168:171], v[224:227]
    ds_read_b64_tr_b16 a[236:237], v19 offset:32768
    ds_read_b64_tr_b16 a[238:239], v19 offset:34816
    v_mfma_f32_16x16x32_bf16 v[240:243], a[240:243], a[172:175], v[240:243]
    v_mul_f32 v123, v115, v123
    v_mul_f32 v96, s34, v96
    v_mul_f32 v112, s34, v112
    v_mfma_f32_16x16x32_bf16 v[244:247], a[244:247], a[172:175], v[244:247]
    ds_read_b64_tr_b16 a[240:241], v20 offset:32768
    ds_read_b64_tr_b16 a[242:243], v20 offset:34816
    v_mfma_f32_16x16x32_bf16 v[228:231], a[244:247], a[168:171], v[228:231]
    s_add_u32 m0, s23, 36864
    v_mul_f32 v97, s34, v97
    v_mul_f32 v113, s34, v113
    v_mfma_f32_16x16x32_bf16 v[232:235], a[248:251], a[168:171], v[232:235]
    s_waitcnt lgkmcnt(8)
    ds_read_b64_tr_b16 a[244:245], v21 offset:32768
    ds_read_b64_tr_b16 a[246:247], v21 offset:34816
    v_mfma_f32_16x16x32_bf16 v[248:251], a[248:251], a[172:175], v[248:251]
    buffer_load_dwordx4 v11, s[12:15], s73 offen offset:0 lds
    v_mul_f32 v98, s34, v98
    v_mfma_f32_16x16x32_bf16 v[252:255], a[216:219], a[172:175], v[252:255]
    s_waitcnt vmcnt(17)
    ds_read_b64_tr_b16 a[248:249], v22 offset:32768
    ds_read_b64_tr_b16 a[250:251], v22 offset:34816
    v_mfma_f32_16x16x32_bf16 v[236:239], a[216:219], a[168:171], v[236:239]
    s_barrier
    v_mfma_f32_16x16x32_bf16 v[224:227], a[220:223], a[176:179], v[224:227]
    ds_read_b64_tr_b16 a[216:217], v19 offset:36864
    ds_read_b64_tr_b16 a[218:219], v19 offset:38912
    v_mfma_f32_16x16x32_bf16 v[240:243], a[220:223], a[180:183], v[240:243]
    buffer_load_dwordx4 v12, s[12:15], s73 offen offset:1024 lds
    v_mul_f32 v114, s34, v114
    v_mfma_f32_16x16x32_bf16 v[244:247], a[224:227], a[180:183], v[244:247]
    s_waitcnt lgkmcnt(8)
    ds_read_b64_tr_b16 a[220:221], v20 offset:36864
    ds_read_b64_tr_b16 a[222:223], v20 offset:38912
    v_mfma_f32_16x16x32_bf16 v[228:231], a[224:227], a[176:179], v[228:231]
    v_mul_f32 v99, s34, v99
    v_mul_f32 v115, s34, v115
    v_exp_f32 v96, v96
    v_mfma_f32_16x16x32_bf16 v[232:235], a[228:231], a[176:179], v[232:235]
    ds_read_b64_tr_b16 a[224:225], v21 offset:36864
    ds_read_b64_tr_b16 a[226:227], v21 offset:38912
    v_mfma_f32_16x16x32_bf16 v[248:251], a[228:231], a[180:183], v[248:251]
    v_exp_f32 v112, v112
    v_exp_f32 v97, v97
    v_exp_f32 v113, v113
    v_exp_f32 v98, v98
    v_exp_f32 v114, v114
    v_exp_f32 v99, v99
    v_exp_f32 v115, v115
    v_add_f32 v96, 1.0, v96
    v_add_f32 v112, 1.0, v112
    v_add_f32 v97, 1.0, v97
    v_add_f32 v113, 1.0, v113
    v_add_f32 v98, 1.0, v98
    v_add_f32 v114, 1.0, v114
    v_add_f32 v99, 1.0, v99
    v_add_f32 v115, 1.0, v115
    v_rcp_f32 v96, v96
    v_rcp_f32 v112, v112
    v_rcp_f32 v97, v97
    v_rcp_f32 v113, v113
    v_rcp_f32 v98, v98
    v_rcp_f32 v114, v114
    v_rcp_f32 v99, v99
    v_rcp_f32 v115, v115
    v_mul_f32 v104, v104, v96
    v_mul_f32 v120, v120, v112
    v_mul_f32 v105, v105, v97
    v_mul_f32 v121, v121, v113
    v_mul_f32 v106, v106, v98
    v_mul_f32 v122, v122, v114
    v_mul_f32 v107, v107, v99
    v_mul_f32 v123, v123, v115
    v_cvt_pk_bf16_f32 v96, v104, v105
    v_cvt_pk_bf16_f32 v112, v120, v121
    v_cvt_pk_bf16_f32 v97, v106, v107
    v_cvt_pk_bf16_f32 v113, v122, v123
    v_accvgpr_write_b32 a200, v96
    v_accvgpr_write_b32 a202, v112
    v_accvgpr_write_b32 a201, v97
    v_accvgpr_write_b32 a203, v113
    v_mul_f32 v108, v100, v108
    v_mul_f32 v124, v116, v124
    v_mul_f32 v109, v101, v109
    v_mul_f32 v125, v117, v125
    v_mul_f32 v110, v102, v110
    v_mul_f32 v126, v118, v126
    v_mul_f32 v111, v103, v111
    v_mul_f32 v127, v119, v127
    v_mul_f32 v100, s34, v100
    v_mul_f32 v116, s34, v116
    v_mul_f32 v101, s34, v101
    v_mul_f32 v117, s34, v117
    v_mul_f32 v102, s34, v102
    v_mul_f32 v118, s34, v118
    v_mul_f32 v103, s34, v103
    v_mul_f32 v119, s34, v119
    v_exp_f32 v100, v100
    v_exp_f32 v116, v116
    v_exp_f32 v101, v101
    v_exp_f32 v117, v117
    v_exp_f32 v102, v102
    v_exp_f32 v118, v118
    v_exp_f32 v103, v103
    v_exp_f32 v119, v119
    v_add_f32 v100, 1.0, v100
    v_add_f32 v116, 1.0, v116
    v_add_f32 v101, 1.0, v101
    v_add_f32 v117, 1.0, v117
    v_add_f32 v102, 1.0, v102
    v_add_f32 v118, 1.0, v118
    v_add_f32 v103, 1.0, v103
    v_add_f32 v119, 1.0, v119
    v_rcp_f32 v100, v100
    v_rcp_f32 v116, v116
    v_rcp_f32 v101, v101
    v_rcp_f32 v117, v117
    v_rcp_f32 v102, v102
    v_rcp_f32 v118, v118
    v_rcp_f32 v103, v103
    v_rcp_f32 v119, v119
    v_mul_f32 v108, v108, v100
    v_mul_f32 v124, v124, v116
    v_mul_f32 v109, v109, v101
    v_mul_f32 v125, v125, v117
    v_mul_f32 v110, v110, v102
    v_mul_f32 v126, v126, v118
    v_mul_f32 v111, v111, v103
    v_mul_f32 v127, v127, v119
    v_cvt_pk_bf16_f32 v100, v108, v109
    v_cvt_pk_bf16_f32 v116, v124, v125
    v_cvt_pk_bf16_f32 v101, v110, v111
    v_cvt_pk_bf16_f32 v117, v126, v127
    v_accvgpr_write_b32 a204, v100
    v_accvgpr_write_b32 a206, v116
    v_accvgpr_write_b32 a205, v101
    v_accvgpr_write_b32 a207, v117
    v_mul_f32 v136, v128, v136
    v_mul_f32 v152, v144, v152
    v_mul_f32 v137, v129, v137
    v_mul_f32 v153, v145, v153
    v_mul_f32 v138, v130, v138
    v_mul_f32 v154, v146, v154
    v_mul_f32 v139, v131, v139
    v_mul_f32 v155, v147, v155
    v_mul_f32 v128, s34, v128
    v_mul_f32 v144, s34, v144
    v_mul_f32 v129, s34, v129
    v_mul_f32 v145, s34, v145
    v_mul_f32 v130, s34, v130
    v_mul_f32 v146, s34, v146
    v_mul_f32 v131, s34, v131
    v_mul_f32 v147, s34, v147
    v_exp_f32 v128, v128
    v_exp_f32 v144, v144
    v_exp_f32 v129, v129
    v_exp_f32 v145, v145
    v_exp_f32 v130, v130
    v_exp_f32 v146, v146
    v_exp_f32 v131, v131
    v_exp_f32 v147, v147
    v_add_f32 v128, 1.0, v128
    v_add_f32 v144, 1.0, v144
    v_add_f32 v129, 1.0, v129
    v_add_f32 v145, 1.0, v145
    v_add_f32 v130, 1.0, v130
    v_add_f32 v146, 1.0, v146
    v_add_f32 v131, 1.0, v131
    v_add_f32 v147, 1.0, v147
    v_rcp_f32 v128, v128
    v_rcp_f32 v144, v144
    v_rcp_f32 v129, v129
    v_rcp_f32 v145, v145
    v_rcp_f32 v130, v130
    v_rcp_f32 v146, v146
    v_rcp_f32 v131, v131
    v_rcp_f32 v147, v147
    v_mul_f32 v136, v136, v128
    v_mul_f32 v152, v152, v144
    v_mul_f32 v137, v137, v129
    v_mul_f32 v153, v153, v145
    v_mul_f32 v138, v138, v130
    v_mul_f32 v154, v154, v146
    v_mul_f32 v139, v139, v131
    v_mul_f32 v155, v155, v147
    v_cvt_pk_bf16_f32 v128, v136, v137
    v_cvt_pk_bf16_f32 v144, v152, v153
    v_cvt_pk_bf16_f32 v129, v138, v139
    v_cvt_pk_bf16_f32 v145, v154, v155
    v_accvgpr_write_b32 a208, v128
    v_accvgpr_write_b32 a210, v144
    v_accvgpr_write_b32 a209, v129
    v_accvgpr_write_b32 a211, v145
    v_mul_f32 v140, v132, v140
    v_mul_f32 v156, v148, v156
    v_mul_f32 v141, v133, v141
    v_mul_f32 v157, v149, v157
    v_mul_f32 v142, v134, v142
    v_mul_f32 v158, v150, v158
    v_mul_f32 v143, v135, v143
    v_mul_f32 v159, v151, v159
    v_mul_f32 v132, s34, v132
    v_mul_f32 v148, s34, v148
    v_mul_f32 v133, s34, v133
    v_mul_f32 v149, s34, v149
    v_mul_f32 v134, s34, v134
    v_mul_f32 v150, s34, v150
    v_mul_f32 v135, s34, v135
    v_mul_f32 v151, s34, v151
    v_exp_f32 v132, v132
    v_exp_f32 v148, v148
    v_exp_f32 v133, v133
    v_exp_f32 v149, v149
    v_exp_f32 v134, v134
    v_exp_f32 v150, v150
    v_exp_f32 v135, v135
    v_exp_f32 v151, v151
    v_add_f32 v132, 1.0, v132
    v_add_f32 v148, 1.0, v148
    v_add_f32 v133, 1.0, v133
    v_add_f32 v149, 1.0, v149
    v_add_f32 v134, 1.0, v134
    v_add_f32 v150, 1.0, v150
    v_add_f32 v135, 1.0, v135
    v_add_f32 v151, 1.0, v151
    v_rcp_f32 v132, v132
    v_rcp_f32 v148, v148
    v_rcp_f32 v133, v133
    v_rcp_f32 v149, v149
    v_rcp_f32 v134, v134
    v_rcp_f32 v150, v150
    v_rcp_f32 v135, v135
    v_rcp_f32 v151, v151
    v_mul_f32 v140, v140, v132
    v_mul_f32 v156, v156, v148
    v_mul_f32 v141, v141, v133
    v_mul_f32 v157, v157, v149
    v_mul_f32 v142, v142, v134
    v_mul_f32 v158, v158, v150
    v_mul_f32 v143, v143, v135
    v_mul_f32 v159, v159, v151
    v_cvt_pk_bf16_f32 v132, v140, v141
    v_cvt_pk_bf16_f32 v148, v156, v157
    v_cvt_pk_bf16_f32 v133, v142, v143
    v_cvt_pk_bf16_f32 v149, v158, v159
    v_accvgpr_write_b32 a212, v132
    v_accvgpr_write_b32 a214, v148
    v_accvgpr_write_b32 a213, v133
    v_accvgpr_write_b32 a215, v149
    v_mfma_f32_16x16x32_bf16 v[252:255], a[232:235], a[180:183], v[252:255]
    ds_read_b64_tr_b16 a[228:229], v22 offset:36864
    ds_read_b64_tr_b16 a[230:231], v22 offset:38912
    v_mfma_f32_16x16x32_bf16 v[236:239], a[232:235], a[176:179], v[236:239]
    buffer_load_dwordx4 v13, s[12:15], s73 offen offset:2048 lds
    v_mfma_f32_16x16x32_bf16 v[224:227], a[236:239], a[184:187], v[224:227]
    s_waitcnt lgkmcnt(8)
    ds_read_b64_tr_b16 a[232:233], v19 offset:40960
    ds_read_b64_tr_b16 a[234:235], v19 offset:43008
    v_mfma_f32_16x16x32_bf16 v[240:243], a[236:239], a[188:191], v[240:243]
    s_add_u32 m0, s23, 49152
    v_mfma_f32_16x16x32_bf16 v[244:247], a[240:243], a[188:191], v[244:247]
    ds_read_b64_tr_b16 a[236:237], v20 offset:40960
    ds_read_b64_tr_b16 a[238:239], v20 offset:43008
    v_mfma_f32_16x16x32_bf16 v[228:231], a[240:243], a[184:187], v[228:231]
    buffer_load_dwordx4 v14, s[12:15], s73 offen offset:0 lds
    v_mfma_f32_16x16x32_bf16 v[232:235], a[244:247], a[184:187], v[232:235]
    ds_read_b64_tr_b16 a[240:241], v21 offset:40960
    ds_read_b64_tr_b16 a[242:243], v21 offset:43008
    v_mfma_f32_16x16x32_bf16 v[248:251], a[244:247], a[188:191], v[248:251]
    buffer_load_dwordx4 v15, s[12:15], s73 offen offset:1024 lds
    v_mfma_f32_16x16x32_bf16 v[252:255], a[248:251], a[188:191], v[252:255]
    s_waitcnt lgkmcnt(8)
    ds_read_b64_tr_b16 a[244:245], v22 offset:40960
    ds_read_b64_tr_b16 a[246:247], v22 offset:43008
    v_mfma_f32_16x16x32_bf16 v[236:239], a[248:251], a[184:187], v[236:239]
    buffer_load_dwordx4 v16, s[12:15], s73 offen offset:2048 lds
    v_mfma_f32_16x16x32_bf16 v[160:163], a[216:219], a[192:195], v[160:163]
    ds_read_b64_tr_b16 a[248:249], v19 offset:45056
    ds_read_b64_tr_b16 a[250:251], v19 offset:47104
    v_mfma_f32_16x16x32_bf16 v[176:179], a[216:219], a[196:199], v[176:179]
    v_mfma_f32_16x16x32_bf16 v[180:183], a[220:223], a[196:199], v[180:183]
    ds_read_b64_tr_b16 a[216:217], v20 offset:45056
    ds_read_b64_tr_b16 a[218:219], v20 offset:47104
    v_mfma_f32_16x16x32_bf16 v[164:167], a[220:223], a[192:195], v[164:167]
    v_mfma_f32_16x16x32_bf16 v[168:171], a[224:227], a[192:195], v[168:171]
    s_waitcnt lgkmcnt(8)
    ds_read_b64_tr_b16 a[220:221], v21 offset:45056
    ds_read_b64_tr_b16 a[222:223], v21 offset:47104
    v_mfma_f32_16x16x32_bf16 v[184:187], a[224:227], a[196:199], v[184:187]
    v_mfma_f32_16x16x32_bf16 v[188:191], a[228:231], a[196:199], v[188:191]
    ds_read_b64_tr_b16 a[224:225], v22 offset:45056
    ds_read_b64_tr_b16 a[226:227], v22 offset:47104
    v_mfma_f32_16x16x32_bf16 v[172:175], a[228:231], a[192:195], v[172:175]
    v_mfma_f32_16x16x32_bf16 v[160:163], a[232:235], a[200:203], v[160:163]
    ds_read_b64_tr_b16 a[228:229], v19 offset:49152
    ds_read_b64_tr_b16 a[230:231], v19 offset:51200
    v_mfma_f32_16x16x32_bf16 v[176:179], a[232:235], a[204:207], v[176:179]
    s_add_u32 m0, s23, 61440
    v_mfma_f32_16x16x32_bf16 v[180:183], a[236:239], a[204:207], v[180:183]
    s_waitcnt lgkmcnt(8)
    ds_read_b64_tr_b16 a[232:233], v20 offset:49152
    ds_read_b64_tr_b16 a[234:235], v20 offset:51200
    v_mfma_f32_16x16x32_bf16 v[164:167], a[236:239], a[200:203], v[164:167]
    buffer_load_dwordx4 v8, s[12:15], s74 offen offset:0 lds
    v_mfma_f32_16x16x32_bf16 v[168:171], a[240:243], a[200:203], v[168:171]
    ds_read_b64_tr_b16 a[236:237], v21 offset:49152
    ds_read_b64_tr_b16 a[238:239], v21 offset:51200
    v_mfma_f32_16x16x32_bf16 v[184:187], a[240:243], a[204:207], v[184:187]
    buffer_load_dwordx4 v9, s[12:15], s74 offen offset:1024 lds
    v_mfma_f32_16x16x32_bf16 v[188:191], a[244:247], a[204:207], v[188:191]
    ds_read_b64_tr_b16 a[240:241], v22 offset:49152
    ds_read_b64_tr_b16 a[242:243], v22 offset:51200
    v_mfma_f32_16x16x32_bf16 v[172:175], a[244:247], a[200:203], v[172:175]
    buffer_load_dwordx4 v10, s[12:15], s74 offen offset:2048 lds
    v_mfma_f32_16x16x32_bf16 v[160:163], a[248:251], a[208:211], v[160:163]
    s_waitcnt lgkmcnt(8)
    ds_read_b64_tr_b16 a[244:245], v19 offset:53248
    ds_read_b64_tr_b16 a[246:247], v19 offset:55296
    v_mfma_f32_16x16x32_bf16 v[176:179], a[248:251], a[212:215], v[176:179]
    v_mfma_f32_16x16x32_bf16 v[180:183], a[216:219], a[212:215], v[180:183]
    ds_read_b64_tr_b16 a[248:249], v20 offset:53248
    ds_read_b64_tr_b16 a[250:251], v20 offset:55296
    v_mfma_f32_16x16x32_bf16 v[164:167], a[216:219], a[208:211], v[164:167]
    v_mfma_f32_16x16x32_bf16 v[168:171], a[220:223], a[208:211], v[168:171]
    ds_read_b64_tr_b16 a[216:217], v21 offset:53248
    ds_read_b64_tr_b16 a[218:219], v21 offset:55296
    v_mfma_f32_16x16x32_bf16 v[184:187], a[220:223], a[212:215], v[184:187]
    v_mfma_f32_16x16x32_bf16 v[188:191], a[224:227], a[212:215], v[188:191]
    s_waitcnt lgkmcnt(8)
    ds_read_b64_tr_b16 a[220:221], v22 offset:53248
    ds_read_b64_tr_b16 a[222:223], v22 offset:55296
    v_mfma_f32_16x16x32_bf16 v[172:175], a[224:227], a[208:211], v[172:175]
    v_mfma_f32_16x16x32_bf16 v[192:195], a[228:231], a[192:195], v[192:195]
    ds_read_b64_tr_b16 a[224:225], v19 offset:57344
    ds_read_b64_tr_b16 a[226:227], v19 offset:59392
    v_mfma_f32_16x16x32_bf16 v[208:211], a[228:231], a[196:199], v[208:211]
    v_mfma_f32_16x16x32_bf16 v[212:215], a[232:235], a[196:199], v[212:215]
    ds_read_b64_tr_b16 a[228:229], v20 offset:57344
    ds_read_b64_tr_b16 a[230:231], v20 offset:59392
    v_mfma_f32_16x16x32_bf16 v[196:199], a[232:235], a[192:195], v[196:199]
    v_mfma_f32_16x16x32_bf16 v[200:203], a[236:239], a[192:195], v[200:203]
    s_waitcnt lgkmcnt(8)
    ds_read_b64_tr_b16 a[232:233], v21 offset:57344
    ds_read_b64_tr_b16 a[234:235], v21 offset:59392
    v_mfma_f32_16x16x32_bf16 v[216:219], a[236:239], a[196:199], v[216:219]
    v_mfma_f32_16x16x32_bf16 v[220:223], a[240:243], a[196:199], v[220:223]
    s_waitcnt vmcnt(18)
    ds_read_b64_tr_b16 a[236:237], v22 offset:57344
    ds_read_b64_tr_b16 a[238:239], v22 offset:59392
    v_mfma_f32_16x16x32_bf16 v[204:207], a[240:243], a[192:195], v[204:207]
    s_barrier
    v_mfma_f32_16x16x32_bf16 v[192:195], a[244:247], a[200:203], v[192:195]
    ds_read_b64_tr_b16 a[240:241], v19 offset:61440
    ds_read_b64_tr_b16 a[242:243], v19 offset:63488
    v_mfma_f32_16x16x32_bf16 v[208:211], a[244:247], a[204:207], v[208:211]
    s_lshl_b32 s27, s69, 8
    s_add_u32 s27, s27, s26
    v_mfma_f32_16x16x32_bf16 v[212:215], a[248:251], a[204:207], v[212:215]
    s_waitcnt lgkmcnt(8)
    ds_read_b64_tr_b16 a[244:245], v20 offset:61440
    ds_read_b64_tr_b16 a[246:247], v20 offset:63488
    v_mfma_f32_16x16x32_bf16 v[196:199], a[248:251], a[200:203], v[196:199]
    v_cvt_pk_bf16_f32 v160, v160, v161
    v_cvt_pk_bf16_f32 v161, v162, v163
    v_cvt_pk_bf16_f32 v162, v164, v165
    v_mfma_f32_16x16x32_bf16 v[200:203], a[216:219], a[200:203], v[200:203]
    ds_read_b64_tr_b16 a[248:249], v21 offset:61440
    ds_read_b64_tr_b16 a[250:251], v21 offset:63488
    v_mfma_f32_16x16x32_bf16 v[216:219], a[216:219], a[204:207], v[216:219]
    v_cvt_pk_bf16_f32 v163, v166, v167
    s_add_u32 m0, s23, 73728
    v_mfma_f32_16x16x32_bf16 v[220:223], a[220:223], a[204:207], v[220:223]
    ds_read_b64_tr_b16 a[216:217], v22 offset:61440
    ds_read_b64_tr_b16 a[218:219], v22 offset:63488
    v_mfma_f32_16x16x32_bf16 v[204:207], a[220:223], a[200:203], v[204:207]
    v_add_u32 v19, 61440, v19
    v_add_u32 v20, 61440, v20
    v_add_u32 v21, 61440, v21
    v_add_u32 v22, 61440, v22
    v_mfma_f32_16x16x32_bf16 v[192:195], a[224:227], a[208:211], v[192:195]
    s_waitcnt lgkmcnt(8)
    ds_read_b64_tr_b16 a[220:221], v19 offset:4096
    ds_read_b64_tr_b16 a[222:223], v19 offset:6144
    v_mfma_f32_16x16x32_bf16 v[208:211], a[224:227], a[212:215], v[208:211]
    buffer_store_dwordx4 v[160:163], v23, s[16:19], s27 offen sc0 sc1
    v_mfma_f32_16x16x32_bf16 v[212:215], a[228:231], a[212:215], v[212:215]
    ds_read_b64_tr_b16 a[224:225], v20 offset:4096
    ds_read_b64_tr_b16 a[226:227], v20 offset:6144
    v_mfma_f32_16x16x32_bf16 v[196:199], a[228:231], a[208:211], v[196:199]
    v_cvt_pk_bf16_f32 v164, v168, v169
    v_cvt_pk_bf16_f32 v165, v170, v171
    v_cvt_pk_bf16_f32 v166, v172, v173
    v_mfma_f32_16x16x32_bf16 v[200:203], a[232:235], a[208:211], v[200:203]
    ds_read_b64_tr_b16 a[228:229], v21 offset:4096
    ds_read_b64_tr_b16 a[230:231], v21 offset:6144
    v_mfma_f32_16x16x32_bf16 v[216:219], a[232:235], a[212:215], v[216:219]
    v_cvt_pk_bf16_f32 v167, v174, v175
    v_mfma_f32_16x16x32_bf16 v[220:223], a[236:239], a[212:215], v[220:223]
    s_waitcnt lgkmcnt(8)
    ds_read_b64_tr_b16 a[232:233], v22 offset:4096
    ds_read_b64_tr_b16 a[234:235], v22 offset:6144
    v_mfma_f32_16x16x32_bf16 v[204:207], a[236:239], a[208:211], v[204:207]
    buffer_store_dwordx4 v[164:167], v24, s[16:19], s27 offen sc0 sc1
    v_mfma_f32_16x16x32_bf16 v[224:227], a[240:243], a[192:195], v[224:227]
    ds_read_b64_tr_b16 a[236:237], v19 offset:8192
    ds_read_b64_tr_b16 a[238:239], v19 offset:10240
    v_mfma_f32_16x16x32_bf16 v[240:243], a[240:243], a[196:199], v[240:243]
    v_cvt_pk_bf16_f32 v176, v176, v177
    v_cvt_pk_bf16_f32 v177, v178, v179
    v_cvt_pk_bf16_f32 v178, v180, v181
    v_mfma_f32_16x16x32_bf16 v[244:247], a[244:247], a[196:199], v[244:247]
    ds_read_b64_tr_b16 a[240:241], v20 offset:8192
    ds_read_b64_tr_b16 a[242:243], v20 offset:10240
    v_mfma_f32_16x16x32_bf16 v[228:231], a[244:247], a[192:195], v[228:231]
    v_cvt_pk_bf16_f32 v179, v182, v183
    v_mfma_f32_16x16x32_bf16 v[232:235], a[248:251], a[192:195], v[232:235]
    s_waitcnt lgkmcnt(8)
    ds_read_b64_tr_b16 a[244:245], v21 offset:8192
    ds_read_b64_tr_b16 a[246:247], v21 offset:10240
    v_mfma_f32_16x16x32_bf16 v[248:251], a[248:251], a[196:199], v[248:251]
    buffer_store_dwordx4 v[176:179], v25, s[16:19], s27 offen sc0 sc1
    v_mfma_f32_16x16x32_bf16 v[252:255], a[216:219], a[196:199], v[252:255]
    ds_read_b64_tr_b16 a[248:249], v22 offset:8192
    ds_read_b64_tr_b16 a[250:251], v22 offset:10240
    v_mfma_f32_16x16x32_bf16 v[236:239], a[216:219], a[192:195], v[236:239]
    buffer_load_dwordx4 v11, s[12:15], s74 offen offset:0 lds
    v_cvt_pk_bf16_f32 v180, v184, v185
    v_cvt_pk_bf16_f32 v181, v186, v187
    v_cvt_pk_bf16_f32 v182, v188, v189
    v_cvt_pk_bf16_f32 v183, v190, v191
    v_mfma_f32_16x16x32_bf16 v[224:227], a[220:223], a[200:203], v[224:227]
    ds_read_b64_tr_b16 a[216:217], v19 offset:12288
    ds_read_b64_tr_b16 a[218:219], v19 offset:14336
    v_mfma_f32_16x16x32_bf16 v[240:243], a[220:223], a[204:207], v[240:243]
    buffer_load_dwordx4 v12, s[12:15], s74 offen offset:1024 lds
    s_lshl_b32 s29, s70, 8
    v_mfma_f32_16x16x32_bf16 v[244:247], a[224:227], a[204:207], v[244:247]
    s_waitcnt lgkmcnt(8)
    ds_read_b64_tr_b16 a[220:221], v20 offset:12288
    ds_read_b64_tr_b16 a[222:223], v20 offset:14336
    v_mfma_f32_16x16x32_bf16 v[228:231], a[224:227], a[200:203], v[228:231]
    buffer_store_dwordx4 v[180:183], v26, s[16:19], s27 offen sc0 sc1
    v_mfma_f32_16x16x32_bf16 v[232:235], a[228:231], a[200:203], v[232:235]
    ds_read_b64_tr_b16 a[224:225], v21 offset:12288
    ds_read_b64_tr_b16 a[226:227], v21 offset:14336
    v_mfma_f32_16x16x32_bf16 v[248:251], a[228:231], a[204:207], v[248:251]
    buffer_load_dwordx4 v13, s[12:15], s74 offen offset:2048 lds
    s_add_u32 s29, s29, s26
    v_mfma_f32_16x16x32_bf16 v[252:255], a[232:235], a[204:207], v[252:255]
    ds_read_b64_tr_b16 a[228:229], v22 offset:12288
    ds_read_b64_tr_b16 a[230:231], v22 offset:14336
    v_mfma_f32_16x16x32_bf16 v[236:239], a[232:235], a[200:203], v[236:239]
    v_cvt_pk_bf16_f32 v192, v192, v193
    v_cvt_pk_bf16_f32 v193, v194, v195
    v_cvt_pk_bf16_f32 v194, v196, v197
    v_mfma_f32_16x16x32_bf16 v[224:227], a[236:239], a[208:211], v[224:227]
    s_waitcnt lgkmcnt(8)
    ds_read_b64_tr_b16 a[232:233], v19 offset:16384
    ds_read_b64_tr_b16 a[234:235], v19 offset:18432
    v_mfma_f32_16x16x32_bf16 v[240:243], a[236:239], a[212:215], v[240:243]
    v_cvt_pk_bf16_f32 v195, v198, v199
    s_add_u32 m0, s23, 86016
    v_mfma_f32_16x16x32_bf16 v[244:247], a[240:243], a[212:215], v[244:247]
    ds_read_b64_tr_b16 a[236:237], v20 offset:16384
    ds_read_b64_tr_b16 a[238:239], v20 offset:18432
    v_mfma_f32_16x16x32_bf16 v[228:231], a[240:243], a[208:211], v[228:231]
    buffer_store_dwordx4 v[192:195], v23, s[16:19], s29 offen sc0 sc1
    v_mfma_f32_16x16x32_bf16 v[232:235], a[244:247], a[208:211], v[232:235]
    ds_read_b64_tr_b16 a[240:241], v21 offset:16384
    ds_read_b64_tr_b16 a[242:243], v21 offset:18432
    v_mfma_f32_16x16x32_bf16 v[248:251], a[244:247], a[212:215], v[248:251]
    v_cvt_pk_bf16_f32 v196, v200, v201
    v_cvt_pk_bf16_f32 v197, v202, v203
    v_cvt_pk_bf16_f32 v198, v204, v205
    v_mfma_f32_16x16x32_bf16 v[252:255], a[248:251], a[212:215], v[252:255]
    s_waitcnt lgkmcnt(8)
    ds_read_b64_tr_b16 a[244:245], v22 offset:16384
    ds_read_b64_tr_b16 a[246:247], v22 offset:18432
    v_mfma_f32_16x16x32_bf16 v[236:239], a[248:251], a[208:211], v[236:239]
    v_cvt_pk_bf16_f32 v199, v206, v207
    v_mfma_f32_16x16x32_bf16 v[64:67], a[216:219], a[144:147], 0
    ds_read_b64_tr_b16 a[248:249], v19 offset:20480
    ds_read_b64_tr_b16 a[250:251], v19 offset:22528
    v_mfma_f32_16x16x32_bf16 v[80:83], a[216:219], a[148:151], 0
    buffer_store_dwordx4 v[196:199], v24, s[16:19], s29 offen sc0 sc1
    v_mfma_f32_16x16x32_bf16 v[84:87], a[220:223], a[148:151], 0
    ds_read_b64_tr_b16 a[216:217], v20 offset:20480
    ds_read_b64_tr_b16 a[218:219], v20 offset:22528
    v_mfma_f32_16x16x32_bf16 v[68:71], a[220:223], a[144:147], 0
    v_cvt_pk_bf16_f32 v208, v208, v209
    v_cvt_pk_bf16_f32 v209, v210, v211
    v_cvt_pk_bf16_f32 v210, v212, v213
    v_cvt_pk_bf16_f32 v211, v214, v215
    v_mfma_f32_16x16x32_bf16 v[72:75], a[224:227], a[144:147], 0
    s_waitcnt lgkmcnt(8)
    ds_read_b64_tr_b16 a[220:221], v21 offset:20480
    ds_read_b64_tr_b16 a[222:223], v21 offset:22528
    v_mfma_f32_16x16x32_bf16 v[88:91], a[224:227], a[148:151], 0
    buffer_store_dwordx4 v[208:211], v25, s[16:19], s29 offen sc0 sc1
    v_mfma_f32_16x16x32_bf16 v[92:95], a[228:231], a[148:151], 0
    s_waitcnt vmcnt(22)
    ds_read_b64_tr_b16 a[224:225], v22 offset:20480
    ds_read_b64_tr_b16 a[226:227], v22 offset:22528
    v_mfma_f32_16x16x32_bf16 v[76:79], a[228:231], a[144:147], 0
    s_barrier
    v_subrev_u32 v19, 122880, v19
    v_subrev_u32 v20, 122880, v20
    v_subrev_u32 v21, 122880, v21
    v_subrev_u32 v22, 122880, v22
    v_mfma_f32_16x16x32_bf16 v[64:67], a[232:235], a[152:155], v[64:67]
    ds_read_b64_tr_b16 a[228:229], v19 offset:0
    ds_read_b64_tr_b16 a[230:231], v19 offset:2048
    v_mfma_f32_16x16x32_bf16 v[80:83], a[232:235], a[156:159], v[80:83]
    buffer_load_dwordx4 v14, s[12:15], s74 offen offset:0 lds
    v_cvt_pk_bf16_f32 v212, v216, v217
    v_cvt_pk_bf16_f32 v213, v218, v219
    v_cvt_pk_bf16_f32 v214, v220, v221
    v_cvt_pk_bf16_f32 v215, v222, v223
    v_mfma_f32_16x16x32_bf16 v[84:87], a[236:239], a[156:159], v[84:87]
    s_waitcnt lgkmcnt(8)
    ds_read_b64_tr_b16 a[232:233], v20 offset:0
    ds_read_b64_tr_b16 a[234:235], v20 offset:2048
    v_mfma_f32_16x16x32_bf16 v[68:71], a[236:239], a[152:155], v[68:71]
    buffer_load_dwordx4 v15, s[12:15], s74 offen offset:1024 lds
    s_lshl_b32 s30, s71, 8
    v_mfma_f32_16x16x32_bf16 v[72:75], a[240:243], a[152:155], v[72:75]
    ds_read_b64_tr_b16 a[236:237], v21 offset:0
    ds_read_b64_tr_b16 a[238:239], v21 offset:2048
    v_mfma_f32_16x16x32_bf16 v[88:91], a[240:243], a[156:159], v[88:91]
    buffer_store_dwordx4 v[212:215], v26, s[16:19], s29 offen sc0 sc1
    v_mfma_f32_16x16x32_bf16 v[92:95], a[244:247], a[156:159], v[92:95]
    ds_read_b64_tr_b16 a[240:241], v22 offset:0
    ds_read_b64_tr_b16 a[242:243], v22 offset:2048
    v_mfma_f32_16x16x32_bf16 v[76:79], a[244:247], a[152:155], v[76:79]
    buffer_load_dwordx4 v16, s[12:15], s74 offen offset:2048 lds
    s_add_u32 s30, s30, s26
    v_mfma_f32_16x16x32_bf16 v[64:67], a[248:251], a[160:163], v[64:67]
    s_waitcnt lgkmcnt(8)
    ds_read_b64_tr_b16 a[244:245], v19 offset:4096
    ds_read_b64_tr_b16 a[246:247], v19 offset:6144
    v_mfma_f32_16x16x32_bf16 v[80:83], a[248:251], a[164:167], v[80:83]
    v_cvt_pk_bf16_f32 v224, v224, v225
    v_cvt_pk_bf16_f32 v225, v226, v227
    v_cvt_pk_bf16_f32 v226, v228, v229
    v_mfma_f32_16x16x32_bf16 v[84:87], a[216:219], a[164:167], v[84:87]
    ds_read_b64_tr_b16 a[248:249], v20 offset:4096
    ds_read_b64_tr_b16 a[250:251], v20 offset:6144
    v_mfma_f32_16x16x32_bf16 v[68:71], a[216:219], a[160:163], v[68:71]
    v_cvt_pk_bf16_f32 v227, v230, v231
    s_add_u32 m0, s23, 98304
    v_mfma_f32_16x16x32_bf16 v[72:75], a[220:223], a[160:163], v[72:75]
    ds_read_b64_tr_b16 a[216:217], v21 offset:4096
    ds_read_b64_tr_b16 a[218:219], v21 offset:6144
    v_mfma_f32_16x16x32_bf16 v[88:91], a[220:223], a[164:167], v[88:91]
    buffer_store_dwordx4 v[224:227], v23, s[16:19], s30 offen sc0 sc1
    v_mfma_f32_16x16x32_bf16 v[92:95], a[224:227], a[164:167], v[92:95]
    s_waitcnt lgkmcnt(8)
    ds_read_b64_tr_b16 a[220:221], v22 offset:4096
    ds_read_b64_tr_b16 a[222:223], v22 offset:6144
    v_mfma_f32_16x16x32_bf16 v[76:79], a[224:227], a[160:163], v[76:79]
    v_cvt_pk_bf16_f32 v228, v232, v233
    v_cvt_pk_bf16_f32 v229, v234, v235
    v_cvt_pk_bf16_f32 v230, v236, v237
    v_mfma_f32_16x16x32_bf16 v[64:67], a[228:231], a[168:171], v[64:67]
    ds_read_b64_tr_b16 a[224:225], v19 offset:8192
    ds_read_b64_tr_b16 a[226:227], v19 offset:10240
    v_mfma_f32_16x16x32_bf16 v[80:83], a[228:231], a[172:175], v[80:83]
    buffer_load_dwordx4 v8, s[12:15], s75 offen offset:0 lds
    v_cvt_pk_bf16_f32 v231, v238, v239
    v_mfma_f32_16x16x32_bf16 v[84:87], a[232:235], a[172:175], v[84:87]
    ds_read_b64_tr_b16 a[228:229], v20 offset:8192
    ds_read_b64_tr_b16 a[230:231], v20 offset:10240
    v_mfma_f32_16x16x32_bf16 v[68:71], a[232:235], a[168:171], v[68:71]
    buffer_store_dwordx4 v[228:231], v24, s[16:19], s30 offen sc0 sc1
    v_mfma_f32_16x16x32_bf16 v[72:75], a[236:239], a[168:171], v[72:75]
    s_waitcnt lgkmcnt(8)
    ds_read_b64_tr_b16 a[232:233], v21 offset:8192
    ds_read_b64_tr_b16 a[234:235], v21 offset:10240
    v_mfma_f32_16x16x32_bf16 v[88:91], a[236:239], a[172:175], v[88:91]
    buffer_load_dwordx4 v9, s[12:15], s75 offen offset:1024 lds
    v_cvt_pk_bf16_f32 v240, v240, v241
    v_mfma_f32_16x16x32_bf16 v[92:95], a[240:243], a[172:175], v[92:95]
    ds_read_b64_tr_b16 a[236:237], v22 offset:8192
    ds_read_b64_tr_b16 a[238:239], v22 offset:10240
    v_mfma_f32_16x16x32_bf16 v[76:79], a[240:243], a[168:171], v[76:79]
    buffer_load_dwordx4 v10, s[12:15], s75 offen offset:2048 lds
    v_cvt_pk_bf16_f32 v241, v242, v243
    v_mfma_f32_16x16x32_bf16 v[64:67], a[244:247], a[176:179], v[64:67]
    ds_read_b64_tr_b16 a[240:241], v19 offset:12288
    ds_read_b64_tr_b16 a[242:243], v19 offset:14336
    v_mfma_f32_16x16x32_bf16 v[80:83], a[244:247], a[180:183], v[80:83]
    v_cvt_pk_bf16_f32 v242, v244, v245
    v_cvt_pk_bf16_f32 v243, v246, v247
    v_mfma_f32_16x16x32_bf16 v[84:87], a[248:251], a[180:183], v[84:87]
    s_waitcnt lgkmcnt(8)
    ds_read_b64_tr_b16 a[244:245], v20 offset:12288
    ds_read_b64_tr_b16 a[246:247], v20 offset:14336
    v_mfma_f32_16x16x32_bf16 v[68:71], a[248:251], a[176:179], v[68:71]
    buffer_store_dwordx4 v[240:243], v25, s[16:19], s30 offen sc0 sc1
    v_mfma_f32_16x16x32_bf16 v[72:75], a[216:219], a[176:179], v[72:75]
    ds_read_b64_tr_b16 a[248:249], v21 offset:12288
    ds_read_b64_tr_b16 a[250:251], v21 offset:14336
    v_mfma_f32_16x16x32_bf16 v[88:91], a[216:219], a[180:183], v[88:91]
    v_cvt_pk_bf16_f32 v244, v248, v249
    v_cvt_pk_bf16_f32 v245, v250, v251
    v_cvt_pk_bf16_f32 v246, v252, v253
    v_cvt_pk_bf16_f32 v247, v254, v255
    v_mfma_f32_16x16x32_bf16 v[92:95], a[220:223], a[180:183], v[92:95]
    ds_read_b64_tr_b16 a[216:217], v22 offset:12288
    ds_read_b64_tr_b16 a[218:219], v22 offset:14336
    v_mfma_f32_16x16x32_bf16 v[76:79], a[220:223], a[176:179], v[76:79]
    buffer_store_dwordx4 v[244:247], v26, s[16:19], s30 offen sc0 sc1
    v_mfma_f32_16x16x32_bf16 v[64:67], a[224:227], a[184:187], v[64:67]
    s_waitcnt lgkmcnt(8)
    ds_read_b64_tr_b16 a[220:221], v19 offset:16384
    ds_read_b64_tr_b16 a[222:223], v19 offset:18432
    v_mfma_f32_16x16x32_bf16 v[80:83], a[224:227], a[188:191], v[80:83]
    s_add_u32 m0, s23, 110592
    v_mfma_f32_16x16x32_bf16 v[84:87], a[228:231], a[188:191], v[84:87]
    ds_read_b64_tr_b16 a[224:225], v20 offset:16384
    ds_read_b64_tr_b16 a[226:227], v20 offset:18432
    v_mfma_f32_16x16x32_bf16 v[68:71], a[228:231], a[184:187], v[68:71]
    buffer_load_dwordx4 v11, s[12:15], s75 offen offset:0 lds
    v_mfma_f32_16x16x32_bf16 v[72:75], a[232:235], a[184:187], v[72:75]
    ds_read_b64_tr_b16 a[228:229], v21 offset:16384
    ds_read_b64_tr_b16 a[230:231], v21 offset:18432
    v_mfma_f32_16x16x32_bf16 v[88:91], a[232:235], a[188:191], v[88:91]
    buffer_load_dwordx4 v12, s[12:15], s75 offen offset:1024 lds
    v_mfma_f32_16x16x32_bf16 v[92:95], a[236:239], a[188:191], v[92:95]
    s_waitcnt lgkmcnt(8)
    ds_read_b64_tr_b16 a[232:233], v22 offset:16384
    ds_read_b64_tr_b16 a[234:235], v22 offset:18432
    v_mfma_f32_16x16x32_bf16 v[76:79], a[236:239], a[184:187], v[76:79]
    buffer_load_dwordx4 v13, s[12:15], s75 offen offset:2048 lds
    v_mfma_f32_16x16x32_bf16 v[64:67], a[240:243], a[192:195], v[64:67]
    ds_read_b64_tr_b16 a[236:237], v19 offset:20480
    ds_read_b64_tr_b16 a[238:239], v19 offset:22528
    v_mfma_f32_16x16x32_bf16 v[80:83], a[240:243], a[196:199], v[80:83]
    v_mfma_f32_16x16x32_bf16 v[84:87], a[244:247], a[196:199], v[84:87]
    ds_read_b64_tr_b16 a[240:241], v20 offset:20480
    ds_read_b64_tr_b16 a[242:243], v20 offset:22528
    v_mfma_f32_16x16x32_bf16 v[68:71], a[244:247], a[192:195], v[68:71]
    v_mfma_f32_16x16x32_bf16 v[72:75], a[248:251], a[192:195], v[72:75]
    s_waitcnt lgkmcnt(8)
    ds_read_b64_tr_b16 a[244:245], v21 offset:20480
    ds_read_b64_tr_b16 a[246:247], v21 offset:22528
    v_mfma_f32_16x16x32_bf16 v[88:91], a[248:251], a[196:199], v[88:91]
    v_mfma_f32_16x16x32_bf16 v[92:95], a[216:219], a[196:199], v[92:95]
    s_waitcnt vmcnt(30)
    ds_read_b64_tr_b16 a[248:249], v22 offset:20480
    ds_read_b64_tr_b16 a[250:251], v22 offset:22528
    v_mfma_f32_16x16x32_bf16 v[76:79], a[216:219], a[192:195], v[76:79]
    s_barrier
    v_mfma_f32_16x16x32_bf16 v[64:67], a[220:223], a[200:203], v[64:67]
    ds_read_b64_tr_b16 a[216:217], v19 offset:24576
    ds_read_b64_tr_b16 a[218:219], v19 offset:26624
    v_mfma_f32_16x16x32_bf16 v[80:83], a[220:223], a[204:207], v[80:83]
    v_mfma_f32_16x16x32_bf16 v[84:87], a[224:227], a[204:207], v[84:87]
    s_waitcnt lgkmcnt(8)
    ds_read_b64_tr_b16 a[220:221], v20 offset:24576
    ds_read_b64_tr_b16 a[222:223], v20 offset:26624
    v_mfma_f32_16x16x32_bf16 v[68:71], a[224:227], a[200:203], v[68:71]
    s_add_u32 m0, s23, 122880
    v_mfma_f32_16x16x32_bf16 v[72:75], a[228:231], a[200:203], v[72:75]
    ds_read_b64_tr_b16 a[224:225], v21 offset:24576
    ds_read_b64_tr_b16 a[226:227], v21 offset:26624
    v_mfma_f32_16x16x32_bf16 v[88:91], a[228:231], a[204:207], v[88:91]
    buffer_load_dwordx4 v14, s[12:15], s75 offen offset:0 lds
    v_mfma_f32_16x16x32_bf16 v[92:95], a[232:235], a[204:207], v[92:95]
    ds_read_b64_tr_b16 a[228:229], v22 offset:24576
    ds_read_b64_tr_b16 a[230:231], v22 offset:26624
    v_mfma_f32_16x16x32_bf16 v[76:79], a[232:235], a[200:203], v[76:79]
    buffer_load_dwordx4 v15, s[12:15], s75 offen offset:1024 lds
    v_mfma_f32_16x16x32_bf16 v[64:67], a[236:239], a[208:211], v[64:67]
    s_waitcnt lgkmcnt(8)
    ds_read_b64_tr_b16 a[232:233], v19 offset:28672
    ds_read_b64_tr_b16 a[234:235], v19 offset:30720
    v_mfma_f32_16x16x32_bf16 v[80:83], a[236:239], a[212:215], v[80:83]
    buffer_load_dwordx4 v16, s[12:15], s75 offen offset:2048 lds
    v_mfma_f32_16x16x32_bf16 v[84:87], a[240:243], a[212:215], v[84:87]
    ds_read_b64_tr_b16 a[236:237], v20 offset:28672
    ds_read_b64_tr_b16 a[238:239], v20 offset:30720
    v_mfma_f32_16x16x32_bf16 v[68:71], a[240:243], a[208:211], v[68:71]
    v_mfma_f32_16x16x32_bf16 v[72:75], a[244:247], a[208:211], v[72:75]
    ds_read_b64_tr_b16 a[240:241], v21 offset:28672
    ds_read_b64_tr_b16 a[242:243], v21 offset:30720
    v_mfma_f32_16x16x32_bf16 v[88:91], a[244:247], a[212:215], v[88:91]
    v_mov_b32 v54, 1
    s_lshl_b32 s32, s21, 3
    v_mfma_f32_16x16x32_bf16 v[92:95], a[248:251], a[212:215], v[92:95]
    s_waitcnt lgkmcnt(8)
    ds_read_b64_tr_b16 a[244:245], v22 offset:28672
    ds_read_b64_tr_b16 a[246:247], v22 offset:30720
    v_mfma_f32_16x16x32_bf16 v[76:79], a[248:251], a[208:211], v[76:79]
    buffer_atomic_add v54, v43, s[40:43], s32 offen offset:128 sc0 sc1
    v_mfma_f32_16x16x32_bf16 v[96:99], a[216:219], a[144:147], 0
    ds_read_b64_tr_b16 a[248:249], v19 offset:32768
    ds_read_b64_tr_b16 a[250:251], v19 offset:34816
    v_mfma_f32_16x16x32_bf16 v[112:115], a[216:219], a[148:151], 0
    v_mfma_f32_16x16x32_bf16 v[116:119], a[220:223], a[148:151], 0
    ds_read_b64_tr_b16 a[216:217], v20 offset:32768
    ds_read_b64_tr_b16 a[218:219], v20 offset:34816
    v_mfma_f32_16x16x32_bf16 v[100:103], a[220:223], a[144:147], 0
    v_mfma_f32_16x16x32_bf16 v[104:107], a[224:227], a[144:147], 0
    s_waitcnt lgkmcnt(8)
    ds_read_b64_tr_b16 a[220:221], v21 offset:32768
    ds_read_b64_tr_b16 a[222:223], v21 offset:34816
    v_mfma_f32_16x16x32_bf16 v[120:123], a[224:227], a[148:151], 0
    v_mfma_f32_16x16x32_bf16 v[124:127], a[228:231], a[148:151], 0
    ds_read_b64_tr_b16 a[224:225], v22 offset:32768
    ds_read_b64_tr_b16 a[226:227], v22 offset:34816
    v_mfma_f32_16x16x32_bf16 v[108:111], a[228:231], a[144:147], 0
    s_lshl_b32 s27, s72, 8
    s_add_u32 s27, s27, s26
    v_mfma_f32_16x16x32_bf16 v[96:99], a[232:235], a[152:155], v[96:99]
    ds_read_b64_tr_b16 a[228:229], v19 offset:36864
    ds_read_b64_tr_b16 a[230:231], v19 offset:38912
    v_mfma_f32_16x16x32_bf16 v[112:115], a[232:235], a[156:159], v[112:115]
    v_cvt_pk_bf16_f32 v64, v64, v65
    s_add_u32 m0, s23, 135168
    v_mfma_f32_16x16x32_bf16 v[116:119], a[236:239], a[156:159], v[116:119]
    s_waitcnt lgkmcnt(8)
    ds_read_b64_tr_b16 a[232:233], v20 offset:36864
    ds_read_b64_tr_b16 a[234:235], v20 offset:38912
    v_mfma_f32_16x16x32_bf16 v[100:103], a[236:239], a[152:155], v[100:103]
    buffer_load_dwordx4 v8, s[12:15], s76 offen offset:0 lds
    v_mfma_f32_16x16x32_bf16 v[104:107], a[240:243], a[152:155], v[104:107]
    ds_read_b64_tr_b16 a[236:237], v21 offset:36864
    ds_read_b64_tr_b16 a[238:239], v21 offset:38912
    v_mfma_f32_16x16x32_bf16 v[120:123], a[240:243], a[156:159], v[120:123]
    v_cvt_pk_bf16_f32 v65, v66, v67
    v_cvt_pk_bf16_f32 v66, v68, v69
    v_mfma_f32_16x16x32_bf16 v[124:127], a[244:247], a[156:159], v[124:127]
    ds_read_b64_tr_b16 a[240:241], v22 offset:36864
    ds_read_b64_tr_b16 a[242:243], v22 offset:38912
    v_mfma_f32_16x16x32_bf16 v[108:111], a[244:247], a[152:155], v[108:111]
    v_cvt_pk_bf16_f32 v67, v70, v71
    v_mfma_f32_16x16x32_bf16 v[96:99], a[248:251], a[160:163], v[96:99]
    s_waitcnt lgkmcnt(8)
    ds_read_b64_tr_b16 a[244:245], v19 offset:40960
    ds_read_b64_tr_b16 a[246:247], v19 offset:43008
    v_mfma_f32_16x16x32_bf16 v[112:115], a[248:251], a[164:167], v[112:115]
    buffer_store_dwordx4 v[64:67], v23, s[16:19], s27 offen sc0 sc1
    v_mfma_f32_16x16x32_bf16 v[116:119], a[216:219], a[164:167], v[116:119]
    ds_read_b64_tr_b16 a[248:249], v20 offset:40960
    ds_read_b64_tr_b16 a[250:251], v20 offset:43008
    v_mfma_f32_16x16x32_bf16 v[100:103], a[216:219], a[160:163], v[100:103]
    v_cvt_pk_bf16_f32 v68, v72, v73
    v_cvt_pk_bf16_f32 v69, v74, v75
    v_mfma_f32_16x16x32_bf16 v[104:107], a[220:223], a[160:163], v[104:107]
    ds_read_b64_tr_b16 a[216:217], v21 offset:40960
    ds_read_b64_tr_b16 a[218:219], v21 offset:43008
    v_mfma_f32_16x16x32_bf16 v[120:123], a[220:223], a[164:167], v[120:123]
    buffer_load_dwordx4 v9, s[12:15], s76 offen offset:1024 lds
    v_cvt_pk_bf16_f32 v70, v76, v77
    v_mfma_f32_16x16x32_bf16 v[124:127], a[224:227], a[164:167], v[124:127]
    s_waitcnt lgkmcnt(8)
    ds_read_b64_tr_b16 a[220:221], v22 offset:40960
    ds_read_b64_tr_b16 a[222:223], v22 offset:43008
    v_mfma_f32_16x16x32_bf16 v[108:111], a[224:227], a[160:163], v[108:111]
    v_cvt_pk_bf16_f32 v71, v78, v79
    v_mfma_f32_16x16x32_bf16 v[96:99], a[228:231], a[168:171], v[96:99]
    ds_read_b64_tr_b16 a[224:225], v19 offset:45056
    ds_read_b64_tr_b16 a[226:227], v19 offset:47104
    v_mfma_f32_16x16x32_bf16 v[112:115], a[228:231], a[172:175], v[112:115]
    buffer_store_dwordx4 v[68:71], v24, s[16:19], s27 offen sc0 sc1
    v_mfma_f32_16x16x32_bf16 v[116:119], a[232:235], a[172:175], v[116:119]
    ds_read_b64_tr_b16 a[228:229], v20 offset:45056
    ds_read_b64_tr_b16 a[230:231], v20 offset:47104
    v_mfma_f32_16x16x32_bf16 v[100:103], a[232:235], a[168:171], v[100:103]
    buffer_load_dwordx4 v10, s[12:15], s76 offen offset:2048 lds
    v_cvt_pk_bf16_f32 v80, v80, v81
    v_mfma_f32_16x16x32_bf16 v[104:107], a[236:239], a[168:171], v[104:107]
    s_waitcnt lgkmcnt(8)
    ds_read_b64_tr_b16 a[232:233], v21 offset:45056
    ds_read_b64_tr_b16 a[234:235], v21 offset:47104
    v_mfma_f32_16x16x32_bf16 v[120:123], a[236:239], a[172:175], v[120:123]
    v_cvt_pk_bf16_f32 v81, v82, v83
    v_cvt_pk_bf16_f32 v82, v84, v85
    v_mfma_f32_16x16x32_bf16 v[124:127], a[240:243], a[172:175], v[124:127]
    s_waitcnt vmcnt(33)
    ds_read_b64_tr_b16 a[236:237], v22 offset:45056
    ds_read_b64_tr_b16 a[238:239], v22 offset:47104
    v_mfma_f32_16x16x32_bf16 v[108:111], a[240:243], a[168:171], v[108:111]
    s_barrier
    v_mfma_f32_16x16x32_bf16 v[96:99], a[244:247], a[176:179], v[96:99]
    ds_read_b64_tr_b16 a[240:241], v19 offset:49152
    ds_read_b64_tr_b16 a[242:243], v19 offset:51200
    v_mfma_f32_16x16x32_bf16 v[112:115], a[244:247], a[180:183], v[112:115]
    v_cvt_pk_bf16_f32 v83, v86, v87
    v_mfma_f32_16x16x32_bf16 v[116:119], a[248:251], a[180:183], v[116:119]
    s_waitcnt lgkmcnt(8)
    ds_read_b64_tr_b16 a[244:245], v20 offset:49152
    ds_read_b64_tr_b16 a[246:247], v20 offset:51200
    v_mfma_f32_16x16x32_bf16 v[100:103], a[248:251], a[176:179], v[100:103]
    buffer_store_dwordx4 v[80:83], v25, s[16:19], s27 offen sc0 sc1
    v_mfma_f32_16x16x32_bf16 v[104:107], a[216:219], a[176:179], v[104:107]
    ds_read_b64_tr_b16 a[248:249], v21 offset:49152
    ds_read_b64_tr_b16 a[250:251], v21 offset:51200
    v_mfma_f32_16x16x32_bf16 v[120:123], a[216:219], a[180:183], v[120:123]
    v_cvt_pk_bf16_f32 v84, v88, v89
    v_cvt_pk_bf16_f32 v85, v90, v91
    v_cvt_pk_bf16_f32 v86, v92, v93
    v_cvt_pk_bf16_f32 v87, v94, v95
    v_mfma_f32_16x16x32_bf16 v[124:127], a[220:223], a[180:183], v[124:127]
    ds_read_b64_tr_b16 a[216:217], v22 offset:49152
    ds_read_b64_tr_b16 a[218:219], v22 offset:51200
    v_mfma_f32_16x16x32_bf16 v[108:111], a[220:223], a[176:179], v[108:111]
    buffer_store_dwordx4 v[84:87], v26, s[16:19], s27 offen sc0 sc1
    v_mfma_f32_16x16x32_bf16 v[96:99], a[224:227], a[184:187], v[96:99]
    s_waitcnt lgkmcnt(8)
    ds_read_b64_tr_b16 a[220:221], v19 offset:53248
    ds_read_b64_tr_b16 a[222:223], v19 offset:55296
    v_mfma_f32_16x16x32_bf16 v[112:115], a[224:227], a[188:191], v[112:115]
    s_add_u32 m0, s23, 0
    v_mfma_f32_16x16x32_bf16 v[116:119], a[228:231], a[188:191], v[116:119]
    ds_read_b64_tr_b16 a[224:225], v20 offset:53248
    ds_read_b64_tr_b16 a[226:227], v20 offset:55296
    v_mfma_f32_16x16x32_bf16 v[100:103], a[228:231], a[184:187], v[100:103]
    buffer_load_dwordx4 v11, s[12:15], s76 offen offset:0 lds
    v_mfma_f32_16x16x32_bf16 v[104:107], a[232:235], a[184:187], v[104:107]
    ds_read_b64_tr_b16 a[228:229], v21 offset:53248
    ds_read_b64_tr_b16 a[230:231], v21 offset:55296
    v_mfma_f32_16x16x32_bf16 v[120:123], a[232:235], a[188:191], v[120:123]
    buffer_load_dwordx4 v12, s[12:15], s76 offen offset:1024 lds
    v_mfma_f32_16x16x32_bf16 v[124:127], a[236:239], a[188:191], v[124:127]
    s_waitcnt lgkmcnt(8)
    ds_read_b64_tr_b16 a[232:233], v22 offset:53248
    ds_read_b64_tr_b16 a[234:235], v22 offset:55296
    v_mfma_f32_16x16x32_bf16 v[108:111], a[236:239], a[184:187], v[108:111]
    buffer_load_dwordx4 v13, s[12:15], s76 offen offset:2048 lds
    v_mfma_f32_16x16x32_bf16 v[96:99], a[240:243], a[192:195], v[96:99]
    ds_read_b64_tr_b16 a[236:237], v19 offset:57344
    ds_read_b64_tr_b16 a[238:239], v19 offset:59392
    v_mfma_f32_16x16x32_bf16 v[112:115], a[240:243], a[196:199], v[112:115]
    v_mfma_f32_16x16x32_bf16 v[116:119], a[244:247], a[196:199], v[116:119]
    ds_read_b64_tr_b16 a[240:241], v20 offset:57344
    ds_read_b64_tr_b16 a[242:243], v20 offset:59392
    v_mfma_f32_16x16x32_bf16 v[100:103], a[244:247], a[192:195], v[100:103]
    v_mfma_f32_16x16x32_bf16 v[104:107], a[248:251], a[192:195], v[104:107]
    s_waitcnt lgkmcnt(8)
    ds_read_b64_tr_b16 a[244:245], v21 offset:57344
    ds_read_b64_tr_b16 a[246:247], v21 offset:59392
    v_mfma_f32_16x16x32_bf16 v[120:123], a[248:251], a[196:199], v[120:123]
    v_mfma_f32_16x16x32_bf16 v[124:127], a[216:219], a[196:199], v[124:127]
    ds_read_b64_tr_b16 a[248:249], v22 offset:57344
    ds_read_b64_tr_b16 a[250:251], v22 offset:59392
    v_mfma_f32_16x16x32_bf16 v[108:111], a[216:219], a[192:195], v[108:111]
    v_mfma_f32_16x16x32_bf16 v[96:99], a[220:223], a[200:203], v[96:99]
    ds_read_b64_tr_b16 a[216:217], v19 offset:61440
    ds_read_b64_tr_b16 a[218:219], v19 offset:63488
    v_mfma_f32_16x16x32_bf16 v[112:115], a[220:223], a[204:207], v[112:115]
    s_add_u32 m0, s23, 12288
    v_mfma_f32_16x16x32_bf16 v[116:119], a[224:227], a[204:207], v[116:119]
    s_waitcnt lgkmcnt(8)
    ds_read_b64_tr_b16 a[220:221], v20 offset:61440
    ds_read_b64_tr_b16 a[222:223], v20 offset:63488
    v_mfma_f32_16x16x32_bf16 v[100:103], a[224:227], a[200:203], v[100:103]
    buffer_load_dwordx4 v14, s[12:15], s76 offen offset:0 lds
    v_mfma_f32_16x16x32_bf16 v[104:107], a[228:231], a[200:203], v[104:107]
    ds_read_b64_tr_b16 a[224:225], v21 offset:61440
    ds_read_b64_tr_b16 a[226:227], v21 offset:63488
    v_mfma_f32_16x16x32_bf16 v[120:123], a[228:231], a[204:207], v[120:123]
    buffer_load_dwordx4 v15, s[12:15], s76 offen offset:1024 lds
    v_mfma_f32_16x16x32_bf16 v[124:127], a[232:235], a[204:207], v[124:127]
    ds_read_b64_tr_b16 a[228:229], v22 offset:61440
    ds_read_b64_tr_b16 a[230:231], v22 offset:63488
    v_mfma_f32_16x16x32_bf16 v[108:111], a[232:235], a[200:203], v[108:111]
    v_add_u32 v19, 61440, v19
    v_add_u32 v20, 61440, v20
    v_add_u32 v21, 61440, v21
    v_add_u32 v22, 61440, v22
    v_mfma_f32_16x16x32_bf16 v[96:99], a[236:239], a[208:211], v[96:99]
    s_waitcnt lgkmcnt(8)
    ds_read_b64_tr_b16 a[232:233], v19 offset:4096
    ds_read_b64_tr_b16 a[234:235], v19 offset:6144
    v_mfma_f32_16x16x32_bf16 v[112:115], a[236:239], a[212:215], v[112:115]
    buffer_load_dwordx4 v16, s[12:15], s76 offen offset:2048 lds
    v_mfma_f32_16x16x32_bf16 v[116:119], a[240:243], a[212:215], v[116:119]
    ds_read_b64_tr_b16 a[236:237], v20 offset:4096
    ds_read_b64_tr_b16 a[238:239], v20 offset:6144
    v_mfma_f32_16x16x32_bf16 v[100:103], a[240:243], a[208:211], v[100:103]
    v_mfma_f32_16x16x32_bf16 v[104:107], a[244:247], a[208:211], v[104:107]
    ds_read_b64_tr_b16 a[240:241], v21 offset:4096
    ds_read_b64_tr_b16 a[242:243], v21 offset:6144
    v_mfma_f32_16x16x32_bf16 v[120:123], a[244:247], a[212:215], v[120:123]
    v_mfma_f32_16x16x32_bf16 v[124:127], a[248:251], a[212:215], v[124:127]
    s_waitcnt lgkmcnt(8)
    ds_read_b64_tr_b16 a[244:245], v22 offset:4096
    ds_read_b64_tr_b16 a[246:247], v22 offset:6144
    v_mfma_f32_16x16x32_bf16 v[108:111], a[248:251], a[208:211], v[108:111]
    v_mfma_f32_16x16x32_bf16 v[128:131], a[216:219], a[144:147], 0
    ds_read_b64_tr_b16 a[248:249], v19 offset:8192
    ds_read_b64_tr_b16 a[250:251], v19 offset:10240
    v_mfma_f32_16x16x32_bf16 v[144:147], a[216:219], a[148:151], 0
    v_mfma_f32_16x16x32_bf16 v[148:151], a[220:223], a[148:151], 0
    ds_read_b64_tr_b16 a[216:217], v20 offset:8192
    ds_read_b64_tr_b16 a[218:219], v20 offset:10240
    v_mfma_f32_16x16x32_bf16 v[132:135], a[220:223], a[144:147], 0
    v_mfma_f32_16x16x32_bf16 v[136:139], a[224:227], a[144:147], 0
    s_waitcnt lgkmcnt(8)
    ds_read_b64_tr_b16 a[220:221], v21 offset:8192
    ds_read_b64_tr_b16 a[222:223], v21 offset:10240
    v_mfma_f32_16x16x32_bf16 v[152:155], a[224:227], a[148:151], 0
    v_mfma_f32_16x16x32_bf16 v[156:159], a[228:231], a[148:151], 0
    s_waitcnt vmcnt(20)
    ds_read_b64_tr_b16 a[224:225], v22 offset:8192
    ds_read_b64_tr_b16 a[226:227], v22 offset:10240
    v_mfma_f32_16x16x32_bf16 v[140:143], a[228:231], a[144:147], 0
    s_barrier
    v_mfma_f32_16x16x32_bf16 v[128:131], a[232:235], a[152:155], v[128:131]
    ds_read_b64_tr_b16 a[228:229], v19 offset:12288
    ds_read_b64_tr_b16 a[230:231], v19 offset:14336
    v_mfma_f32_16x16x32_bf16 v[144:147], a[232:235], a[156:159], v[144:147]
    buffer_store_dword v45, v41, s[16:19], 0 offen sc0 sc1
    v_mfma_f32_16x16x32_bf16 v[148:151], a[236:239], a[156:159], v[148:151]
    s_waitcnt lgkmcnt(8)
    ds_read_b64_tr_b16 a[232:233], v20 offset:12288
    ds_read_b64_tr_b16 a[234:235], v20 offset:14336
    v_mfma_f32_16x16x32_bf16 v[132:135], a[236:239], a[152:155], v[132:135]
    s_lshl_b32 s29, s73, 8
    s_add_u32 s29, s29, s26
    v_mfma_f32_16x16x32_bf16 v[136:139], a[240:243], a[152:155], v[136:139]
    ds_read_b64_tr_b16 a[236:237], v21 offset:12288
    ds_read_b64_tr_b16 a[238:239], v21 offset:14336
    v_mfma_f32_16x16x32_bf16 v[152:155], a[240:243], a[156:159], v[152:155]
    v_cvt_pk_bf16_f32 v96, v96, v97
    v_cvt_pk_bf16_f32 v97, v98, v99
    v_mfma_f32_16x16x32_bf16 v[156:159], a[244:247], a[156:159], v[156:159]
    ds_read_b64_tr_b16 a[240:241], v22 offset:12288
    ds_read_b64_tr_b16 a[242:243], v22 offset:14336
    v_mfma_f32_16x16x32_bf16 v[140:143], a[244:247], a[152:155], v[140:143]
    v_cvt_pk_bf16_f32 v98, v100, v101
    v_cvt_pk_bf16_f32 v99, v102, v103
    v_mfma_f32_16x16x32_bf16 v[128:131], a[248:251], a[160:163], v[128:131]
    s_waitcnt lgkmcnt(8)
    ds_read_b64_tr_b16 a[244:245], v19 offset:16384
    ds_read_b64_tr_b16 a[246:247], v19 offset:18432
    v_mfma_f32_16x16x32_bf16 v[144:147], a[248:251], a[164:167], v[144:147]
    buffer_store_dwordx4 v[96:99], v23, s[16:19], s29 offen sc0 sc1
    v_mfma_f32_16x16x32_bf16 v[148:151], a[216:219], a[164:167], v[148:151]
    ds_read_b64_tr_b16 a[248:249], v20 offset:16384
    ds_read_b64_tr_b16 a[250:251], v20 offset:18432
    v_mfma_f32_16x16x32_bf16 v[132:135], a[216:219], a[160:163], v[132:135]
    v_cvt_pk_bf16_f32 v100, v104, v105
    s_add_u32 m0, s23, 24576
    v_mfma_f32_16x16x32_bf16 v[136:139], a[220:223], a[160:163], v[136:139]
    ds_read_b64_tr_b16 a[216:217], v21 offset:16384
    ds_read_b64_tr_b16 a[218:219], v21 offset:18432
    v_mfma_f32_16x16x32_bf16 v[152:155], a[220:223], a[164:167], v[152:155]
    buffer_load_dwordx4 v8, s[12:15], s77 offen offset:0 lds
    v_cvt_pk_bf16_f32 v101, v106, v107
    v_mfma_f32_16x16x32_bf16 v[156:159], a[224:227], a[164:167], v[156:159]
    s_waitcnt lgkmcnt(8)
    ds_read_b64_tr_b16 a[220:221], v22 offset:16384
    ds_read_b64_tr_b16 a[222:223], v22 offset:18432
    v_mfma_f32_16x16x32_bf16 v[140:143], a[224:227], a[160:163], v[140:143]
    v_cvt_pk_bf16_f32 v102, v108, v109
    v_cvt_pk_bf16_f32 v103, v110, v111
    v_mfma_f32_16x16x32_bf16 v[128:131], a[228:231], a[168:171], v[128:131]
    ds_read_b64_tr_b16 a[224:225], v19 offset:20480
    ds_read_b64_tr_b16 a[226:227], v19 offset:22528
    v_mfma_f32_16x16x32_bf16 v[144:147], a[228:231], a[172:175], v[144:147]
    buffer_store_dwordx4 v[100:103], v24, s[16:19], s29 offen sc0 sc1
    v_mfma_f32_16x16x32_bf16 v[148:151], a[232:235], a[172:175], v[148:151]
    ds_read_b64_tr_b16 a[228:229], v20 offset:20480
    ds_read_b64_tr_b16 a[230:231], v20 offset:22528
    v_mfma_f32_16x16x32_bf16 v[132:135], a[232:235], a[168:171], v[132:135]
    buffer_load_dwordx4 v9, s[12:15], s77 offen offset:1024 lds
    v_cvt_pk_bf16_f32 v112, v112, v113
    v_mfma_f32_16x16x32_bf16 v[136:139], a[236:239], a[168:171], v[136:139]
    s_waitcnt lgkmcnt(8)
    ds_read_b64_tr_b16 a[232:233], v21 offset:20480
    ds_read_b64_tr_b16 a[234:235], v21 offset:22528
    v_mfma_f32_16x16x32_bf16 v[152:155], a[236:239], a[172:175], v[152:155]
    buffer_load_dwordx4 v10, s[12:15], s77 offen offset:2048 lds
    v_cvt_pk_bf16_f32 v113, v114, v115
    v_mfma_f32_16x16x32_bf16 v[156:159], a[240:243], a[172:175], v[156:159]
    ds_read_b64_tr_b16 a[236:237], v22 offset:20480
    ds_read_b64_tr_b16 a[238:239], v22 offset:22528
    v_mfma_f32_16x16x32_bf16 v[140:143], a[240:243], a[168:171], v[140:143]
    v_cvt_pk_bf16_f32 v114, v116, v117
    v_cvt_pk_bf16_f32 v115, v118, v119
    v_mfma_f32_16x16x32_bf16 v[128:131], a[244:247], a[176:179], v[128:131]
    ds_read_b64_tr_b16 a[240:241], v19 offset:24576
    ds_read_b64_tr_b16 a[242:243], v19 offset:26624
    v_mfma_f32_16x16x32_bf16 v[144:147], a[244:247], a[180:183], v[144:147]
    buffer_store_dwordx4 v[112:115], v25, s[16:19], s29 offen sc0 sc1
    v_mfma_f32_16x16x32_bf16 v[148:151], a[248:251], a[180:183], v[148:151]
    s_waitcnt lgkmcnt(8)
    ds_read_b64_tr_b16 a[244:245], v20 offset:24576
    ds_read_b64_tr_b16 a[246:247], v20 offset:26624
    v_mfma_f32_16x16x32_bf16 v[132:135], a[248:251], a[176:179], v[132:135]
    v_cvt_pk_bf16_f32 v116, v120, v121
    v_cvt_pk_bf16_f32 v117, v122, v123
    v_mfma_f32_16x16x32_bf16 v[136:139], a[216:219], a[176:179], v[136:139]
    ds_read_b64_tr_b16 a[248:249], v21 offset:24576
    ds_read_b64_tr_b16 a[250:251], v21 offset:26624
    v_mfma_f32_16x16x32_bf16 v[152:155], a[216:219], a[180:183], v[152:155]
    v_cvt_pk_bf16_f32 v118, v124, v125
    v_cvt_pk_bf16_f32 v119, v126, v127
    v_mfma_f32_16x16x32_bf16 v[156:159], a[220:223], a[180:183], v[156:159]
    ds_read_b64_tr_b16 a[216:217], v22 offset:24576
    ds_read_b64_tr_b16 a[218:219], v22 offset:26624
    v_mfma_f32_16x16x32_bf16 v[140:143], a[220:223], a[176:179], v[140:143]
    buffer_store_dwordx4 v[116:119], v26, s[16:19], s29 offen sc0 sc1
    v_mfma_f32_16x16x32_bf16 v[128:131], a[224:227], a[184:187], v[128:131]
    s_waitcnt lgkmcnt(8)
    ds_read_b64_tr_b16 a[220:221], v19 offset:28672
    ds_read_b64_tr_b16 a[222:223], v19 offset:30720
    v_mfma_f32_16x16x32_bf16 v[144:147], a[224:227], a[188:191], v[144:147]
    s_add_u32 m0, s23, 36864
    v_mfma_f32_16x16x32_bf16 v[148:151], a[228:231], a[188:191], v[148:151]
    ds_read_b64_tr_b16 a[224:225], v20 offset:28672
    ds_read_b64_tr_b16 a[226:227], v20 offset:30720
    v_mfma_f32_16x16x32_bf16 v[132:135], a[228:231], a[184:187], v[132:135]
    buffer_load_dwordx4 v11, s[12:15], s77 offen offset:0 lds
    v_mfma_f32_16x16x32_bf16 v[136:139], a[232:235], a[184:187], v[136:139]
    ds_read_b64_tr_b16 a[228:229], v21 offset:28672
    ds_read_b64_tr_b16 a[230:231], v21 offset:30720
    v_mfma_f32_16x16x32_bf16 v[152:155], a[232:235], a[188:191], v[152:155]
    buffer_load_dwordx4 v12, s[12:15], s77 offen offset:1024 lds
    v_mfma_f32_16x16x32_bf16 v[156:159], a[236:239], a[188:191], v[156:159]
    s_waitcnt lgkmcnt(8)
    ds_read_b64_tr_b16 a[232:233], v22 offset:28672
    ds_read_b64_tr_b16 a[234:235], v22 offset:30720
    v_mfma_f32_16x16x32_bf16 v[140:143], a[236:239], a[184:187], v[140:143]
    buffer_load_dwordx4 v13, s[12:15], s77 offen offset:2048 lds
    v_mfma_f32_16x16x32_bf16 v[128:131], a[240:243], a[192:195], v[128:131]
    ds_read_b64_tr_b16 a[236:237], v19 offset:32768
    ds_read_b64_tr_b16 a[238:239], v19 offset:34816
    v_mfma_f32_16x16x32_bf16 v[144:147], a[240:243], a[196:199], v[144:147]
    v_mfma_f32_16x16x32_bf16 v[148:151], a[244:247], a[196:199], v[148:151]
    ds_read_b64_tr_b16 a[240:241], v20 offset:32768
    ds_read_b64_tr_b16 a[242:243], v20 offset:34816
    v_mfma_f32_16x16x32_bf16 v[132:135], a[244:247], a[192:195], v[132:135]
    v_mfma_f32_16x16x32_bf16 v[136:139], a[248:251], a[192:195], v[136:139]
    s_waitcnt lgkmcnt(8)
    ds_read_b64_tr_b16 a[244:245], v21 offset:32768
    ds_read_b64_tr_b16 a[246:247], v21 offset:34816
    v_mfma_f32_16x16x32_bf16 v[152:155], a[248:251], a[196:199], v[152:155]
    v_mfma_f32_16x16x32_bf16 v[156:159], a[216:219], a[196:199], v[156:159]
    s_waitcnt vmcnt(28)
    ds_read_b64_tr_b16 a[248:249], v22 offset:32768
    ds_read_b64_tr_b16 a[250:251], v22 offset:34816
    v_mfma_f32_16x16x32_bf16 v[140:143], a[216:219], a[192:195], v[140:143]
    s_barrier
    v_mfma_f32_16x16x32_bf16 v[128:131], a[220:223], a[200:203], v[128:131]
    ds_read_b64_tr_b16 a[216:217], v19 offset:36864
    ds_read_b64_tr_b16 a[218:219], v19 offset:38912
    v_mfma_f32_16x16x32_bf16 v[144:147], a[220:223], a[204:207], v[144:147]
    v_mfma_f32_16x16x32_bf16 v[148:151], a[224:227], a[204:207], v[148:151]
    s_waitcnt lgkmcnt(8)
    ds_read_b64_tr_b16 a[220:221], v20 offset:36864
    ds_read_b64_tr_b16 a[222:223], v20 offset:38912
    v_mfma_f32_16x16x32_bf16 v[132:135], a[224:227], a[200:203], v[132:135]
    s_add_u32 m0, s23, 49152
    v_mfma_f32_16x16x32_bf16 v[136:139], a[228:231], a[200:203], v[136:139]
    ds_read_b64_tr_b16 a[224:225], v21 offset:36864
    ds_read_b64_tr_b16 a[226:227], v21 offset:38912
    v_mfma_f32_16x16x32_bf16 v[152:155], a[228:231], a[204:207], v[152:155]
    buffer_load_dwordx4 v14, s[12:15], s77 offen offset:0 lds
    v_mfma_f32_16x16x32_bf16 v[156:159], a[232:235], a[204:207], v[156:159]
    ds_read_b64_tr_b16 a[228:229], v22 offset:36864
    ds_read_b64_tr_b16 a[230:231], v22 offset:38912
    v_mfma_f32_16x16x32_bf16 v[140:143], a[232:235], a[200:203], v[140:143]
    buffer_load_dwordx4 v15, s[12:15], s77 offen offset:1024 lds
    v_mfma_f32_16x16x32_bf16 v[128:131], a[236:239], a[208:211], v[128:131]
    s_waitcnt lgkmcnt(8)
    ds_read_b64_tr_b16 a[232:233], v19 offset:40960
    ds_read_b64_tr_b16 a[234:235], v19 offset:43008
    v_mfma_f32_16x16x32_bf16 v[144:147], a[236:239], a[212:215], v[144:147]
    v_mfma_f32_16x16x32_bf16 v[148:151], a[240:243], a[212:215], v[148:151]
    ds_read_b64_tr_b16 a[236:237], v20 offset:40960
    ds_read_b64_tr_b16 a[238:239], v20 offset:43008
    v_mfma_f32_16x16x32_bf16 v[132:135], a[240:243], a[208:211], v[132:135]
    v_mfma_f32_16x16x32_bf16 v[136:139], a[244:247], a[208:211], v[136:139]
    ds_read_b64_tr_b16 a[240:241], v21 offset:40960
    ds_read_b64_tr_b16 a[242:243], v21 offset:43008
    v_mfma_f32_16x16x32_bf16 v[152:155], a[244:247], a[212:215], v[152:155]
    v_mfma_f32_16x16x32_bf16 v[156:159], a[248:251], a[212:215], v[156:159]
    s_waitcnt lgkmcnt(8)
    ds_read_b64_tr_b16 a[244:245], v22 offset:40960
    ds_read_b64_tr_b16 a[246:247], v22 offset:43008
    v_mfma_f32_16x16x32_bf16 v[140:143], a[248:251], a[208:211], v[140:143]
    buffer_load_dwordx4 v16, s[12:15], s77 offen offset:2048 lds
    v_mfma_f32_16x16x32_bf16 v[160:163], a[216:219], a[144:147], 0
    ds_read_b64_tr_b16 a[248:249], v19 offset:45056
    ds_read_b64_tr_b16 a[250:251], v19 offset:47104
    v_mfma_f32_16x16x32_bf16 v[176:179], a[216:219], a[148:151], 0
    v_mfma_f32_16x16x32_bf16 v[180:183], a[220:223], a[148:151], 0
    ds_read_b64_tr_b16 a[216:217], v20 offset:45056
    ds_read_b64_tr_b16 a[218:219], v20 offset:47104
    v_mfma_f32_16x16x32_bf16 v[164:167], a[220:223], a[144:147], 0
    v_mfma_f32_16x16x32_bf16 v[168:171], a[224:227], a[144:147], 0
    s_waitcnt lgkmcnt(8)
    ds_read_b64_tr_b16 a[220:221], v21 offset:45056
    ds_read_b64_tr_b16 a[222:223], v21 offset:47104
    v_mfma_f32_16x16x32_bf16 v[184:187], a[224:227], a[148:151], 0
    v_mfma_f32_16x16x32_bf16 v[188:191], a[228:231], a[148:151], 0
    ds_read_b64_tr_b16 a[224:225], v22 offset:45056
    ds_read_b64_tr_b16 a[226:227], v22 offset:47104
    v_mfma_f32_16x16x32_bf16 v[172:175], a[228:231], a[144:147], 0
    s_lshl_b32 s30, s74, 8
    s_add_u32 s30, s30, s26
    v_mfma_f32_16x16x32_bf16 v[160:163], a[232:235], a[152:155], v[160:163]
    ds_read_b64_tr_b16 a[228:229], v19 offset:49152
    ds_read_b64_tr_b16 a[230:231], v19 offset:51200
    v_mfma_f32_16x16x32_bf16 v[176:179], a[232:235], a[156:159], v[176:179]
    v_cvt_pk_bf16_f32 v128, v128, v129
    v_cvt_pk_bf16_f32 v129, v130, v131
    v_mfma_f32_16x16x32_bf16 v[180:183], a[236:239], a[156:159], v[180:183]
    s_waitcnt lgkmcnt(8)
    ds_read_b64_tr_b16 a[232:233], v20 offset:49152
    ds_read_b64_tr_b16 a[234:235], v20 offset:51200
    v_mfma_f32_16x16x32_bf16 v[164:167], a[236:239], a[152:155], v[164:167]
    v_cvt_pk_bf16_f32 v130, v132, v133
    v_cvt_pk_bf16_f32 v131, v134, v135
    v_mfma_f32_16x16x32_bf16 v[168:171], a[240:243], a[152:155], v[168:171]
    ds_read_b64_tr_b16 a[236:237], v21 offset:49152
    ds_read_b64_tr_b16 a[238:239], v21 offset:51200
    v_mfma_f32_16x16x32_bf16 v[184:187], a[240:243], a[156:159], v[184:187]
    buffer_store_dwordx4 v[128:131], v23, s[16:19], s30 offen sc0 sc1
    v_mfma_f32_16x16x32_bf16 v[188:191], a[244:247], a[156:159], v[188:191]
    ds_read_b64_tr_b16 a[240:241], v22 offset:49152
    ds_read_b64_tr_b16 a[242:243], v22 offset:51200
    v_mfma_f32_16x16x32_bf16 v[172:175], a[244:247], a[152:155], v[172:175]
    v_cvt_pk_bf16_f32 v132, v136, v137
    v_cvt_pk_bf16_f32 v133, v138, v139
    v_mfma_f32_16x16x32_bf16 v[160:163], a[248:251], a[160:163], v[160:163]
    s_waitcnt lgkmcnt(8)
    ds_read_b64_tr_b16 a[244:245], v19 offset:53248
    ds_read_b64_tr_b16 a[246:247], v19 offset:55296
    v_mfma_f32_16x16x32_bf16 v[176:179], a[248:251], a[164:167], v[176:179]
    v_cvt_pk_bf16_f32 v134, v140, v141
    v_cvt_pk_bf16_f32 v135, v142, v143
    v_mfma_f32_16x16x32_bf16 v[180:183], a[216:219], a[164:167], v[180:183]
    ds_read_b64_tr_b16 a[248:249], v20 offset:53248
    ds_read_b64_tr_b16 a[250:251], v20 offset:55296
    v_mfma_f32_16x16x32_bf16 v[164:167], a[216:219], a[160:163], v[164:167]
    buffer_store_dwordx4 v[132:135], v24, s[16:19], s30 offen sc0 sc1
    v_mfma_f32_16x16x32_bf16 v[168:171], a[220:223], a[160:163], v[168:171]
    ds_read_b64_tr_b16 a[216:217], v21 offset:53248
    ds_read_b64_tr_b16 a[218:219], v21 offset:55296
    v_mfma_f32_16x16x32_bf16 v[184:187], a[220:223], a[164:167], v[184:187]
    v_cvt_pk_bf16_f32 v144, v144, v145
    v_cvt_pk_bf16_f32 v145, v146, v147
    v_mfma_f32_16x16x32_bf16 v[188:191], a[224:227], a[164:167], v[188:191]
    s_waitcnt lgkmcnt(8)
    ds_read_b64_tr_b16 a[220:221], v22 offset:53248
    ds_read_b64_tr_b16 a[222:223], v22 offset:55296
    v_mfma_f32_16x16x32_bf16 v[172:175], a[224:227], a[160:163], v[172:175]
    v_cvt_pk_bf16_f32 v146, v148, v149
    v_cvt_pk_bf16_f32 v147, v150, v151
    v_mfma_f32_16x16x32_bf16 v[160:163], a[228:231], a[168:171], v[160:163]
    ds_read_b64_tr_b16 a[224:225], v19 offset:57344
    ds_read_b64_tr_b16 a[226:227], v19 offset:59392
    v_mfma_f32_16x16x32_bf16 v[176:179], a[228:231], a[172:175], v[176:179]
    buffer_store_dwordx4 v[144:147], v25, s[16:19], s30 offen sc0 sc1
    v_mfma_f32_16x16x32_bf16 v[180:183], a[232:235], a[172:175], v[180:183]
    ds_read_b64_tr_b16 a[228:229], v20 offset:57344
    ds_read_b64_tr_b16 a[230:231], v20 offset:59392
    v_mfma_f32_16x16x32_bf16 v[164:167], a[232:235], a[168:171], v[164:167]
    v_cvt_pk_bf16_f32 v148, v152, v153
    v_mfma_f32_16x16x32_bf16 v[168:171], a[236:239], a[168:171], v[168:171]
    s_waitcnt lgkmcnt(8)
    ds_read_b64_tr_b16 a[232:233], v21 offset:57344
    ds_read_b64_tr_b16 a[234:235], v21 offset:59392
    v_mfma_f32_16x16x32_bf16 v[184:187], a[236:239], a[172:175], v[184:187]
    v_cvt_pk_bf16_f32 v149, v154, v155
    v_cvt_pk_bf16_f32 v150, v156, v157
    v_mfma_f32_16x16x32_bf16 v[188:191], a[240:243], a[172:175], v[188:191]
    s_waitcnt vmcnt(25)
    ds_read_b64_tr_b16 a[236:237], v22 offset:57344
    ds_read_b64_tr_b16 a[238:239], v22 offset:59392
    v_mfma_f32_16x16x32_bf16 v[172:175], a[240:243], a[168:171], v[172:175]
    s_barrier
    v_mfma_f32_16x16x32_bf16 v[160:163], a[244:247], a[176:179], v[160:163]
    ds_read_b64_tr_b16 a[240:241], v19 offset:61440
    ds_read_b64_tr_b16 a[242:243], v19 offset:63488
    v_mfma_f32_16x16x32_bf16 v[176:179], a[244:247], a[180:183], v[176:179]
    v_lshlrev_b32 v46, 3, v0
    v_and_b32 v44, 0xffffff00, v44
    v_cvt_pk_bf16_f32 v151, v158, v159
    v_mfma_f32_16x16x32_bf16 v[180:183], a[248:251], a[180:183], v[180:183]
    s_waitcnt lgkmcnt(8)
    ds_read_b64_tr_b16 a[244:245], v20 offset:61440
    ds_read_b64_tr_b16 a[246:247], v20 offset:63488
    v_mfma_f32_16x16x32_bf16 v[164:167], a[248:251], a[176:179], v[164:167]
    buffer_store_dwordx4 v[148:151], v26, s[16:19], s30 offen sc0 sc1
    v_mfma_f32_16x16x32_bf16 v[168:171], a[216:219], a[176:179], v[168:171]
    ds_read_b64_tr_b16 a[248:249], v21 offset:61440
    ds_read_b64_tr_b16 a[250:251], v21 offset:63488
    v_mfma_f32_16x16x32_bf16 v[184:187], a[216:219], a[180:183], v[184:187]
    v_add_u32 v46, 147456, v46
    v_and_or_b32 v54, v54, 15, v44
    ds_write_b64 v46, v[54:55]
    v_mfma_f32_16x16x32_bf16 v[188:191], a[220:223], a[180:183], v[188:191]
    ds_read_b64_tr_b16 a[216:217], v22 offset:61440
    ds_read_b64_tr_b16 a[218:219], v22 offset:63488
    v_mfma_f32_16x16x32_bf16 v[172:175], a[220:223], a[176:179], v[172:175]
    v_add_u32 v19, 61440, v19
    v_add_u32 v20, 61440, v20
    v_add_u32 v21, 61440, v21
    v_add_u32 v22, 61440, v22
    v_mfma_f32_16x16x32_bf16 v[160:163], a[224:227], a[184:187], v[160:163]
    s_waitcnt lgkmcnt(9)
    ds_read_b64_tr_b16 a[220:221], v19 offset:4096
    ds_read_b64_tr_b16 a[222:223], v19 offset:6144
    v_mfma_f32_16x16x32_bf16 v[176:179], a[224:227], a[188:191], v[176:179]
    v_mfma_f32_16x16x32_bf16 v[180:183], a[228:231], a[188:191], v[180:183]
    ds_read_b64_tr_b16 a[224:225], v20 offset:4096
    ds_read_b64_tr_b16 a[226:227], v20 offset:6144
    v_mfma_f32_16x16x32_bf16 v[164:167], a[228:231], a[184:187], v[164:167]
    v_mfma_f32_16x16x32_bf16 v[168:171], a[232:235], a[184:187], v[168:171]
    ds_read_b64_tr_b16 a[228:229], v21 offset:4096
    ds_read_b64_tr_b16 a[230:231], v21 offset:6144
    v_mfma_f32_16x16x32_bf16 v[184:187], a[232:235], a[188:191], v[184:187]
    v_mfma_f32_16x16x32_bf16 v[188:191], a[236:239], a[188:191], v[188:191]
    s_waitcnt lgkmcnt(9)
    ds_read_b64_tr_b16 a[232:233], v22 offset:4096
    ds_read_b64_tr_b16 a[234:235], v22 offset:6144
    v_mfma_f32_16x16x32_bf16 v[172:175], a[236:239], a[184:187], v[172:175]
    v_mfma_f32_16x16x32_bf16 v[160:163], a[240:243], a[192:195], v[160:163]
    ds_read_b64_tr_b16 a[236:237], v19 offset:8192
    ds_read_b64_tr_b16 a[238:239], v19 offset:10240
    v_mfma_f32_16x16x32_bf16 v[176:179], a[240:243], a[196:199], v[176:179]
    v_mfma_f32_16x16x32_bf16 v[180:183], a[244:247], a[196:199], v[180:183]
    ds_read_b64_tr_b16 a[240:241], v20 offset:8192
    ds_read_b64_tr_b16 a[242:243], v20 offset:10240
    v_mfma_f32_16x16x32_bf16 v[164:167], a[244:247], a[192:195], v[164:167]
    v_mfma_f32_16x16x32_bf16 v[168:171], a[248:251], a[192:195], v[168:171]
    s_waitcnt lgkmcnt(8)
    ds_read_b64_tr_b16 a[244:245], v21 offset:8192
    ds_read_b64_tr_b16 a[246:247], v21 offset:10240
    v_mfma_f32_16x16x32_bf16 v[184:187], a[248:251], a[196:199], v[184:187]
    v_mfma_f32_16x16x32_bf16 v[188:191], a[216:219], a[196:199], v[188:191]
    ds_read_b64_tr_b16 a[248:249], v22 offset:8192
    ds_read_b64_tr_b16 a[250:251], v22 offset:10240
    v_mfma_f32_16x16x32_bf16 v[172:175], a[216:219], a[192:195], v[172:175]
    v_mfma_f32_16x16x32_bf16 v[160:163], a[220:223], a[200:203], v[160:163]
    ds_read_b64_tr_b16 a[216:217], v19 offset:12288
    ds_read_b64_tr_b16 a[218:219], v19 offset:14336
    v_mfma_f32_16x16x32_bf16 v[176:179], a[220:223], a[204:207], v[176:179]
    v_mfma_f32_16x16x32_bf16 v[180:183], a[224:227], a[204:207], v[180:183]
    s_waitcnt lgkmcnt(8)
    ds_read_b64_tr_b16 a[220:221], v20 offset:12288
    ds_read_b64_tr_b16 a[222:223], v20 offset:14336
    v_mfma_f32_16x16x32_bf16 v[164:167], a[224:227], a[200:203], v[164:167]
    v_mfma_f32_16x16x32_bf16 v[168:171], a[228:231], a[200:203], v[168:171]
    ds_read_b64_tr_b16 a[224:225], v21 offset:12288
    ds_read_b64_tr_b16 a[226:227], v21 offset:14336
    v_mfma_f32_16x16x32_bf16 v[184:187], a[228:231], a[204:207], v[184:187]
    v_mfma_f32_16x16x32_bf16 v[188:191], a[232:235], a[204:207], v[188:191]
    ds_read_b64_tr_b16 a[228:229], v22 offset:12288
    ds_read_b64_tr_b16 a[230:231], v22 offset:14336
    v_mfma_f32_16x16x32_bf16 v[172:175], a[232:235], a[200:203], v[172:175]
    v_mfma_f32_16x16x32_bf16 v[160:163], a[236:239], a[208:211], v[160:163]
    s_waitcnt lgkmcnt(8)
    ds_read_b64_tr_b16 a[232:233], v19 offset:16384
    ds_read_b64_tr_b16 a[234:235], v19 offset:18432
    v_mfma_f32_16x16x32_bf16 v[176:179], a[236:239], a[212:215], v[176:179]
    v_mfma_f32_16x16x32_bf16 v[180:183], a[240:243], a[212:215], v[180:183]
    ds_read_b64_tr_b16 a[236:237], v20 offset:16384
    ds_read_b64_tr_b16 a[238:239], v20 offset:18432
    v_mfma_f32_16x16x32_bf16 v[164:167], a[240:243], a[208:211], v[164:167]
    v_mfma_f32_16x16x32_bf16 v[168:171], a[244:247], a[208:211], v[168:171]
    ds_read_b64_tr_b16 a[240:241], v21 offset:16384
    ds_read_b64_tr_b16 a[242:243], v21 offset:18432
    v_mfma_f32_16x16x32_bf16 v[184:187], a[244:247], a[212:215], v[184:187]
    v_mfma_f32_16x16x32_bf16 v[188:191], a[248:251], a[212:215], v[188:191]
    s_waitcnt lgkmcnt(8)
    ds_read_b64_tr_b16 a[244:245], v22 offset:16384
    ds_read_b64_tr_b16 a[246:247], v22 offset:18432
    v_mfma_f32_16x16x32_bf16 v[172:175], a[248:251], a[208:211], v[172:175]
    v_mfma_f32_16x16x32_bf16 v[192:195], a[216:219], a[144:147], 0
    ds_read_b64_tr_b16 a[248:249], v19 offset:20480
    ds_read_b64_tr_b16 a[250:251], v19 offset:22528
    v_mfma_f32_16x16x32_bf16 v[208:211], a[216:219], a[148:151], 0
    v_mfma_f32_16x16x32_bf16 v[212:215], a[220:223], a[148:151], 0
    ds_read_b64_tr_b16 a[216:217], v20 offset:20480
    ds_read_b64_tr_b16 a[218:219], v20 offset:22528
    v_mfma_f32_16x16x32_bf16 v[196:199], a[220:223], a[144:147], 0
    v_mfma_f32_16x16x32_bf16 v[200:203], a[224:227], a[144:147], 0
    s_waitcnt lgkmcnt(8)
    ds_read_b64_tr_b16 a[220:221], v21 offset:20480
    ds_read_b64_tr_b16 a[222:223], v21 offset:22528
    v_mfma_f32_16x16x32_bf16 v[216:219], a[224:227], a[148:151], 0
    v_mfma_f32_16x16x32_bf16 v[220:223], a[228:231], a[148:151], 0
    s_waitcnt vmcnt(0)
    ds_read_b64_tr_b16 a[224:225], v22 offset:20480
    ds_read_b64_tr_b16 a[226:227], v22 offset:22528
    v_mfma_f32_16x16x32_bf16 v[204:207], a[228:231], a[144:147], 0
    s_barrier
    v_subrev_u32 v19, 122880, v19
    v_subrev_u32 v20, 122880, v20
    v_subrev_u32 v21, 122880, v21
    v_subrev_u32 v22, 122880, v22
    v_mfma_f32_16x16x32_bf16 v[192:195], a[232:235], a[152:155], v[192:195]
    ds_read_b64_tr_b16 a[228:229], v19 offset:0
    ds_read_b64_tr_b16 a[230:231], v19 offset:2048
    v_mfma_f32_16x16x32_bf16 v[208:211], a[232:235], a[156:159], v[208:211]
    v_mov_b32 v44, 2
    v_mov_b32 v46, 147456
    s_lshl_b32 s27, s75, 8
    v_mfma_f32_16x16x32_bf16 v[212:215], a[236:239], a[156:159], v[212:215]
    s_waitcnt lgkmcnt(8)
    ds_read_b64_tr_b16 a[232:233], v20 offset:0
    ds_read_b64_tr_b16 a[234:235], v20 offset:2048
    v_mfma_f32_16x16x32_bf16 v[196:199], a[236:239], a[152:155], v[196:199]
    buffer_store_dword v44, v41, s[16:19], 0 offen sc0 sc1
    v_mfma_f32_16x16x32_bf16 v[200:203], a[240:243], a[152:155], v[200:203]
    ds_read_b64_tr_b16 a[236:237], v21 offset:0
    ds_read_b64_tr_b16 a[238:239], v21 offset:2048
    v_mfma_f32_16x16x32_bf16 v[216:219], a[240:243], a[156:159], v[216:219]
    ds_read_b64 v[54:55], v46
    s_add_u32 s27, s27, s26
    v_cvt_pk_bf16_f32 v160, v160, v161
    v_mfma_f32_16x16x32_bf16 v[220:223], a[244:247], a[156:159], v[220:223]
    ds_read_b64_tr_b16 a[240:241], v22 offset:0
    ds_read_b64_tr_b16 a[242:243], v22 offset:2048
    v_mfma_f32_16x16x32_bf16 v[204:207], a[244:247], a[152:155], v[204:207]
    v_cvt_pk_bf16_f32 v161, v162, v163
    v_cvt_pk_bf16_f32 v162, v164, v165
    v_cvt_pk_bf16_f32 v163, v166, v167
    v_mfma_f32_16x16x32_bf16 v[192:195], a[248:251], a[160:163], v[192:195]
    s_waitcnt lgkmcnt(2)
    ds_read_b64_tr_b16 a[244:245], v19 offset:4096
    ds_read_b64_tr_b16 a[246:247], v19 offset:6144
    v_mfma_f32_16x16x32_bf16 v[208:211], a[248:251], a[164:167], v[208:211]
    buffer_store_dwordx4 v[160:163], v23, s[16:19], s27 offen sc0 sc1
    v_mfma_f32_16x16x32_bf16 v[212:215], a[216:219], a[164:167], v[212:215]
    ds_read_b64_tr_b16 a[248:249], v20 offset:4096
    ds_read_b64_tr_b16 a[250:251], v20 offset:6144
    v_mfma_f32_16x16x32_bf16 v[196:199], a[216:219], a[160:163], v[196:199]
    v_cvt_pk_bf16_f32 v164, v168, v169
    v_cvt_pk_bf16_f32 v165, v170, v171
    v_mfma_f32_16x16x32_bf16 v[200:203], a[220:223], a[160:163], v[200:203]
    ds_read_b64_tr_b16 a[216:217], v21 offset:4096
    ds_read_b64_tr_b16 a[218:219], v21 offset:6144
    v_mfma_f32_16x16x32_bf16 v[216:219], a[220:223], a[164:167], v[216:219]
    v_cvt_pk_bf16_f32 v166, v172, v173
    v_cvt_pk_bf16_f32 v167, v174, v175
    v_mfma_f32_16x16x32_bf16 v[220:223], a[224:227], a[164:167], v[220:223]
    ds_read_b64_tr_b16 a[220:221], v22 offset:4096
    ds_read_b64_tr_b16 a[222:223], v22 offset:6144
    v_mfma_f32_16x16x32_bf16 v[204:207], a[224:227], a[160:163], v[204:207]
    buffer_store_dwordx4 v[164:167], v24, s[16:19], s27 offen sc0 sc1
    v_mfma_f32_16x16x32_bf16 v[192:195], a[228:231], a[168:171], v[192:195]
    ds_read_b64_tr_b16 a[224:225], v19 offset:8192
    ds_read_b64_tr_b16 a[226:227], v19 offset:10240
    v_mfma_f32_16x16x32_bf16 v[208:211], a[228:231], a[172:175], v[208:211]
    v_cvt_pk_bf16_f32 v176, v176, v177
    v_readfirstlane_b32 s31, v54
    v_and_b32 v45, 0xffffff00, v54
    v_mfma_f32_16x16x32_bf16 v[212:215], a[232:235], a[172:175], v[212:215]
    ds_read_b64_tr_b16 a[228:229], v20 offset:8192
    ds_read_b64_tr_b16 a[230:231], v20 offset:10240
    v_mfma_f32_16x16x32_bf16 v[196:199], a[232:235], a[168:171], v[196:199]
    v_cvt_pk_bf16_f32 v177, v178, v179
    s_mul_i32 s33, s21, 9
    v_add_u32 v45, 0x100, v45
    s_and_b32 s31, s31, 15
    v_mfma_f32_16x16x32_bf16 v[200:203], a[236:239], a[168:171], v[200:203]
    s_waitcnt lgkmcnt(8)
    ds_read_b64_tr_b16 a[232:233], v21 offset:8192
    ds_read_b64_tr_b16 a[234:235], v21 offset:10240
    v_mfma_f32_16x16x32_bf16 v[216:219], a[236:239], a[172:175], v[216:219]
    v_cvt_pk_bf16_f32 v178, v180, v181
    v_cvt_pk_bf16_f32 v179, v182, v183
    v_mfma_f32_16x16x32_bf16 v[220:223], a[240:243], a[172:175], v[220:223]
    ds_read_b64_tr_b16 a[236:237], v22 offset:8192
    ds_read_b64_tr_b16 a[238:239], v22 offset:10240
    v_mfma_f32_16x16x32_bf16 v[204:207], a[240:243], a[168:171], v[204:207]
    buffer_store_dwordx4 v[176:179], v25, s[16:19], s27 offen sc0 sc1
    v_mfma_f32_16x16x32_bf16 v[192:195], a[244:247], a[176:179], v[192:195]
    ds_read_b64_tr_b16 a[240:241], v19 offset:12288
    ds_read_b64_tr_b16 a[242:243], v19 offset:14336
    v_mfma_f32_16x16x32_bf16 v[208:211], a[244:247], a[180:183], v[208:211]
    s_add_u32 s33, s33, s31
    s_sub_u32 s35, s31, 9
    v_mfma_f32_16x16x32_bf16 v[212:215], a[248:251], a[180:183], v[212:215]
    s_waitcnt lgkmcnt(8)
    ds_read_b64_tr_b16 a[244:245], v20 offset:12288
    ds_read_b64_tr_b16 a[246:247], v20 offset:14336
    v_mfma_f32_16x16x32_bf16 v[196:199], a[248:251], a[176:179], v[196:199]
    v_cvt_pk_bf16_f32 v180, v184, v185
    v_cvt_pk_bf16_f32 v181, v186, v187
    s_cmp_lt_u32 s31, 9
    s_cselect_b32 s48, s33, -1
    s_cselect_b32 s49, s31, s35
    v_mfma_f32_16x16x32_bf16 v[200:203], a[216:219], a[176:179], v[200:203]
    ds_read_b64_tr_b16 a[248:249], v21 offset:12288
    ds_read_b64_tr_b16 a[250:251], v21 offset:14336
    v_mfma_f32_16x16x32_bf16 v[216:219], a[216:219], a[180:183], v[216:219]
    v_cvt_pk_bf16_f32 v182, v188, v189
    v_cvt_pk_bf16_f32 v183, v190, v191
    v_mfma_f32_16x16x32_bf16 v[220:223], a[220:223], a[180:183], v[220:223]
    ds_read_b64_tr_b16 a[216:217], v22 offset:12288
    ds_read_b64_tr_b16 a[218:219], v22 offset:14336
    v_mfma_f32_16x16x32_bf16 v[204:207], a[220:223], a[176:179], v[204:207]
    buffer_store_dwordx4 v[180:183], v26, s[16:19], s27 offen sc0 sc1
    v_mfma_f32_16x16x32_bf16 v[192:195], a[224:227], a[184:187], v[192:195]
    s_waitcnt lgkmcnt(8)
    ds_read_b64_tr_b16 a[220:221], v19 offset:16384
    ds_read_b64_tr_b16 a[222:223], v19 offset:18432
    v_mfma_f32_16x16x32_bf16 v[208:211], a[224:227], a[188:191], v[208:211]
    s_max_i32 s33, s48, 0
    s_lshl_b32 s33, s33, 2
    v_mfma_f32_16x16x32_bf16 v[212:215], a[228:231], a[188:191], v[212:215]
    ds_read_b64_tr_b16 a[224:225], v20 offset:16384
    ds_read_b64_tr_b16 a[226:227], v20 offset:18432
    v_mfma_f32_16x16x32_bf16 v[196:199], a[228:231], a[184:187], v[196:199]
    s_add_u32 s33, s33, s22
    s_lshl_b32 s31, s33, 8
    v_mfma_f32_16x16x32_bf16 v[200:203], a[232:235], a[184:187], v[200:203]
    ds_read_b64_tr_b16 a[228:229], v21 offset:16384
    ds_read_b64_tr_b16 a[230:231], v21 offset:18432
    v_mfma_f32_16x16x32_bf16 v[216:219], a[232:235], a[188:191], v[216:219]
    v_lshl_add_u32 v62, v1, 2, s31
    s_lshl_b32 s33, s33, 1
    v_mfma_f32_16x16x32_bf16 v[220:223], a[236:239], a[188:191], v[220:223]
    s_waitcnt lgkmcnt(8)
    ds_read_b64_tr_b16 a[232:233], v22 offset:16384
    ds_read_b64_tr_b16 a[234:235], v22 offset:18432
    v_mfma_f32_16x16x32_bf16 v[204:207], a[236:239], a[184:187], v[204:207]
    v_mov_b32 v63, s33
    v_mfma_f32_16x16x32_bf16 v[192:195], a[240:243], a[192:195], v[192:195]
    ds_read_b64_tr_b16 a[236:237], v19 offset:20480
    ds_read_b64_tr_b16 a[238:239], v19 offset:22528
    v_mfma_f32_16x16x32_bf16 v[208:211], a[240:243], a[196:199], v[208:211]
    global_load_dword v48, v62, s[52:53]
    v_mfma_f32_16x16x32_bf16 v[212:215], a[244:247], a[196:199], v[212:215]
    ds_read_b64_tr_b16 a[240:241], v20 offset:20480
    ds_read_b64_tr_b16 a[242:243], v20 offset:22528
    v_mfma_f32_16x16x32_bf16 v[196:199], a[244:247], a[192:195], v[196:199]
    global_load_dword v49, v62, s[54:55]
    v_mfma_f32_16x16x32_bf16 v[200:203], a[248:251], a[192:195], v[200:203]
    s_waitcnt lgkmcnt(8)
    ds_read_b64_tr_b16 a[244:245], v21 offset:20480
    ds_read_b64_tr_b16 a[246:247], v21 offset:22528
    v_mfma_f32_16x16x32_bf16 v[216:219], a[248:251], a[196:199], v[216:219]
    global_load_dword v50, v62, s[56:57]
    v_mfma_f32_16x16x32_bf16 v[220:223], a[216:219], a[196:199], v[220:223]
    s_waitcnt vmcnt(15)
    ds_read_b64_tr_b16 a[248:249], v22 offset:20480
    ds_read_b64_tr_b16 a[250:251], v22 offset:22528
    v_mfma_f32_16x16x32_bf16 v[204:207], a[216:219], a[192:195], v[204:207]
    s_barrier
    v_mfma_f32_16x16x32_bf16 v[192:195], a[220:223], a[200:203], v[192:195]
    ds_read_b64_tr_b16 a[216:217], v19 offset:24576
    ds_read_b64_tr_b16 a[218:219], v19 offset:26624
    v_mfma_f32_16x16x32_bf16 v[208:211], a[220:223], a[204:207], v[208:211]
    global_load_dword v51, v62, s[58:59]
    v_mfma_f32_16x16x32_bf16 v[212:215], a[224:227], a[204:207], v[212:215]
    s_waitcnt lgkmcnt(8)
    ds_read_b64_tr_b16 a[220:221], v20 offset:24576
    ds_read_b64_tr_b16 a[222:223], v20 offset:26624
    v_mfma_f32_16x16x32_bf16 v[196:199], a[224:227], a[200:203], v[196:199]
    global_load_dword v52, v62, s[96:97]
    v_mfma_f32_16x16x32_bf16 v[200:203], a[228:231], a[200:203], v[200:203]
    ds_read_b64_tr_b16 a[224:225], v21 offset:24576
    ds_read_b64_tr_b16 a[226:227], v21 offset:26624
    v_mfma_f32_16x16x32_bf16 v[216:219], a[228:231], a[204:207], v[216:219]
    v_mfma_f32_16x16x32_bf16 v[220:223], a[232:235], a[204:207], v[220:223]
    ds_read_b64_tr_b16 a[228:229], v22 offset:24576
    ds_read_b64_tr_b16 a[230:231], v22 offset:26624
    v_mfma_f32_16x16x32_bf16 v[204:207], a[232:235], a[200:203], v[204:207]
    global_load_dword v53, v62, s[98:99]
    v_mfma_f32_16x16x32_bf16 v[192:195], a[236:239], a[208:211], v[192:195]
    s_waitcnt lgkmcnt(8)
    ds_read_b64_tr_b16 a[232:233], v19 offset:28672
    ds_read_b64_tr_b16 a[234:235], v19 offset:30720
    v_mfma_f32_16x16x32_bf16 v[208:211], a[236:239], a[212:215], v[208:211]
    v_mfma_f32_16x16x32_bf16 v[212:215], a[240:243], a[212:215], v[212:215]
    ds_read_b64_tr_b16 a[236:237], v20 offset:28672
    ds_read_b64_tr_b16 a[238:239], v20 offset:30720
    v_mfma_f32_16x16x32_bf16 v[196:199], a[240:243], a[208:211], v[196:199]
    global_load_ushort v54, v63, s[100:101]
    v_mfma_f32_16x16x32_bf16 v[200:203], a[244:247], a[208:211], v[200:203]
    ds_read_b64_tr_b16 a[240:241], v21 offset:28672
    ds_read_b64_tr_b16 a[242:243], v21 offset:30720
    v_mfma_f32_16x16x32_bf16 v[216:219], a[244:247], a[212:215], v[216:219]
    v_mfma_f32_16x16x32_bf16 v[220:223], a[248:251], a[212:215], v[220:223]
    s_waitcnt lgkmcnt(8)
    ds_read_b64_tr_b16 a[244:245], v22 offset:28672
    ds_read_b64_tr_b16 a[246:247], v22 offset:30720
    v_mfma_f32_16x16x32_bf16 v[204:207], a[248:251], a[208:211], v[204:207]
    v_mfma_f32_16x16x32_bf16 v[224:227], a[216:219], a[144:147], 0
    ds_read_b64_tr_b16 a[248:249], v19 offset:32768
    ds_read_b64_tr_b16 a[250:251], v19 offset:34816
    v_mfma_f32_16x16x32_bf16 v[240:243], a[216:219], a[148:151], 0
    v_mfma_f32_16x16x32_bf16 v[244:247], a[220:223], a[148:151], 0
    ds_read_b64_tr_b16 a[216:217], v20 offset:32768
    ds_read_b64_tr_b16 a[218:219], v20 offset:34816
    v_mfma_f32_16x16x32_bf16 v[228:231], a[220:223], a[144:147], 0
    v_mfma_f32_16x16x32_bf16 v[232:235], a[224:227], a[144:147], 0
    s_waitcnt lgkmcnt(8)
    ds_read_b64_tr_b16 a[220:221], v21 offset:32768
    ds_read_b64_tr_b16 a[222:223], v21 offset:34816
    v_mfma_f32_16x16x32_bf16 v[248:251], a[224:227], a[148:151], 0
    v_mfma_f32_16x16x32_bf16 v[252:255], a[228:231], a[148:151], 0
    ds_read_b64_tr_b16 a[224:225], v22 offset:32768
    ds_read_b64_tr_b16 a[226:227], v22 offset:34816
    v_mfma_f32_16x16x32_bf16 v[236:239], a[228:231], a[144:147], 0
    s_lshl_b32 s29, s76, 8
    s_add_u32 s29, s29, s26
    v_mfma_f32_16x16x32_bf16 v[224:227], a[232:235], a[152:155], v[224:227]
    ds_read_b64_tr_b16 a[228:229], v19 offset:36864
    ds_read_b64_tr_b16 a[230:231], v19 offset:38912
    v_mfma_f32_16x16x32_bf16 v[240:243], a[232:235], a[156:159], v[240:243]
    v_cvt_pk_bf16_f32 v192, v192, v193
    v_cvt_pk_bf16_f32 v193, v194, v195
    v_mfma_f32_16x16x32_bf16 v[244:247], a[236:239], a[156:159], v[244:247]
    s_waitcnt lgkmcnt(8)
    ds_read_b64_tr_b16 a[232:233], v20 offset:36864
    ds_read_b64_tr_b16 a[234:235], v20 offset:38912
    v_mfma_f32_16x16x32_bf16 v[228:231], a[236:239], a[152:155], v[228:231]
    v_cvt_pk_bf16_f32 v194, v196, v197
    v_cvt_pk_bf16_f32 v195, v198, v199
    v_mfma_f32_16x16x32_bf16 v[232:235], a[240:243], a[152:155], v[232:235]
    ds_read_b64_tr_b16 a[236:237], v21 offset:36864
    ds_read_b64_tr_b16 a[238:239], v21 offset:38912
    v_mfma_f32_16x16x32_bf16 v[248:251], a[240:243], a[156:159], v[248:251]
    buffer_store_dwordx4 v[192:195], v23, s[16:19], s29 offen sc0 sc1
    v_mfma_f32_16x16x32_bf16 v[252:255], a[244:247], a[156:159], v[252:255]
    ds_read_b64_tr_b16 a[240:241], v22 offset:36864
    ds_read_b64_tr_b16 a[242:243], v22 offset:38912
    v_mfma_f32_16x16x32_bf16 v[236:239], a[244:247], a[152:155], v[236:239]
    v_cvt_pk_bf16_f32 v196, v200, v201
    v_cvt_pk_bf16_f32 v197, v202, v203
    v_mfma_f32_16x16x32_bf16 v[224:227], a[248:251], a[160:163], v[224:227]
    s_waitcnt lgkmcnt(8)
    ds_read_b64_tr_b16 a[244:245], v19 offset:40960
    ds_read_b64_tr_b16 a[246:247], v19 offset:43008
    v_mfma_f32_16x16x32_bf16 v[240:243], a[248:251], a[164:167], v[240:243]
    s_lshl_b32 s32, s21, 7
    s_add_u32 s32, s32, 4096
    v_mfma_f32_16x16x32_bf16 v[244:247], a[216:219], a[164:167], v[244:247]
    ds_read_b64_tr_b16 a[248:249], v20 offset:40960
    ds_read_b64_tr_b16 a[250:251], v20 offset:43008
    v_mfma_f32_16x16x32_bf16 v[228:231], a[216:219], a[160:163], v[228:231]
    v_cvt_pk_bf16_f32 v198, v204, v205
    v_cvt_pk_bf16_f32 v199, v206, v207
    v_mfma_f32_16x16x32_bf16 v[232:235], a[220:223], a[160:163], v[232:235]
    ds_read_b64_tr_b16 a[216:217], v21 offset:40960
    ds_read_b64_tr_b16 a[218:219], v21 offset:43008
    v_mfma_f32_16x16x32_bf16 v[248:251], a[220:223], a[164:167], v[248:251]
    buffer_store_dwordx4 v[196:199], v24, s[16:19], s29 offen sc0 sc1
    v_mfma_f32_16x16x32_bf16 v[252:255], a[224:227], a[164:167], v[252:255]
    s_waitcnt lgkmcnt(8)
    ds_read_b64_tr_b16 a[220:221], v22 offset:40960
    ds_read_b64_tr_b16 a[222:223], v22 offset:43008
    v_mfma_f32_16x16x32_bf16 v[236:239], a[224:227], a[160:163], v[236:239]
    v_and_b32 v46, 15, v1
    v_lshl_add_u32 v46, v46, 2, s32
    v_mfma_f32_16x16x32_bf16 v[224:227], a[228:231], a[168:171], v[224:227]
    ds_read_b64_tr_b16 a[224:225], v19 offset:45056
    ds_read_b64_tr_b16 a[226:227], v19 offset:47104
    v_mfma_f32_16x16x32_bf16 v[240:243], a[228:231], a[172:175], v[240:243]
    buffer_load_dword v47, v46, s[16:19], 0 offen sc0 sc1
    v_mfma_f32_16x16x32_bf16 v[244:247], a[232:235], a[172:175], v[244:247]
    ds_read_b64_tr_b16 a[228:229], v20 offset:45056
    ds_read_b64_tr_b16 a[230:231], v20 offset:47104
    v_mfma_f32_16x16x32_bf16 v[228:231], a[232:235], a[168:171], v[228:231]
    v_cvt_pk_bf16_f32 v208, v208, v209
    v_cvt_pk_bf16_f32 v209, v210, v211
    v_mfma_f32_16x16x32_bf16 v[232:235], a[236:239], a[168:171], v[232:235]
    s_waitcnt lgkmcnt(8)
    ds_read_b64_tr_b16 a[232:233], v21 offset:45056
    ds_read_b64_tr_b16 a[234:235], v21 offset:47104
    v_mfma_f32_16x16x32_bf16 v[248:251], a[236:239], a[172:175], v[248:251]
    v_cvt_pk_bf16_f32 v210, v212, v213
    v_cvt_pk_bf16_f32 v211, v214, v215
    v_mfma_f32_16x16x32_bf16 v[252:255], a[240:243], a[172:175], v[252:255]
    s_waitcnt vmcnt(19)
    ds_read_b64_tr_b16 a[236:237], v22 offset:45056
    ds_read_b64_tr_b16 a[238:239], v22 offset:47104
    v_mfma_f32_16x16x32_bf16 v[236:239], a[240:243], a[168:171], v[236:239]
    s_barrier
    v_mfma_f32_16x16x32_bf16 v[224:227], a[244:247], a[176:179], v[224:227]
    ds_read_b64_tr_b16 a[240:241], v19 offset:49152
    ds_read_b64_tr_b16 a[242:243], v19 offset:51200
    v_mfma_f32_16x16x32_bf16 v[240:243], a[244:247], a[180:183], v[240:243]
    buffer_store_dwordx4 v[208:211], v25, s[16:19], s29 offen sc0 sc1
    v_mfma_f32_16x16x32_bf16 v[244:247], a[248:251], a[180:183], v[244:247]
    s_waitcnt lgkmcnt(8)
    ds_read_b64_tr_b16 a[244:245], v20 offset:49152
    ds_read_b64_tr_b16 a[246:247], v20 offset:51200
    v_mfma_f32_16x16x32_bf16 v[228:231], a[248:251], a[176:179], v[228:231]
    v_cvt_pk_bf16_f32 v212, v216, v217
    v_cvt_pk_bf16_f32 v213, v218, v219
    v_mfma_f32_16x16x32_bf16 v[232:235], a[216:219], a[176:179], v[232:235]
    ds_read_b64_tr_b16 a[248:249], v21 offset:49152
    ds_read_b64_tr_b16 a[250:251], v21 offset:51200
    v_mfma_f32_16x16x32_bf16 v[248:251], a[216:219], a[180:183], v[248:251]
    v_cvt_pk_bf16_f32 v214, v220, v221
    v_cvt_pk_bf16_f32 v215, v222, v223
    v_mfma_f32_16x16x32_bf16 v[252:255], a[220:223], a[180:183], v[252:255]
    ds_read_b64_tr_b16 a[216:217], v22 offset:49152
    ds_read_b64_tr_b16 a[218:219], v22 offset:51200
    v_mfma_f32_16x16x32_bf16 v[236:239], a[220:223], a[176:179], v[236:239]
    buffer_store_dwordx4 v[212:215], v26, s[16:19], s29 offen sc0 sc1
    v_mfma_f32_16x16x32_bf16 v[224:227], a[224:227], a[184:187], v[224:227]
    s_waitcnt lgkmcnt(8)
    ds_read_b64_tr_b16 a[220:221], v19 offset:53248
    ds_read_b64_tr_b16 a[222:223], v19 offset:55296
    v_mfma_f32_16x16x32_bf16 v[240:243], a[224:227], a[188:191], v[240:243]
    v_mfma_f32_16x16x32_bf16 v[244:247], a[228:231], a[188:191], v[244:247]
    ds_read_b64_tr_b16 a[224:225], v20 offset:53248
    ds_read_b64_tr_b16 a[226:227], v20 offset:55296
    v_mfma_f32_16x16x32_bf16 v[228:231], a[228:231], a[184:187], v[228:231]
    v_mfma_f32_16x16x32_bf16 v[232:235], a[232:235], a[184:187], v[232:235]
    ds_read_b64_tr_b16 a[228:229], v21 offset:53248
    ds_read_b64_tr_b16 a[230:231], v21 offset:55296
    v_mfma_f32_16x16x32_bf16 v[248:251], a[232:235], a[188:191], v[248:251]
    v_mfma_f32_16x16x32_bf16 v[252:255], a[236:239], a[188:191], v[252:255]
    s_waitcnt lgkmcnt(8)
    ds_read_b64_tr_b16 a[232:233], v22 offset:53248
    ds_read_b64_tr_b16 a[234:235], v22 offset:55296
    v_mfma_f32_16x16x32_bf16 v[236:239], a[236:239], a[184:187], v[236:239]
    v_mfma_f32_16x16x32_bf16 v[224:227], a[240:243], a[192:195], v[224:227]
    ds_read_b64_tr_b16 a[236:237], v19 offset:57344
    ds_read_b64_tr_b16 a[238:239], v19 offset:59392
    v_mfma_f32_16x16x32_bf16 v[240:243], a[240:243], a[196:199], v[240:243]
    v_mfma_f32_16x16x32_bf16 v[244:247], a[244:247], a[196:199], v[244:247]
    ds_read_b64_tr_b16 a[240:241], v20 offset:57344
    ds_read_b64_tr_b16 a[242:243], v20 offset:59392
    v_mfma_f32_16x16x32_bf16 v[228:231], a[244:247], a[192:195], v[228:231]
    v_mfma_f32_16x16x32_bf16 v[232:235], a[248:251], a[192:195], v[232:235]
    s_waitcnt lgkmcnt(8)
    ds_read_b64_tr_b16 a[244:245], v21 offset:57344
    ds_read_b64_tr_b16 a[246:247], v21 offset:59392
    v_mfma_f32_16x16x32_bf16 v[248:251], a[248:251], a[196:199], v[248:251]
    v_mfma_f32_16x16x32_bf16 v[252:255], a[216:219], a[196:199], v[252:255]
    ds_read_b64_tr_b16 a[248:249], v22 offset:57344
    ds_read_b64_tr_b16 a[250:251], v22 offset:59392
    v_mfma_f32_16x16x32_bf16 v[236:239], a[216:219], a[192:195], v[236:239]
    v_mfma_f32_16x16x32_bf16 v[224:227], a[220:223], a[200:203], v[224:227]
    v_mfma_f32_16x16x32_bf16 v[240:243], a[220:223], a[204:207], v[240:243]
    v_mfma_f32_16x16x32_bf16 v[244:247], a[224:227], a[204:207], v[244:247]
    s_waitcnt lgkmcnt(6)
    v_mfma_f32_16x16x32_bf16 v[228:231], a[224:227], a[200:203], v[228:231]
    v_mfma_f32_16x16x32_bf16 v[232:235], a[228:231], a[200:203], v[232:235]
    v_mfma_f32_16x16x32_bf16 v[248:251], a[228:231], a[204:207], v[248:251]
    v_mfma_f32_16x16x32_bf16 v[252:255], a[232:235], a[204:207], v[252:255]
    v_mfma_f32_16x16x32_bf16 v[236:239], a[232:235], a[200:203], v[236:239]
    v_mfma_f32_16x16x32_bf16 v[224:227], a[236:239], a[208:211], v[224:227]
    s_waitcnt lgkmcnt(0)
    v_mfma_f32_16x16x32_bf16 v[240:243], a[236:239], a[212:215], v[240:243]
    v_mfma_f32_16x16x32_bf16 v[244:247], a[240:243], a[212:215], v[244:247]
    v_mfma_f32_16x16x32_bf16 v[228:231], a[240:243], a[208:211], v[228:231]
    v_mfma_f32_16x16x32_bf16 v[232:235], a[244:247], a[208:211], v[232:235]
    v_mfma_f32_16x16x32_bf16 v[248:251], a[244:247], a[212:215], v[248:251]
    v_mfma_f32_16x16x32_bf16 v[252:255], a[248:251], a[212:215], v[252:255]
    v_mfma_f32_16x16x32_bf16 v[236:239], a[248:251], a[208:211], v[236:239]
    s_nop 5
    s_lshl_b32 s30, s77, 8
    s_add_u32 s30, s30, s26
    v_cvt_pk_bf16_f32 v224, v224, v225
    v_cvt_pk_bf16_f32 v225, v226, v227
    v_cvt_pk_bf16_f32 v226, v228, v229
    v_cvt_pk_bf16_f32 v227, v230, v231
    buffer_store_dwordx4 v[224:227], v23, s[16:19], s30 offen sc0 sc1
    v_cvt_pk_bf16_f32 v228, v232, v233
    v_cvt_pk_bf16_f32 v229, v234, v235
    v_cvt_pk_bf16_f32 v230, v236, v237
    v_cvt_pk_bf16_f32 v231, v238, v239
    buffer_store_dwordx4 v[228:231], v24, s[16:19], s30 offen sc0 sc1
    v_cvt_pk_bf16_f32 v240, v240, v241
    v_cvt_pk_bf16_f32 v241, v242, v243
    v_cvt_pk_bf16_f32 v242, v244, v245
    v_cvt_pk_bf16_f32 v243, v246, v247
    buffer_store_dwordx4 v[240:243], v25, s[16:19], s30 offen sc0 sc1
    v_cvt_pk_bf16_f32 v244, v248, v249
    v_cvt_pk_bf16_f32 v245, v250, v251
    v_cvt_pk_bf16_f32 v246, v252, v253
    v_cvt_pk_bf16_f32 v247, v254, v255
    buffer_store_dwordx4 v[244:247], v26, s[16:19], s30 offen sc0 sc1
    s_waitcnt vmcnt(6)
    s_mov_b32 s29, 262144
L_pa:
    v_cmp_ne_u32 vcc, v45, v55
    s_cbranch_vccz L_pa_ok
    s_sub_u32 s29, s29, 1
    s_cbranch_scc1 L_pa_ok
    v_mov_b32 v46, 0
    v_mov_b32 v47, 0
    buffer_load_dword v55, v46, s[40:43], 0 offen sc0 sc1
    s_waitcnt vmcnt(0)
    s_branch L_pa
L_pa_ok:
    s_load_dwordx2 s[8:9], s[0:1], 64
    s_cmp_eq_u32 s48, -1
    s_cbranch_scc1 L_red4
    s_lshl_b32 s30, s48, 2
    s_add_u32 s30, s30, s22
    s_lshl_b32 s30, s30, 12
    s_add_u32 s30, s30, 4194304
    v_lshlrev_b32 v2, 4, v1
    buffer_load_dwordx4 v[184:187], v2, s[16:19], s30 offen offset:0 sc0 sc1
    buffer_load_dwordx4 v[188:191], v2, s[16:19], s30 offen offset:1024 sc0 sc1
    buffer_load_dwordx4 v[192:195], v2, s[16:19], s30 offen offset:2048 sc0 sc1
    buffer_load_dwordx4 v[196:199], v2, s[16:19], s30 offen offset:3072 sc0 sc1
    v_mov_b32 v26, v41
    v_mov_b32 v28, 3
    s_mul_i32 s34, s22, 36864
    s_lshl_b32 s30, s22, 12
    s_add_u32 s30, s30, 147456
    v_add_u32 v29, s30, v2
    v_lshlrev_b32 v208, 16, v48
    v_and_b32 v209, 0xffff0000, v48
    v_lshlrev_b32 v210, 16, v49
    v_and_b32 v211, 0xffff0000, v49
    v_lshlrev_b32 v212, 16, v50
    v_and_b32 v213, 0xffff0000, v50
    v_lshlrev_b32 v214, 16, v51
    v_and_b32 v215, 0xffff0000, v51
    v_lshlrev_b32 v216, 16, v52
    v_and_b32 v217, 0xffff0000, v52
    v_lshlrev_b32 v218, 16, v53
    v_and_b32 v219, 0xffff0000, v53
    v_lshlrev_b32 v40, 16, v54
    v_mul_f32 v40, 0x3fb8aa3b, v40
    v_exp_f32 v40, v40
    s_nop 0
    v_cvt_pk_bf16_f32 v40, v40, v40
    v_lshlrev_b32 v40, 16, v40
    v_mul_f32 v208, v40, v208
    v_mul_f32 v212, v40, v212
    v_mul_f32 v209, v40, v209
    v_mul_f32 v213, v40, v213
    v_mul_f32 v210, v40, v210
    v_mul_f32 v214, v40, v214
    v_mul_f32 v211, v40, v211
    v_mul_f32 v215, v40, v215
    v_mul_f32 v208, 0x3fb8aa3b, v208
    v_mul_f32 v210, 0.15915494, v210
    v_mul_f32 v209, 0x3fb8aa3b, v209
    v_mul_f32 v211, 0.15915494, v211
    v_mov_b32 v44, v208
    v_mov_b32 v45, v209
    v_mov_b32 v46, v210
    v_mov_b32 v47, v211
    v_exp_f32 v44, v44
    v_exp_f32 v45, v45
    v_fract_f32 v46, v46
    v_fract_f32 v47, v47
    v_cos_f32 v220, v46
    v_cos_f32 v221, v47
    v_sin_f32 v222, v46
    v_sin_f32 v223, v47
    s_nop 0
    v_pk_mul_f32 v[220:221], v[220:221], v[44:45]
    v_pk_mul_f32 v[222:223], v[222:223], v[44:45]
    v_mul_f32 v44, 0x41000000, v208
    v_mul_f32 v45, 0x41000000, v209
    v_mul_f32 v46, 0x41000000, v210
    v_mul_f32 v47, 0x41000000, v211
    v_exp_f32 v44, v44
    v_exp_f32 v45, v45
    v_fract_f32 v46, v46
    v_fract_f32 v47, v47
    v_cos_f32 v224, v46
    v_cos_f32 v225, v47
    v_sin_f32 v226, v46
    v_sin_f32 v227, v47
    s_nop 0
    v_pk_mul_f32 v[224:225], v[224:225], v[44:45]
    v_pk_mul_f32 v[226:227], v[226:227], v[44:45]
    v_mul_f32 v44, 0x43800000, v208
    v_mul_f32 v45, 0x43800000, v209
    v_mul_f32 v46, 0x43800000, v210
    v_mul_f32 v47, 0x43800000, v211
    v_exp_f32 v44, v44
    v_exp_f32 v45, v45
    v_fract_f32 v46, v46
    v_fract_f32 v47, v47
    v_cos_f32 v228, v46
    v_cos_f32 v229, v47
    v_sin_f32 v230, v46
    v_sin_f32 v231, v47
    s_nop 0
    v_pk_mul_f32 v[228:229], v[228:229], v[44:45]
    v_pk_mul_f32 v[230:231], v[230:231], v[44:45]
    v_lshl_add_u32 v16, v1, 3, s34
    v_mov_b32 v64, 0x3f803f80
    v_pk_mul_f32 v[36:37], v[218:219], v[214:215]
    v_mov_b32 v65, 0
    v_pk_mul_f32 v[38:39], v[218:219], v[212:213]
    v_cvt_pk_bf16_f32 v66, v224, v225
    v_pk_fma_f32 v[250:251], v[216:217], v[214:215], v[38:39]
    v_cvt_pk_bf16_f32 v67, v226, v227
    v_pk_fma_f32 v[248:249], v[216:217], v[212:213], v[36:37] neg_lo:[0,0,1] neg_hi:[0,0,1]
    v_pk_mul_f32 v[32:33], v[226:227], v[226:227]
    v_cvt_pk_bf16_f32 v128, v248, v249
    s_mov_b32 s30, s49
    v_pk_mul_f32 v[34:35], v[226:227], v[224:225]
    v_cvt_pk_bf16_f32 v129, -v250, -v251
    s_and_b32 s63, s30, 1
    v_pk_fma_f32 v[242:243], v[224:225], v[226:227], v[34:35]
    v_pk_mul_f32 v[36:37], v[222:223], v[222:223]
    s_mul_i32 s31, s30, 43
    v_pk_fma_f32 v[240:241], v[224:225], v[224:225], v[32:33] neg_lo:[0,0,1] neg_hi:[0,0,1]
    v_pk_mul_f32 v[38:39], v[222:223], v[220:221]
    s_lshr_b32 s31, s31, 9
    v_cvt_pk_bf16_f32 v68, v240, v241
    v_pk_fma_f32 v[234:235], v[220:221], v[222:223], v[38:39]
    s_add_u32 s96, s31, 1
    s_barrier
    ds_write_b64 v16, v[64:65] offset:16896
    v_cvt_pk_bf16_f32 v69, v242, v243
    v_pk_fma_f32 v[232:233], v[220:221], v[220:221], v[36:37] neg_lo:[0,0,1] neg_hi:[0,0,1]
    s_lshr_b32 s30, s30, 1
    ds_write_b64 v16, v[66:67] offset:17424
    v_pk_mul_f32 v[32:33], v[242:243], v[226:227]
    v_pk_mul_f32 v[36:37], v[234:235], v[234:235]
    s_lshl_b32 s31, s51, 1
    ds_write_b64 v16, v[128:129] offset:0
    v_pk_mul_f32 v[34:35], v[242:243], v[224:225]
    v_pk_mul_f32 v[38:39], v[234:235], v[232:233]
    s_add_u32 s30, s30, s31
    ds_write_b64 v16, v[68:69] offset:17952
    v_pk_fma_f32 v[242:243], v[240:241], v[226:227], v[34:35]
    v_pk_fma_f32 v[238:239], v[232:233], v[234:235], v[38:39]
    s_sub_u32 s31, s30, 18
    v_pk_fma_f32 v[240:241], v[240:241], v[224:225], v[32:33] neg_lo:[0,0,1] neg_hi:[0,0,1]
    v_pk_fma_f32 v[236:237], v[232:233], v[232:233], v[36:37] neg_lo:[0,0,1] neg_hi:[0,0,1]
    s_cmp_ge_u32 s30, 18
    v_cvt_pk_bf16_f32 v70, v240, v241
    v_pk_mul_f32 v[36:37], v[250:251], v[222:223]
    s_cselect_b32 s30, s31, s30
    v_cvt_pk_bf16_f32 v71, v242, v243
    v_pk_mul_f32 v[38:39], v[250:251], v[220:221]
    s_lshl_b32 s31, s21, 3
    ds_write_b64 v16, v[70:71] offset:18480
    v_pk_mul_f32 v[32:33], v[242:243], v[226:227]
    v_pk_fma_f32 v[246:247], v[248:249], v[222:223], v[38:39]
    s_lshl_b32 s32, s22, 1
    v_pk_mul_f32 v[34:35], v[242:243], v[224:225]
    v_pk_fma_f32 v[244:245], v[248:249], v[220:221], v[36:37] neg_lo:[0,0,1] neg_hi:[0,0,1]
    s_add_u32 s31, s31, s32
    v_pk_fma_f32 v[242:243], v[240:241], v[226:227], v[34:35]
    v_cvt_pk_bf16_f32 v130, v244, v245
    s_add_u32 s31, s31, s63
    v_pk_fma_f32 v[240:241], v[240:241], v[224:225], v[32:33] neg_lo:[0,0,1] neg_hi:[0,0,1]
    v_cvt_pk_bf16_f32 v131, -v246, -v247
    s_mul_i32 s32, s31, 18
    ds_write_b64 v16, v[130:131] offset:528
    v_cvt_pk_bf16_f32 v72, v240, v241
    v_pk_mul_f32 v[36:37], v[246:247], v[222:223]
    s_add_u32 s32, s32, s30
    v_cvt_pk_bf16_f32 v73, v242, v243
    v_pk_mul_f32 v[38:39], v[246:247], v[220:221]
    s_lshl_b32 s32, s32, 14
    ds_write_b64 v16, v[72:73] offset:19008
    v_pk_mul_f32 v[32:33], v[242:243], v[226:227]
    v_pk_fma_f32 v[246:247], v[244:245], v[222:223], v[38:39]
    s_add_u32 s60, s32, 8388608
    v_pk_mul_f32 v[34:35], v[242:243], v[224:225]
    v_pk_fma_f32 v[244:245], v[244:245], v[220:221], v[36:37] neg_lo:[0,0,1] neg_hi:[0,0,1]
    s_mul_i32 s32, s31, 18432
    v_pk_fma_f32 v[242:243], v[240:241], v[226:227], v[34:35]
    v_cvt_pk_bf16_f32 v132, v244, v245
    s_lshl_b32 s33, s30, 6
    v_pk_fma_f32 v[240:241], v[240:241], v[224:225], v[32:33] neg_lo:[0,0,1] neg_hi:[0,0,1]
    v_cvt_pk_bf16_f32 v133, -v246, -v247
    s_add_u32 s61, s32, s33
    ds_write_b64 v16, v[132:133] offset:1056
    v_cvt_pk_bf16_f32 v74, v240, v241
    v_pk_mul_f32 v[36:37], v[246:247], v[222:223]
    s_lshl_b32 s32, s30, 17
    v_cvt_pk_bf16_f32 v75, v242, v243
    v_pk_mul_f32 v[38:39], v[246:247], v[220:221]
    s_lshl_b32 s31, s31, 7
    ds_write_b64 v16, v[74:75] offset:19536
    v_pk_mul_f32 v[32:33], v[242:243], v[226:227]
    v_pk_fma_f32 v[246:247], v[244:245], v[222:223], v[38:39]
    s_add_u32 s32, s32, s31
    v_pk_mul_f32 v[34:35], v[242:243], v[224:225]
    v_pk_fma_f32 v[244:245], v[244:245], v[220:221], v[36:37] neg_lo:[0,0,1] neg_hi:[0,0,1]
    s_add_u32 s62, s32, 1048576
    v_pk_fma_f32 v[242:243], v[240:241], v[226:227], v[34:35]
    v_cvt_pk_bf16_f32 v134, v244, v245
    s_add_u32 s30, s49, 9
    v_pk_fma_f32 v[240:241], v[240:241], v[224:225], v[32:33] neg_lo:[0,0,1] neg_hi:[0,0,1]
    v_cvt_pk_bf16_f32 v135, -v246, -v247
    s_min_u32 s30, s30, 14
    ds_write_b64 v16, v[134:135] offset:1584
    v_cvt_pk_bf16_f32 v76, v240, v241
    v_pk_mul_f32 v[36:37], v[246:247], v[222:223]
    s_and_b32 s67, s30, 1
    v_cvt_pk_bf16_f32 v77, v242, v243
    v_pk_mul_f32 v[38:39], v[246:247], v[220:221]
    s_mul_i32 s31, s30, 43
    ds_write_b64 v16, v[76:77] offset:20064
    v_pk_mul_f32 v[32:33], v[242:243], v[226:227]
    v_pk_fma_f32 v[246:247], v[244:245], v[222:223], v[38:39]
    s_lshr_b32 s31, s31, 9
    v_pk_mul_f32 v[34:35], v[242:243], v[224:225]
    v_pk_fma_f32 v[244:245], v[244:245], v[220:221], v[36:37] neg_lo:[0,0,1] neg_hi:[0,0,1]
    s_add_u32 s97, s31, 1
    v_pk_fma_f32 v[242:243], v[240:241], v[226:227], v[34:35]
    v_cvt_pk_bf16_f32 v136, v244, v245
    s_lshr_b32 s30, s30, 1
    v_pk_fma_f32 v[240:241], v[240:241], v[224:225], v[32:33] neg_lo:[0,0,1] neg_hi:[0,0,1]
    v_cvt_pk_bf16_f32 v137, -v246, -v247
    s_lshl_b32 s31, s51, 1
    ds_write_b64 v16, v[136:137] offset:2112
    v_cvt_pk_bf16_f32 v78, v240, v241
    v_pk_mul_f32 v[36:37], v[246:247], v[222:223]
    s_add_u32 s30, s30, s31
    v_cvt_pk_bf16_f32 v79, v242, v243
    v_pk_mul_f32 v[38:39], v[246:247], v[220:221]
    s_sub_u32 s31, s30, 18
    ds_write_b64 v16, v[78:79] offset:20592
    v_pk_mul_f32 v[32:33], v[242:243], v[226:227]
    v_pk_fma_f32 v[246:247], v[244:245], v[222:223], v[38:39]
    s_cmp_ge_u32 s30, 18
    v_pk_mul_f32 v[34:35], v[242:243], v[224:225]
    v_pk_fma_f32 v[244:245], v[244:245], v[220:221], v[36:37] neg_lo:[0,0,1] neg_hi:[0,0,1]
    s_cselect_b32 s30, s31, s30
    v_pk_fma_f32 v[242:243], v[240:241], v[226:227], v[34:35]
    v_cvt_pk_bf16_f32 v138, v244, v245
    s_lshl_b32 s31, s21, 3
    v_pk_fma_f32 v[240:241], v[240:241], v[224:225], v[32:33] neg_lo:[0,0,1] neg_hi:[0,0,1]
    v_cvt_pk_bf16_f32 v139, -v246, -v247
    s_lshl_b32 s32, s22, 1
    ds_write_b64 v16, v[138:139] offset:2640
    v_cvt_pk_bf16_f32 v80, v240, v241
    v_pk_mul_f32 v[36:37], v[246:247], v[222:223]
    s_add_u32 s31, s31, s32
    v_cvt_pk_bf16_f32 v81, v242, v243
    v_pk_mul_f32 v[38:39], v[246:247], v[220:221]
    s_add_u32 s31, s31, s67
    ds_write_b64 v16, v[80:81] offset:21120
    v_pk_mul_f32 v[32:33], v[242:243], v[226:227]
    v_pk_fma_f32 v[246:247], v[244:245], v[222:223], v[38:39]
    s_mul_i32 s32, s31, 18
    v_pk_mul_f32 v[34:35], v[242:243], v[224:225]
    v_pk_fma_f32 v[244:245], v[244:245], v[220:221], v[36:37] neg_lo:[0,0,1] neg_hi:[0,0,1]
    s_add_u32 s32, s32, s30
    v_pk_fma_f32 v[242:243], v[240:241], v[226:227], v[34:35]
    v_cvt_pk_bf16_f32 v140, v244, v245
    s_lshl_b32 s32, s32, 14
    v_pk_fma_f32 v[240:241], v[240:241], v[224:225], v[32:33] neg_lo:[0,0,1] neg_hi:[0,0,1]
    v_cvt_pk_bf16_f32 v141, -v246, -v247
    s_add_u32 s64, s32, 8388608
    ds_write_b64 v16, v[140:141] offset:3168
    v_cvt_pk_bf16_f32 v82, v240, v241
    v_pk_mul_f32 v[36:37], v[246:247], v[222:223]
    s_mul_i32 s32, s31, 18432
    v_cvt_pk_bf16_f32 v83, v242, v243
    v_pk_mul_f32 v[38:39], v[246:247], v[220:221]
    s_lshl_b32 s33, s30, 6
    ds_write_b64 v16, v[82:83] offset:21648
    v_pk_mul_f32 v[32:33], v[242:243], v[226:227]
    v_pk_fma_f32 v[246:247], v[244:245], v[222:223], v[38:39]
    s_add_u32 s65, s32, s33
    v_pk_mul_f32 v[34:35], v[242:243], v[224:225]
    v_pk_fma_f32 v[244:245], v[244:245], v[220:221], v[36:37] neg_lo:[0,0,1] neg_hi:[0,0,1]
    s_lshl_b32 s32, s30, 17
    v_pk_fma_f32 v[242:243], v[240:241], v[226:227], v[34:35]
    v_cvt_pk_bf16_f32 v142, v244, v245
    s_lshl_b32 s31, s31, 7
    v_pk_fma_f32 v[240:241], v[240:241], v[224:225], v[32:33] neg_lo:[0,0,1] neg_hi:[0,0,1]
    v_cvt_pk_bf16_f32 v143, -v246, -v247
    s_add_u32 s32, s32, s31
    ds_write_b64 v16, v[142:143] offset:3696
    v_cvt_pk_bf16_f32 v84, v240, v241
    v_pk_mul_f32 v[36:37], v[250:251], v[230:231]
    s_add_u32 s66, s32, 1048576
    v_cvt_pk_bf16_f32 v85, v242, v243
    v_pk_mul_f32 v[38:39], v[250:251], v[228:229]
    v_lshlrev_b32 v2, 4, v1
    ds_write_b64 v16, v[84:85] offset:22176
    v_pk_mul_f32 v[32:33], v[242:243], v[226:227]
    v_pk_fma_f32 v[250:251], v[248:249], v[230:231], v[38:39]
    v_and_b32 v3, 15, v1
    v_pk_mul_f32 v[34:35], v[242:243], v[224:225]
    v_pk_fma_f32 v[248:249], v[248:249], v[228:229], v[36:37] neg_lo:[0,0,1] neg_hi:[0,0,1]
    v_lshrrev_b32 v4, 4, v1
    v_pk_fma_f32 v[242:243], v[240:241], v[226:227], v[34:35]
    v_cvt_pk_bf16_f32 v144, v248, v249
    v_mul_u32_u24 v5, 1152, v3
    v_pk_fma_f32 v[240:241], v[240:241], v[224:225], v[32:33] neg_lo:[0,0,1] neg_hi:[0,0,1]
    v_cvt_pk_bf16_f32 v145, -v250, -v251
    v_lshl_add_u32 v5, v4, 4, v5
    ds_write_b64 v16, v[144:145] offset:4224
    v_cvt_pk_bf16_f32 v86, v240, v241
    v_pk_mul_f32 v[36:37], v[250:251], v[234:235]
    v_lshlrev_b32 v7, 4, v4
    v_cvt_pk_bf16_f32 v87, v242, v243
    v_pk_mul_f32 v[38:39], v[250:251], v[232:233]
    v_lshlrev_b32 v8, 15, v4
    ds_write_b64 v16, v[86:87] offset:22704
    v_pk_mul_f32 v[32:33], v[242:243], v[226:227]
    v_pk_fma_f32 v[246:247], v[248:249], v[234:235], v[38:39]
    v_lshl_add_u32 v8, v3, 3, v8
    v_pk_mul_f32 v[34:35], v[242:243], v[224:225]
    v_pk_fma_f32 v[244:245], v[248:249], v[232:233], v[36:37] neg_lo:[0,0,1] neg_hi:[0,0,1]
    v_add_u32 v9, 16384, v8
    v_pk_fma_f32 v[242:243], v[240:241], v[226:227], v[34:35]
    v_cvt_pk_bf16_f32 v146, v244, v245
    v_add_u32 v10, 4096, v2
    v_pk_fma_f32 v[240:241], v[240:241], v[224:225], v[32:33] neg_lo:[0,0,1] neg_hi:[0,0,1]
    v_cvt_pk_bf16_f32 v147, -v246, -v247
    v_add_u32 v11, 8192, v2
    ds_write_b64 v16, v[146:147] offset:4752
    v_cvt_pk_bf16_f32 v88, v240, v241
    v_pk_mul_f32 v[36:37], v[246:247], v[234:235]
    v_add_u32 v12, 12288, v2
    v_cvt_pk_bf16_f32 v89, v242, v243
    v_pk_mul_f32 v[38:39], v[246:247], v[232:233]
    s_lshl_b32 s30, s21, 7
    ds_write_b64 v16, v[88:89] offset:23232
    v_pk_mul_f32 v[32:33], v[242:243], v[226:227]
    v_pk_fma_f32 v[246:247], v[244:245], v[234:235], v[38:39]
    s_add_u32 s30, s30, 4096
    v_pk_mul_f32 v[34:35], v[242:243], v[224:225]
    v_pk_fma_f32 v[244:245], v[244:245], v[232:233], v[36:37] neg_lo:[0,0,1] neg_hi:[0,0,1]
    v_lshl_add_u32 v13, v3, 2, s30
    v_pk_fma_f32 v[242:243], v[240:241], v[226:227], v[34:35]
    v_cvt_pk_bf16_f32 v148, v244, v245
    s_mov_b32 s12, s16
    v_pk_fma_f32 v[240:241], v[240:241], v[224:225], v[32:33] neg_lo:[0,0,1] neg_hi:[0,0,1]
    v_cvt_pk_bf16_f32 v149, -v246, -v247
    s_mov_b32 s13, s17
    ds_write_b64 v16, v[148:149] offset:5280
    v_cvt_pk_bf16_f32 v90, v240, v241
    v_pk_mul_f32 v[36:37], v[246:247], v[234:235]
    s_cmp_lt_u32 s49, 6
    ds_write_b64 v16, v[148:149] offset:6336
    v_cvt_pk_bf16_f32 v91, v242, v243
    v_pk_mul_f32 v[38:39], v[246:247], v[232:233]
    s_cselect_b32 s14, s18, 0
    ds_write_b64 v16, v[90:91] offset:23760
    v_pk_mul_f32 v[32:33], v[242:243], v[226:227]
    v_pk_fma_f32 v[246:247], v[244:245], v[234:235], v[38:39]
    v_pk_mul_f32 v[34:35], v[242:243], v[224:225]
    v_pk_fma_f32 v[244:245], v[244:245], v[232:233], v[36:37] neg_lo:[0,0,1] neg_hi:[0,0,1]
    v_pk_fma_f32 v[242:243], v[240:241], v[226:227], v[34:35]
    v_cvt_pk_bf16_f32 v150, v244, v245
    v_pk_fma_f32 v[240:241], v[240:241], v[224:225], v[32:33] neg_lo:[0,0,1] neg_hi:[0,0,1]
    v_cvt_pk_bf16_f32 v151, -v246, -v247
    ds_write_b64 v16, v[150:151] offset:6864
    v_cvt_pk_bf16_f32 v92, v240, v241
    v_pk_mul_f32 v[36:37], v[246:247], v[234:235]
    v_cvt_pk_bf16_f32 v93, v242, v243
    v_pk_mul_f32 v[38:39], v[246:247], v[232:233]
    ds_write_b64 v16, v[92:93] offset:24288
    v_pk_mul_f32 v[32:33], v[242:243], v[226:227]
    v_pk_fma_f32 v[246:247], v[244:245], v[234:235], v[38:39]
    v_pk_mul_f32 v[34:35], v[242:243], v[224:225]
    v_pk_fma_f32 v[244:245], v[244:245], v[232:233], v[36:37] neg_lo:[0,0,1] neg_hi:[0,0,1]
    v_pk_fma_f32 v[242:243], v[240:241], v[226:227], v[34:35]
    v_cvt_pk_bf16_f32 v152, v244, v245
    v_pk_fma_f32 v[240:241], v[240:241], v[224:225], v[32:33] neg_lo:[0,0,1] neg_hi:[0,0,1]
    v_cvt_pk_bf16_f32 v153, -v246, -v247
    ds_write_b64 v16, v[152:153] offset:7392
    v_cvt_pk_bf16_f32 v94, v240, v241
    v_pk_mul_f32 v[36:37], v[250:251], v[230:231]
    v_cvt_pk_bf16_f32 v95, v242, v243
    v_pk_mul_f32 v[38:39], v[250:251], v[228:229]
    ds_write_b64 v16, v[94:95] offset:24816
    v_pk_mul_f32 v[32:33], v[242:243], v[226:227]
    v_pk_fma_f32 v[250:251], v[248:249], v[230:231], v[38:39]
    v_pk_mul_f32 v[34:35], v[242:243], v[224:225]
    v_pk_fma_f32 v[248:249], v[248:249], v[228:229], v[36:37] neg_lo:[0,0,1] neg_hi:[0,0,1]
    v_pk_fma_f32 v[242:243], v[240:241], v[226:227], v[34:35]
    v_cvt_pk_bf16_f32 v154, v248, v249
    v_pk_fma_f32 v[240:241], v[240:241], v[224:225], v[32:33] neg_lo:[0,0,1] neg_hi:[0,0,1]
    v_cvt_pk_bf16_f32 v155, -v250, -v251
    ds_write_b64 v16, v[154:155] offset:8448
    v_cvt_pk_bf16_f32 v96, v240, v241
    v_pk_mul_f32 v[36:37], v[250:251], v[238:239]
    v_cvt_pk_bf16_f32 v97, v242, v243
    v_pk_mul_f32 v[38:39], v[250:251], v[236:237]
    ds_write_b64 v16, v[96:97] offset:25344
    v_pk_mul_f32 v[32:33], v[242:243], v[226:227]
    v_pk_fma_f32 v[246:247], v[248:249], v[238:239], v[38:39]
    v_pk_mul_f32 v[34:35], v[242:243], v[224:225]
    v_pk_fma_f32 v[244:245], v[248:249], v[236:237], v[36:37] neg_lo:[0,0,1] neg_hi:[0,0,1]
    v_pk_fma_f32 v[242:243], v[240:241], v[226:227], v[34:35]
    v_cvt_pk_bf16_f32 v156, v244, v245
    v_pk_fma_f32 v[240:241], v[240:241], v[224:225], v[32:33] neg_lo:[0,0,1] neg_hi:[0,0,1]
    v_cvt_pk_bf16_f32 v157, -v246, -v247
    ds_write_b64 v16, v[156:157] offset:8976
    v_cvt_pk_bf16_f32 v98, v240, v241
    v_pk_mul_f32 v[36:37], v[246:247], v[238:239]
    ds_write_b64 v16, v[156:157] offset:10560
    v_cvt_pk_bf16_f32 v99, v242, v243
    v_pk_mul_f32 v[38:39], v[246:247], v[236:237]
    ds_write_b64 v16, v[98:99] offset:25872
    v_pk_mul_f32 v[32:33], v[242:243], v[226:227]
    v_pk_fma_f32 v[246:247], v[244:245], v[238:239], v[38:39]
    v_pk_mul_f32 v[34:35], v[242:243], v[224:225]
    v_pk_fma_f32 v[244:245], v[244:245], v[236:237], v[36:37] neg_lo:[0,0,1] neg_hi:[0,0,1]
    v_pk_fma_f32 v[242:243], v[240:241], v[226:227], v[34:35]
    v_cvt_pk_bf16_f32 v158, v244, v245
    v_pk_fma_f32 v[240:241], v[240:241], v[224:225], v[32:33] neg_lo:[0,0,1] neg_hi:[0,0,1]
    v_cvt_pk_bf16_f32 v159, -v246, -v247
    ds_write_b64 v16, v[158:159] offset:11088
    v_cvt_pk_bf16_f32 v100, v240, v241
    v_pk_mul_f32 v[36:37], v[250:251], v[230:231]
    v_cvt_pk_bf16_f32 v101, v242, v243
    v_pk_mul_f32 v[38:39], v[250:251], v[228:229]
    ds_write_b64 v16, v[100:101] offset:26400
    v_pk_mul_f32 v[32:33], v[242:243], v[226:227]
    v_pk_fma_f32 v[250:251], v[248:249], v[230:231], v[38:39]
    v_pk_mul_f32 v[34:35], v[242:243], v[224:225]
    v_pk_fma_f32 v[248:249], v[248:249], v[228:229], v[36:37] neg_lo:[0,0,1] neg_hi:[0,0,1]
    v_pk_fma_f32 v[242:243], v[240:241], v[226:227], v[34:35]
    v_cvt_pk_bf16_f32 v160, v248, v249
    v_pk_fma_f32 v[240:241], v[240:241], v[224:225], v[32:33] neg_lo:[0,0,1] neg_hi:[0,0,1]
    v_cvt_pk_bf16_f32 v161, -v250, -v251
    ds_write_b64 v16, v[160:161] offset:9504
    v_cvt_pk_bf16_f32 v102, v240, v241
    v_pk_mul_f32 v[36:37], v[250:251], v[238:239]
    v_cvt_pk_bf16_f32 v103, v242, v243
    v_pk_mul_f32 v[38:39], v[250:251], v[236:237]
    ds_write_b64 v16, v[102:103] offset:26928
    v_pk_mul_f32 v[32:33], v[242:243], v[226:227]
    v_pk_fma_f32 v[246:247], v[248:249], v[238:239], v[38:39]
    v_pk_mul_f32 v[34:35], v[242:243], v[224:225]
    v_pk_fma_f32 v[244:245], v[248:249], v[236:237], v[36:37] neg_lo:[0,0,1] neg_hi:[0,0,1]
    v_pk_fma_f32 v[242:243], v[240:241], v[226:227], v[34:35]
    v_cvt_pk_bf16_f32 v162, v244, v245
    v_pk_fma_f32 v[240:241], v[240:241], v[224:225], v[32:33] neg_lo:[0,0,1] neg_hi:[0,0,1]
    v_cvt_pk_bf16_f32 v163, -v246, -v247
    ds_write_b64 v16, v[162:163] offset:10032
    v_cvt_pk_bf16_f32 v104, v240, v241
    v_pk_mul_f32 v[36:37], v[246:247], v[238:239]
    ds_write_b64 v16, v[162:163] offset:11616
    v_cvt_pk_bf16_f32 v105, v242, v243
    v_pk_mul_f32 v[38:39], v[246:247], v[236:237]
    ds_write_b64 v16, v[104:105] offset:27456
    v_pk_mul_f32 v[32:33], v[242:243], v[226:227]
    v_pk_fma_f32 v[246:247], v[244:245], v[238:239], v[38:39]
    v_pk_mul_f32 v[34:35], v[242:243], v[224:225]
    v_pk_fma_f32 v[244:245], v[244:245], v[236:237], v[36:37] neg_lo:[0,0,1] neg_hi:[0,0,1]
    v_pk_fma_f32 v[242:243], v[240:241], v[226:227], v[34:35]
    v_cvt_pk_bf16_f32 v164, v244, v245
    s_waitcnt vmcnt(4)
    s_barrier
    buffer_store_dword v28, v26, s[16:19], 0 offen sc0 sc1
    buffer_load_dword v15, v13, s[16:19], 0 offen sc0 sc1
    v_pk_fma_f32 v[240:241], v[240:241], v[224:225], v[32:33] neg_lo:[0,0,1] neg_hi:[0,0,1]
    v_cvt_pk_bf16_f32 v165, -v246, -v247
    ds_write_b64 v16, v[164:165] offset:12144
    v_cvt_pk_bf16_f32 v106, v240, v241
    v_pk_mul_f32 v[36:37], v[250:251], v[230:231]
    v_cvt_pk_bf16_f32 v107, v242, v243
    v_pk_mul_f32 v[38:39], v[250:251], v[228:229]
    ds_write_b64 v16, v[106:107] offset:27984
    v_pk_mul_f32 v[32:33], v[242:243], v[226:227]
    v_pk_fma_f32 v[250:251], v[248:249], v[230:231], v[38:39]
    v_pk_mul_f32 v[34:35], v[242:243], v[224:225]
    v_pk_fma_f32 v[248:249], v[248:249], v[228:229], v[36:37] neg_lo:[0,0,1] neg_hi:[0,0,1]
    v_pk_fma_f32 v[242:243], v[240:241], v[226:227], v[34:35]
    v_cvt_pk_bf16_f32 v166, v248, v249
    v_pk_fma_f32 v[240:241], v[240:241], v[224:225], v[32:33] neg_lo:[0,0,1] neg_hi:[0,0,1]
    v_cvt_pk_bf16_f32 v167, -v250, -v251
    ds_write_b64 v16, v[166:167] offset:12672
    v_cvt_pk_bf16_f32 v108, v240, v241
    v_pk_mul_f32 v[36:37], v[250:251], v[226:227]
    v_cvt_pk_bf16_f32 v109, v242, v243
    v_pk_mul_f32 v[38:39], v[250:251], v[224:225]
    ds_write_b64 v16, v[108:109] offset:28512
    v_pk_mul_f32 v[32:33], v[242:243], v[226:227]
    v_pk_fma_f32 v[246:247], v[248:249], v[226:227], v[38:39]
    v_pk_mul_f32 v[34:35], v[242:243], v[224:225]
    v_pk_fma_f32 v[244:245], v[248:249], v[224:225], v[36:37] neg_lo:[0,0,1] neg_hi:[0,0,1]
    v_pk_fma_f32 v[242:243], v[240:241], v[226:227], v[34:35]
    v_cvt_pk_bf16_f32 v168, v244, v245
    v_pk_fma_f32 v[240:241], v[240:241], v[224:225], v[32:33] neg_lo:[0,0,1] neg_hi:[0,0,1]
    v_cvt_pk_bf16_f32 v169, -v246, -v247
    ds_write_b64 v16, v[168:169] offset:14784
    v_cvt_pk_bf16_f32 v110, v240, v241
    v_pk_mul_f32 v[36:37], v[250:251], v[230:231]
    v_cvt_pk_bf16_f32 v111, v242, v243
    v_pk_mul_f32 v[38:39], v[250:251], v[228:229]
    ds_write_b64 v16, v[110:111] offset:29040
    v_pk_mul_f32 v[32:33], v[242:243], v[226:227]
    v_pk_fma_f32 v[250:251], v[248:249], v[230:231], v[38:39]
    v_pk_mul_f32 v[34:35], v[242:243], v[224:225]
    v_pk_fma_f32 v[248:249], v[248:249], v[228:229], v[36:37] neg_lo:[0,0,1] neg_hi:[0,0,1]
    v_pk_fma_f32 v[242:243], v[240:241], v[226:227], v[34:35]
    v_cvt_pk_bf16_f32 v170, v248, v249
    v_pk_fma_f32 v[240:241], v[240:241], v[224:225], v[32:33] neg_lo:[0,0,1] neg_hi:[0,0,1]
    v_cvt_pk_bf16_f32 v171, -v250, -v251
    ds_write_b64 v16, v[170:171] offset:13200
    v_cvt_pk_bf16_f32 v112, v240, v241
    v_pk_mul_f32 v[36:37], v[250:251], v[226:227]
    v_cvt_pk_bf16_f32 v113, v242, v243
    v_pk_mul_f32 v[38:39], v[250:251], v[224:225]
    ds_write_b64 v16, v[112:113] offset:29568
    v_pk_mul_f32 v[32:33], v[242:243], v[226:227]
    v_pk_fma_f32 v[246:247], v[248:249], v[226:227], v[38:39]
    v_pk_mul_f32 v[34:35], v[242:243], v[224:225]
    v_pk_fma_f32 v[244:245], v[248:249], v[224:225], v[36:37] neg_lo:[0,0,1] neg_hi:[0,0,1]
    v_pk_fma_f32 v[242:243], v[240:241], v[226:227], v[34:35]
    v_cvt_pk_bf16_f32 v172, v244, v245
    v_pk_fma_f32 v[240:241], v[240:241], v[224:225], v[32:33] neg_lo:[0,0,1] neg_hi:[0,0,1]
    v_cvt_pk_bf16_f32 v173, -v246, -v247
    ds_write_b64 v16, v[172:173] offset:15312
    v_cvt_pk_bf16_f32 v114, v240, v241
    v_pk_mul_f32 v[36:37], v[250:251], v[230:231]
    v_cvt_pk_bf16_f32 v115, v242, v243
    v_pk_mul_f32 v[38:39], v[250:251], v[228:229]
    ds_write_b64 v16, v[114:115] offset:30096
    v_pk_mul_f32 v[32:33], v[242:243], v[226:227]
    v_pk_fma_f32 v[250:251], v[248:249], v[230:231], v[38:39]
    v_pk_mul_f32 v[34:35], v[242:243], v[224:225]
    v_pk_fma_f32 v[248:249], v[248:249], v[228:229], v[36:37] neg_lo:[0,0,1] neg_hi:[0,0,1]
    v_pk_fma_f32 v[242:243], v[240:241], v[226:227], v[34:35]
    v_cvt_pk_bf16_f32 v174, v248, v249
    v_pk_fma_f32 v[240:241], v[240:241], v[224:225], v[32:33] neg_lo:[0,0,1] neg_hi:[0,0,1]
    v_cvt_pk_bf16_f32 v175, -v250, -v251
    ds_write_b64 v16, v[174:175] offset:13728
    v_cvt_pk_bf16_f32 v116, v240, v241
    v_pk_mul_f32 v[36:37], v[250:251], v[226:227]
    v_cvt_pk_bf16_f32 v117, v242, v243
    v_pk_mul_f32 v[38:39], v[250:251], v[224:225]
    ds_write_b64 v16, v[116:117] offset:30624
    v_pk_mul_f32 v[32:33], v[242:243], v[226:227]
    v_pk_fma_f32 v[246:247], v[248:249], v[226:227], v[38:39]
    v_pk_mul_f32 v[34:35], v[242:243], v[224:225]
    v_pk_fma_f32 v[244:245], v[248:249], v[224:225], v[36:37] neg_lo:[0,0,1] neg_hi:[0,0,1]
    v_pk_fma_f32 v[242:243], v[240:241], v[226:227], v[34:35]
    v_cvt_pk_bf16_f32 v176, v244, v245
    v_pk_fma_f32 v[240:241], v[240:241], v[224:225], v[32:33] neg_lo:[0,0,1] neg_hi:[0,0,1]
    v_cvt_pk_bf16_f32 v177, -v246, -v247
    ds_write_b64 v16, v[176:177] offset:15840
    v_cvt_pk_bf16_f32 v118, v240, v241
    v_pk_mul_f32 v[36:37], v[250:251], v[230:231]
    v_cvt_pk_bf16_f32 v119, v242, v243
    v_pk_mul_f32 v[38:39], v[250:251], v[228:229]
    ds_write_b64 v16, v[118:119] offset:31152
    v_pk_mul_f32 v[32:33], v[242:243], v[226:227]
    v_pk_fma_f32 v[250:251], v[248:249], v[230:231], v[38:39]
    v_pk_mul_f32 v[34:35], v[242:243], v[224:225]
    v_pk_fma_f32 v[248:249], v[248:249], v[228:229], v[36:37] neg_lo:[0,0,1] neg_hi:[0,0,1]
    v_pk_fma_f32 v[242:243], v[240:241], v[226:227], v[34:35]
    v_cvt_pk_bf16_f32 v178, v248, v249
    v_pk_fma_f32 v[240:241], v[240:241], v[224:225], v[32:33] neg_lo:[0,0,1] neg_hi:[0,0,1]
    v_cvt_pk_bf16_f32 v179, -v250, -v251
    ds_write_b64 v16, v[178:179] offset:14256
    v_cvt_pk_bf16_f32 v120, v240, v241
    v_pk_mul_f32 v[36:37], v[250:251], v[226:227]
    v_cvt_pk_bf16_f32 v121, v242, v243
    v_pk_mul_f32 v[38:39], v[250:251], v[224:225]
    ds_write_b64 v16, v[120:121] offset:31680
    v_pk_mul_f32 v[32:33], v[242:243], v[226:227]
    v_pk_fma_f32 v[246:247], v[248:249], v[226:227], v[38:39]
    v_pk_mul_f32 v[34:35], v[242:243], v[224:225]
    v_pk_fma_f32 v[244:245], v[248:249], v[224:225], v[36:37] neg_lo:[0,0,1] neg_hi:[0,0,1]
    v_pk_fma_f32 v[242:243], v[240:241], v[226:227], v[34:35]
    v_cvt_pk_bf16_f32 v180, v244, v245
    v_pk_fma_f32 v[240:241], v[240:241], v[224:225], v[32:33] neg_lo:[0,0,1] neg_hi:[0,0,1]
    v_cvt_pk_bf16_f32 v181, -v246, -v247
    ds_write_b64 v16, v[180:181] offset:16368
    v_cvt_pk_bf16_f32 v122, v240, v241
    v_cvt_pk_bf16_f32 v123, v242, v243
    ds_write_b64 v16, v[122:123] offset:32208
    v_pk_mul_f32 v[32:33], v[242:243], v[226:227]
    v_pk_mul_f32 v[34:35], v[242:243], v[224:225]
    v_pk_fma_f32 v[242:243], v[240:241], v[226:227], v[34:35]
    v_pk_fma_f32 v[240:241], v[240:241], v[224:225], v[32:33] neg_lo:[0,0,1] neg_hi:[0,0,1]
    v_cvt_pk_bf16_f32 v124, v240, v241
    v_cvt_pk_bf16_f32 v125, v242, v243
    ds_write_b64 v16, v[124:125] offset:32736
    v_pk_mul_f32 v[32:33], v[242:243], v[226:227]
    v_pk_mul_f32 v[34:35], v[242:243], v[224:225]
    v_pk_fma_f32 v[242:243], v[240:241], v[226:227], v[34:35]
    v_pk_fma_f32 v[240:241], v[240:241], v[224:225], v[32:33] neg_lo:[0,0,1] neg_hi:[0,0,1]
    v_cvt_pk_bf16_f32 v126, v240, v241
    v_cvt_pk_bf16_f32 v127, v242, v243
    ds_write_b64 v16, v[126:127] offset:33264
    s_waitcnt vmcnt(2)
    ds_write_b128 v29, v[184:187] offset:0
    ds_write_b128 v29, v[188:191] offset:1024
    ds_write_b128 v29, v[192:195] offset:2048
    ds_write_b128 v29, v[196:199] offset:3072
    v_and_b32 v17, 31, v1
    v_lshrrev_b32 v18, 5, v1
    v_mul_u32_u24 v19, 528, v17
    v_lshl_add_u32 v19, v18, 4, v19
    v_add_u32 v19, s34, v19
    s_waitcnt vmcnt(0)
    s_mov_b32 s29, 262144
L_pb0:
    v_cmp_gt_u32 vcc, s96, v15
    s_cbranch_vccz L_pb0_ok
    s_sub_u32 s29, s29, 1
    s_cbranch_scc1 L_pb0_ok
    buffer_load_dword v15, v13, s[16:19], 0 offen sc0 sc1
    s_waitcnt vmcnt(0)
    s_branch L_pb0
L_pb0_ok:
    s_waitcnt lgkmcnt(0)
    s_and_b32 s9, s9, 0xffff
    s_mov_b32 s10, 1152
    ds_read_b128 v[64:67], v19 offset:0
    ds_read_b128 v[68:71], v19 offset:16896
    s_mov_b32 s11, 0x00020000
    v_and_b32 v6, 1, v1
    ds_read_b128 v[72:75], v19 offset:32
    ds_read_b128 v[76:79], v19 offset:16928
    v_lshlrev_b32 v6, 4, v6
    v_mov_b32 v63, 0x3f80
    buffer_load_dwordx4 a[144:147], v2, s[16:19], s60 offen offset:0 sc0 sc1
    ds_read_b128 v[80:83], v19 offset:64
    ds_read_b128 v[84:87], v19 offset:16960
    v_lshlrev_b32 v6, v6, v63
    v_bfe_u32 v63, v1, 3, 1
    ds_read_b128 v[88:91], v19 offset:96
    ds_read_b128 v[92:95], v19 offset:16992
    s_waitcnt lgkmcnt(6)
    v_mfma_f32_32x32x16_bf16 v[192:207], v[64:67], v[68:71], 0
    v_bfe_u32 v208, v1, 1, 1
    v_lshl_add_u32 v63, v63, 1, v208
    ds_read_b128 v[96:99], v19 offset:128
    ds_read_b128 v[100:103], v19 offset:17024
    s_waitcnt lgkmcnt(6)
    v_mfma_f32_32x32x16_bf16 v[192:207], v[72:75], v[76:79], v[192:207]
    v_bfe_u32 v208, v1, 2, 1
    v_lshlrev_b32 v208, 1, v208
    buffer_load_dwordx4 a[148:151], v2, s[16:19], s60 offen offset:1024 sc0 sc1
    ds_read_b128 v[104:107], v19 offset:160
    ds_read_b128 v[108:111], v19 offset:17056
    s_waitcnt lgkmcnt(6)
    v_mfma_f32_32x32x16_bf16 v[192:207], v[80:83], v[84:87], v[192:207]
    v_sub_u32 v208, v4, v208
    v_lshl_add_u32 v63, v208, 2, v63
    ds_read_b128 v[112:115], v19 offset:192
    ds_read_b128 v[116:119], v19 offset:17088
    s_waitcnt lgkmcnt(6)
    v_mfma_f32_32x32x16_bf16 v[192:207], v[88:91], v[92:95], v[192:207]
    v_cmp_eq_u32 vcc, 0, v63
    s_nop 1
    v_cndmask_b32 v208, 0, v6, vcc
    buffer_load_dwordx4 a[152:155], v2, s[16:19], s60 offen offset:2048 sc0 sc1
    ds_read_b128 v[120:123], v19 offset:224
    ds_read_b128 v[124:127], v19 offset:17120
    s_waitcnt lgkmcnt(6)
    v_mfma_f32_32x32x16_bf16 v[192:207], v[96:99], v[100:103], v[192:207]
    v_cmp_eq_u32 vcc, 1, v63
    s_nop 1
    v_cndmask_b32 v209, 0, v6, vcc
    ds_read_b128 v[128:131], v19 offset:256
    ds_read_b128 v[132:135], v19 offset:17152
    s_waitcnt lgkmcnt(6)
    v_mfma_f32_32x32x16_bf16 v[192:207], v[104:107], v[108:111], v[192:207]
    v_cmp_eq_u32 vcc, 2, v63
    s_nop 1
    v_cndmask_b32 v210, 0, v6, vcc
    ds_read_b128 v[136:139], v19 offset:288
    ds_read_b128 v[140:143], v19 offset:17184
    s_waitcnt lgkmcnt(6)
    v_mfma_f32_32x32x16_bf16 v[192:207], v[112:115], v[116:119], v[192:207]
    v_cmp_eq_u32 vcc, 3, v63
    s_nop 1
    v_cndmask_b32 v211, 0, v6, vcc
    buffer_load_dwordx4 a[156:159], v2, s[16:19], s60 offen offset:3072 sc0 sc1
    ds_read_b128 v[144:147], v19 offset:320
    ds_read_b128 v[148:151], v19 offset:17216
    s_waitcnt lgkmcnt(6)
    v_mfma_f32_32x32x16_bf16 v[192:207], v[120:123], v[124:127], v[192:207]
    v_cmp_eq_u32 vcc, 4, v63
    s_nop 1
    v_cndmask_b32 v212, 0, v6, vcc
    ds_read_b128 v[152:155], v19 offset:352
    ds_read_b128 v[156:159], v19 offset:17248
    s_waitcnt lgkmcnt(6)
    v_mfma_f32_32x32x16_bf16 v[192:207], v[128:131], v[132:135], v[192:207]
    v_cmp_eq_u32 vcc, 5, v63
    s_nop 1
    v_cndmask_b32 v213, 0, v6, vcc
    ds_read_b128 v[160:163], v19 offset:384
    ds_read_b128 v[164:167], v19 offset:17280
    s_waitcnt lgkmcnt(6)
    v_mfma_f32_32x32x16_bf16 v[192:207], v[136:139], v[140:143], v[192:207]
    v_cmp_eq_u32 vcc, 6, v63
    s_nop 1
    v_cndmask_b32 v214, 0, v6, vcc
    buffer_load_dwordx4 a[160:163], v10, s[16:19], s60 offen offset:0 sc0 sc1
    ds_read_b128 v[168:171], v19 offset:416
    ds_read_b128 v[172:175], v19 offset:17312
    s_waitcnt lgkmcnt(6)
    v_mfma_f32_32x32x16_bf16 v[192:207], v[144:147], v[148:151], v[192:207]
    v_cmp_eq_u32 vcc, 7, v63
    s_nop 1
    v_cndmask_b32 v215, 0, v6, vcc
    ds_read_b128 v[176:179], v19 offset:448
    ds_read_b128 v[180:183], v19 offset:17344
    s_waitcnt lgkmcnt(6)
    v_mfma_f32_32x32x16_bf16 v[192:207], v[152:155], v[156:159], v[192:207]
    buffer_load_dwordx4 a[164:167], v10, s[16:19], s60 offen offset:1024 sc0 sc1
    ds_read_b128 v[184:187], v19 offset:480
    ds_read_b128 v[188:191], v19 offset:17376
    s_waitcnt lgkmcnt(6)
    v_mfma_f32_32x32x16_bf16 v[192:207], v[160:163], v[164:167], v[192:207]
    s_waitcnt lgkmcnt(4)
    v_mfma_f32_32x32x16_bf16 v[192:207], v[168:171], v[172:175], v[192:207]
    s_waitcnt lgkmcnt(2)
    v_mfma_f32_32x32x16_bf16 v[192:207], v[176:179], v[180:183], v[192:207]
    s_waitcnt lgkmcnt(0)
    v_mfma_f32_32x32x16_bf16 v[192:207], v[184:187], v[188:191], v[192:207]
    v_lshlrev_b32 v20, 4, v17
    v_lshl_add_u32 v20, v18, 3, v20
    v_add_u32 v20, s34, v20
    v_mov_b32 v22, 0
    v_mov_b32 v23, 0
    v_and_b32 v21, 3, v1
    v_lshl_add_u32 v21, v21, 3, s34
    v_and_b32 v24, 33, v1
    v_cmp_eq_u32 vcc, 0, v24
    v_add_u32 v25, 8256, v20
    v_add_u32 v24, 8, v20
    v_cndmask_b32 v24, v25, v24, vcc
    v_cmp_ne_u32 vcc, 0, v18
    v_add_u32 v25, 2080, v20
    v_add_u32 v26, 3104, v20
    s_nop 7
    ds_write_b64 v21, v[22:23]
    v_cvt_pk_bf16_f32 v32, v192, v193
    v_cvt_pk_bf16_f32 v33, v194, v195
    ds_write_b64 v20, v[32:33] offset:32
    v_cvt_pk_bf16_f32 v34, v196, v196
    v_cvt_pk_bf16_f32 v35, v197, v198
    ds_write_b64 v20, v[34:35] offset:544
    v_cndmask_b32 v40, v200, v201, vcc
    v_cvt_pk_bf16_f32 v36, v200, v200
    v_cvt_pk_bf16_f32 v37, v40, v201
    ds_write_b64 v20, v[36:37] offset:1056
    v_cndmask_b32 v40, v202, v203, vcc
    v_cvt_pk_bf16_f32 v38, v202, v202
    v_cvt_pk_bf16_f32 v39, v40, v203
    ds_write_b64 v20, v[38:39] offset:1568
    v_cvt_pk_bf16_f32 v42, v204, v204
    ds_write2_b32 v25, v42, v42 offset0:0 offset1:1
    v_cvt_pk_bf16_f32 v43, v205, v205
    ds_write2_b32 v25, v43, v43 offset0:128 offset1:129
    v_cvt_pk_bf16_f32 v44, v206, v206
    ds_write2_b32 v26, v44, v44 offset0:0 offset1:1
    v_cvt_pk_bf16_f32 v45, v207, v207
    ds_write2_b32 v26, v45, v45 offset0:128 offset1:129
    ds_write_b16 v24, v42 offset:2080
    ds_write_b16 v24, v43 offset:2592
    ds_write_b16 v24, v44 offset:3104
    ds_write_b16 v24, v45 offset:3616
    v_lshl_add_u32 v20, v1, 4, s34
    v_and_b32 v21, 7, v1
    v_mul_u32_u24 v21, 4128, v21
    v_add_u32 v21, s34, v21
    v_mov_b32 v24, 0
    v_mov_b32 v25, 0
    s_waitcnt lgkmcnt(0)
    ds_read_b128 v[64:67], v20 offset:16
    ds_read_b128 v[68:71], v20 offset:32
    ds_read_b128 v[72:75], v20 offset:1040
    ds_read_b128 v[76:79], v20 offset:1056
    ds_read_b128 v[80:83], v20 offset:2064
    ds_read_b128 v[84:87], v20 offset:2080
    ds_read_b128 v[88:91], v20 offset:3088
    ds_read_b128 v[92:95], v20 offset:3104
    s_waitcnt lgkmcnt(0)
    ds_write_b128 v21, v[22:25]
    ds_write_b128 v20, v[66:69] offset:12400
    ds_write_b128 v20, v[68:71] offset:28912
    v_pk_mov_b32 v[108:109], v[64:65], v[66:67] op_sel:[1,0]
    v_pk_mov_b32 v[110:111], v[66:67], v[68:69] op_sel:[1,0]
    v_pk_mov_b32 v[112:113], v[68:69], v[70:71] op_sel:[1,0]
    buffer_load_dwordx4 a[168:171], v10, s[16:19], s60 offen offset:2048 sc0 sc1
    ds_write_b128 v20, v[108:111] offset:4144
    ds_write_b128 v20, v[110:113] offset:20656
    v_alignbit_b32 v96, v65, v64, 16
    v_alignbit_b32 v97, v66, v65, 16
    v_alignbit_b32 v98, v67, v66, 16
    v_alignbit_b32 v99, v68, v67, 16
    v_alignbit_b32 v100, v69, v68, 16
    v_alignbit_b32 v101, v70, v69, 16
    ds_write_b128 v20, v[96:99] offset:16
    ds_write_b128 v20, v[98:101] offset:16528
    v_alignbit_b32 v102, v66, v65, 16
    v_alignbit_b32 v103, v67, v66, 16
    v_alignbit_b32 v104, v68, v67, 16
    v_alignbit_b32 v105, v69, v68, 16
    v_alignbit_b32 v106, v70, v69, 16
    v_alignbit_b32 v107, v71, v70, 16
    buffer_load_dwordx4 a[172:175], v10, s[16:19], s60 offen offset:3072 sc0 sc1
    buffer_load_dwordx4 a[176:179], v11, s[16:19], s60 offen offset:0 sc0 sc1
    ds_write_b128 v20, v[102:105] offset:8272
    ds_write_b128 v20, v[104:107] offset:24784
    ds_write_b128 v20, v[74:77] offset:13424
    ds_write_b128 v20, v[76:79] offset:29936
    v_pk_mov_b32 v[126:127], v[72:73], v[74:75] op_sel:[1,0]
    v_pk_mov_b32 v[128:129], v[74:75], v[76:77] op_sel:[1,0]
    v_pk_mov_b32 v[130:131], v[76:77], v[78:79] op_sel:[1,0]
    buffer_load_dwordx4 a[180:183], v11, s[16:19], s60 offen offset:1024 sc0 sc1
    ds_write_b128 v20, v[126:129] offset:5168
    ds_write_b128 v20, v[128:131] offset:21680
    v_alignbit_b32 v114, v73, v72, 16
    v_alignbit_b32 v115, v74, v73, 16
    v_alignbit_b32 v116, v75, v74, 16
    v_alignbit_b32 v117, v76, v75, 16
    v_alignbit_b32 v118, v77, v76, 16
    v_alignbit_b32 v119, v78, v77, 16
    ds_write_b128 v20, v[114:117] offset:1040
    ds_write_b128 v20, v[116:119] offset:17552
    v_alignbit_b32 v120, v74, v73, 16
    v_alignbit_b32 v121, v75, v74, 16
    v_alignbit_b32 v122, v76, v75, 16
    v_alignbit_b32 v123, v77, v76, 16
    v_alignbit_b32 v124, v78, v77, 16
    v_alignbit_b32 v125, v79, v78, 16
    buffer_load_dwordx4 a[184:187], v11, s[16:19], s60 offen offset:2048 sc0 sc1
    buffer_load_dwordx4 a[188:191], v11, s[16:19], s60 offen offset:3072 sc0 sc1
    ds_write_b128 v20, v[120:123] offset:9296
    ds_write_b128 v20, v[122:125] offset:25808
    ds_write_b128 v20, v[82:85] offset:14448
    ds_write_b128 v20, v[84:87] offset:30960
    v_pk_mov_b32 v[144:145], v[80:81], v[82:83] op_sel:[1,0]
    v_pk_mov_b32 v[146:147], v[82:83], v[84:85] op_sel:[1,0]
    v_pk_mov_b32 v[148:149], v[84:85], v[86:87] op_sel:[1,0]
    buffer_load_dwordx4 a[192:195], v12, s[16:19], s60 offen offset:0 sc0 sc1
    ds_write_b128 v20, v[144:147] offset:6192
    ds_write_b128 v20, v[146:149] offset:22704
    v_alignbit_b32 v132, v81, v80, 16
    v_alignbit_b32 v133, v82, v81, 16
    v_alignbit_b32 v134, v83, v82, 16
    v_alignbit_b32 v135, v84, v83, 16
    v_alignbit_b32 v136, v85, v84, 16
    v_alignbit_b32 v137, v86, v85, 16
    ds_write_b128 v20, v[132:135] offset:2064
    ds_write_b128 v20, v[134:137] offset:18576
    v_alignbit_b32 v138, v82, v81, 16
    v_alignbit_b32 v139, v83, v82, 16
    v_alignbit_b32 v140, v84, v83, 16
    v_alignbit_b32 v141, v85, v84, 16
    v_alignbit_b32 v142, v86, v85, 16
    v_alignbit_b32 v143, v87, v86, 16
    buffer_load_dwordx4 a[196:199], v12, s[16:19], s60 offen offset:1024 sc0 sc1
    buffer_load_dwordx4 a[200:203], v12, s[16:19], s60 offen offset:2048 sc0 sc1
    ds_write_b128 v20, v[138:141] offset:10320
    ds_write_b128 v20, v[140:143] offset:26832
    ds_write_b128 v20, v[90:93] offset:15472
    ds_write_b128 v20, v[92:95] offset:31984
    v_pk_mov_b32 v[162:163], v[88:89], v[90:91] op_sel:[1,0]
    v_pk_mov_b32 v[164:165], v[90:91], v[92:93] op_sel:[1,0]
    v_pk_mov_b32 v[166:167], v[92:93], v[94:95] op_sel:[1,0]
    buffer_load_dwordx4 a[204:207], v12, s[16:19], s60 offen offset:3072 sc0 sc1
    ds_write_b128 v20, v[162:165] offset:7216
    ds_write_b128 v20, v[164:167] offset:23728
    v_alignbit_b32 v150, v89, v88, 16
    v_alignbit_b32 v151, v90, v89, 16
    v_alignbit_b32 v152, v91, v90, 16
    v_alignbit_b32 v153, v92, v91, 16
    v_alignbit_b32 v154, v93, v92, 16
    v_alignbit_b32 v155, v94, v93, 16
    ds_write_b128 v20, v[150:153] offset:3088
    ds_write_b128 v20, v[152:155] offset:19600
    v_alignbit_b32 v156, v90, v89, 16
    v_alignbit_b32 v157, v91, v90, 16
    v_alignbit_b32 v158, v92, v91, 16
    v_alignbit_b32 v159, v93, v92, 16
    v_alignbit_b32 v160, v94, v93, 16
    v_alignbit_b32 v161, v95, v94, 16
    ds_write_b128 v20, v[156:159] offset:11344
    ds_write_b128 v20, v[158:161] offset:27856
    v_and_b32 v17, 15, v1
    v_lshrrev_b32 v18, 4, v1
    v_lshlrev_b32 v19, 4, v18
    v_lshrrev_b32 v20, 3, v17
    v_lshl_add_u32 v20, v20, 4, v19
    v_add_u32 v20, v21, v20
    s_lshl_b32 s29, s22, 12
    s_add_u32 s29, s29, 147936
    v_lshlrev_b32 v21, 5, v17
    v_sub_u32 v21, v19, v21
    v_add_u32 v21, s29, v21
    v_lshlrev_b32 v22, 1, v17
    v_sub_u32 v22, v22, v18
    v_mov_b32 v23, s34
    s_mov_b32 s29, 262144
L_pb1:
    v_cmp_gt_u32 vcc, s97, v15
    s_cbranch_vccz L_pb1_ok
    s_sub_u32 s29, s29, 1
    s_cbranch_scc1 L_pb1_ok
    buffer_load_dword v15, v13, s[16:19], 0 offen sc0 sc1
    s_waitcnt vmcnt(0)
    s_branch L_pb1
L_pb1_ok:
    buffer_load_dwordx4 v[216:219], v5, s[4:7], s61 offen
    s_lshr_b32 s30, s62, 17
    s_sub_u32 s30, s30, 8
    s_lshl_b32 s30, s30, 6
    buffer_load_dwordx4 v[220:223], v7, s[8:11], s30 offen
    buffer_load_dwordx4 v[224:227], v5, s[4:7], s65 offen
    s_lshr_b32 s30, s66, 17
    s_sub_u32 s30, s30, 8
    s_lshl_b32 s30, s30, 6
    buffer_load_dwordx4 v[228:231], v7, s[8:11], s30 offen
    s_waitcnt lgkmcnt(0)
    v_cmp_lt_i32 vcc, -2, v22
    v_add_u32 v24, 3584, v21
    s_nop 0
    v_cndmask_b32 v24, v23, v24, vcc
    ds_read_b128 v[64:67], v20 offset:0
    ds_read_b128 v[96:99], v24
    ds_read_b128 v[68:71], v20 offset:512
    ds_read_b128 v[100:103], v21 offset:3072
    ds_read_b128 v[72:75], v20 offset:1024
    ds_read_b128 v[104:107], v21 offset:2560
    ds_read_b128 v[76:79], v20 offset:1536
    ds_read_b128 v[108:111], v21 offset:2048
    ds_read_b128 v[80:83], v20 offset:2048
    ds_read_b128 v[112:115], v21 offset:1536
    ds_read_b128 v[84:87], v20 offset:2560
    ds_read_b128 v[116:119], v21 offset:1024
    ds_read_b128 v[88:91], v20 offset:3072
    ds_read_b128 v[120:123], v21 offset:512
    ds_read_b128 v[92:95], v20 offset:3584
    ds_read_b128 v[124:127], v21 offset:0
    s_waitcnt lgkmcnt(0)
    v_mfma_f32_16x16x32_bf16 v[32:35], v[64:67], v[96:99], 0
    v_cmp_lt_i32 vcc, 2, v22
    v_mfma_f32_16x16x32_bf16 v[36:39], v[64:67], v[100:103], 0
    v_add_u32 v24, 3648, v21
    v_mfma_f32_16x16x32_bf16 v[40:43], v[64:67], v[104:107], 0
    v_cndmask_b32 v24, v23, v24, vcc
    v_mfma_f32_16x16x32_bf16 v[44:47], v[64:67], v[108:111], 0
    ds_read_b128 v[128:131], v20 offset:64
    v_mfma_f32_16x16x32_bf16 v[48:51], v[64:67], v[112:115], 0
    ds_read_b128 v[160:163], v24
    v_mfma_f32_16x16x32_bf16 v[52:55], v[64:67], v[116:119], 0
    ds_read_b128 v[132:135], v20 offset:576
    v_mfma_f32_16x16x32_bf16 v[56:59], v[64:67], v[120:123], 0
    ds_read_b128 v[164:167], v21 offset:3136
    v_mfma_f32_16x16x32_bf16 v[60:63], v[64:67], v[124:127], 0
    ds_read_b128 v[136:139], v20 offset:1088
    v_mfma_f32_16x16x32_bf16 v[36:39], v[68:71], v[96:99], v[36:39]
    ds_read_b128 v[168:171], v21 offset:2624
    v_mfma_f32_16x16x32_bf16 v[40:43], v[68:71], v[100:103], v[40:43]
    ds_read_b128 v[140:143], v20 offset:1600
    v_mfma_f32_16x16x32_bf16 v[44:47], v[68:71], v[104:107], v[44:47]
    ds_read_b128 v[172:175], v21 offset:2112
    v_mfma_f32_16x16x32_bf16 v[48:51], v[68:71], v[108:111], v[48:51]
    ds_read_b128 v[144:147], v20 offset:2112
    v_mfma_f32_16x16x32_bf16 v[52:55], v[68:71], v[112:115], v[52:55]
    ds_read_b128 v[176:179], v21 offset:1600
    v_mfma_f32_16x16x32_bf16 v[56:59], v[68:71], v[116:119], v[56:59]
    ds_read_b128 v[148:151], v20 offset:2624
    v_mfma_f32_16x16x32_bf16 v[60:63], v[68:71], v[120:123], v[60:63]
    ds_read_b128 v[180:183], v21 offset:1088
    v_mfma_f32_16x16x32_bf16 v[40:43], v[72:75], v[96:99], v[40:43]
    ds_read_b128 v[152:155], v20 offset:3136
    v_mfma_f32_16x16x32_bf16 v[44:47], v[72:75], v[100:103], v[44:47]
    ds_read_b128 v[184:187], v21 offset:576
    v_mfma_f32_16x16x32_bf16 v[48:51], v[72:75], v[104:107], v[48:51]
    ds_read_b128 v[156:159], v20 offset:3648
    v_mfma_f32_16x16x32_bf16 v[52:55], v[72:75], v[108:111], v[52:55]
    ds_read_b128 v[188:191], v21 offset:64
    v_mfma_f32_16x16x32_bf16 v[56:59], v[72:75], v[112:115], v[56:59]
    v_mfma_f32_16x16x32_bf16 v[60:63], v[72:75], v[116:119], v[60:63]
    buffer_load_dwordx4 a[208:211], v2, s[12:15], s64 offen offset:0 sc0 sc1
    v_mfma_f32_16x16x32_bf16 v[44:47], v[76:79], v[96:99], v[44:47]
    v_mfma_f32_16x16x32_bf16 v[48:51], v[76:79], v[100:103], v[48:51]
    v_mfma_f32_16x16x32_bf16 v[52:55], v[76:79], v[104:107], v[52:55]
    v_mfma_f32_16x16x32_bf16 v[56:59], v[76:79], v[108:111], v[56:59]
    v_mfma_f32_16x16x32_bf16 v[60:63], v[76:79], v[112:115], v[60:63]
    v_mfma_f32_16x16x32_bf16 v[48:51], v[80:83], v[96:99], v[48:51]
    v_mfma_f32_16x16x32_bf16 v[52:55], v[80:83], v[100:103], v[52:55]
    v_mfma_f32_16x16x32_bf16 v[56:59], v[80:83], v[104:107], v[56:59]
    buffer_load_dwordx4 a[212:215], v2, s[12:15], s64 offen offset:1024 sc0 sc1
    v_mfma_f32_16x16x32_bf16 v[60:63], v[80:83], v[108:111], v[60:63]
    v_mfma_f32_16x16x32_bf16 v[52:55], v[84:87], v[96:99], v[52:55]
    v_mfma_f32_16x16x32_bf16 v[56:59], v[84:87], v[100:103], v[56:59]
    v_mfma_f32_16x16x32_bf16 v[60:63], v[84:87], v[104:107], v[60:63]
    v_mfma_f32_16x16x32_bf16 v[56:59], v[88:91], v[96:99], v[56:59]
    v_mfma_f32_16x16x32_bf16 v[60:63], v[88:91], v[100:103], v[60:63]
    v_mfma_f32_16x16x32_bf16 v[60:63], v[92:95], v[96:99], v[60:63]
    s_waitcnt lgkmcnt(0)
    v_mfma_f32_16x16x32_bf16 v[32:35], v[128:131], v[160:163], v[32:35]
    v_cmp_lt_i32 vcc, 6, v22
    v_mfma_f32_16x16x32_bf16 v[36:39], v[128:131], v[164:167], v[36:39]
    v_add_u32 v24, 3712, v21
    v_mfma_f32_16x16x32_bf16 v[40:43], v[128:131], v[168:171], v[40:43]
    v_cndmask_b32 v24, v23, v24, vcc
    v_mfma_f32_16x16x32_bf16 v[44:47], v[128:131], v[172:175], v[44:47]
    ds_read_b128 v[64:67], v20 offset:128
    v_mfma_f32_16x16x32_bf16 v[48:51], v[128:131], v[176:179], v[48:51]
    ds_read_b128 v[96:99], v24
    v_mfma_f32_16x16x32_bf16 v[52:55], v[128:131], v[180:183], v[52:55]
    ds_read_b128 v[68:71], v20 offset:640
    v_mfma_f32_16x16x32_bf16 v[56:59], v[128:131], v[184:187], v[56:59]
    ds_read_b128 v[100:103], v21 offset:3200
    v_mfma_f32_16x16x32_bf16 v[60:63], v[128:131], v[188:191], v[60:63]
    ds_read_b128 v[72:75], v20 offset:1152
    v_mfma_f32_16x16x32_bf16 v[36:39], v[132:135], v[160:163], v[36:39]
    ds_read_b128 v[104:107], v21 offset:2688
    v_mfma_f32_16x16x32_bf16 v[40:43], v[132:135], v[164:167], v[40:43]
    ds_read_b128 v[76:79], v20 offset:1664
    v_mfma_f32_16x16x32_bf16 v[44:47], v[132:135], v[168:171], v[44:47]
    ds_read_b128 v[108:111], v21 offset:2176
    v_mfma_f32_16x16x32_bf16 v[48:51], v[132:135], v[172:175], v[48:51]
    ds_read_b128 v[80:83], v20 offset:2176
    v_mfma_f32_16x16x32_bf16 v[52:55], v[132:135], v[176:179], v[52:55]
    ds_read_b128 v[112:115], v21 offset:1664
    v_mfma_f32_16x16x32_bf16 v[56:59], v[132:135], v[180:183], v[56:59]
    ds_read_b128 v[84:87], v20 offset:2688
    v_mfma_f32_16x16x32_bf16 v[60:63], v[132:135], v[184:187], v[60:63]
    ds_read_b128 v[116:119], v21 offset:1152
    v_mfma_f32_16x16x32_bf16 v[40:43], v[136:139], v[160:163], v[40:43]
    ds_read_b128 v[88:91], v20 offset:3200
    v_mfma_f32_16x16x32_bf16 v[44:47], v[136:139], v[164:167], v[44:47]
    ds_read_b128 v[120:123], v21 offset:640
    v_mfma_f32_16x16x32_bf16 v[48:51], v[136:139], v[168:171], v[48:51]
    ds_read_b128 v[92:95], v20 offset:3712
    v_mfma_f32_16x16x32_bf16 v[52:55], v[136:139], v[172:175], v[52:55]
    ds_read_b128 v[124:127], v21 offset:128
    v_mfma_f32_16x16x32_bf16 v[56:59], v[136:139], v[176:179], v[56:59]
    v_mfma_f32_16x16x32_bf16 v[60:63], v[136:139], v[180:183], v[60:63]
    buffer_load_dwordx4 a[216:219], v2, s[12:15], s64 offen offset:2048 sc0 sc1
    v_mfma_f32_16x16x32_bf16 v[44:47], v[140:143], v[160:163], v[44:47]
    v_mfma_f32_16x16x32_bf16 v[48:51], v[140:143], v[164:167], v[48:51]
    v_mfma_f32_16x16x32_bf16 v[52:55], v[140:143], v[168:171], v[52:55]
    v_mfma_f32_16x16x32_bf16 v[56:59], v[140:143], v[172:175], v[56:59]
    v_mfma_f32_16x16x32_bf16 v[60:63], v[140:143], v[176:179], v[60:63]
    v_mfma_f32_16x16x32_bf16 v[48:51], v[144:147], v[160:163], v[48:51]
    v_mfma_f32_16x16x32_bf16 v[52:55], v[144:147], v[164:167], v[52:55]
    v_mfma_f32_16x16x32_bf16 v[56:59], v[144:147], v[168:171], v[56:59]
    buffer_load_dwordx4 a[220:223], v2, s[12:15], s64 offen offset:3072 sc0 sc1
    v_mfma_f32_16x16x32_bf16 v[60:63], v[144:147], v[172:175], v[60:63]
    v_mfma_f32_16x16x32_bf16 v[52:55], v[148:151], v[160:163], v[52:55]
    v_mfma_f32_16x16x32_bf16 v[56:59], v[148:151], v[164:167], v[56:59]
    v_mfma_f32_16x16x32_bf16 v[60:63], v[148:151], v[168:171], v[60:63]
    v_mfma_f32_16x16x32_bf16 v[56:59], v[152:155], v[160:163], v[56:59]
    v_mfma_f32_16x16x32_bf16 v[60:63], v[152:155], v[164:167], v[60:63]
    v_mfma_f32_16x16x32_bf16 v[60:63], v[156:159], v[160:163], v[60:63]
    s_waitcnt lgkmcnt(0)
    v_mfma_f32_16x16x32_bf16 v[32:35], v[64:67], v[96:99], v[32:35]
    v_cmp_lt_i32 vcc, 10, v22
    v_mfma_f32_16x16x32_bf16 v[36:39], v[64:67], v[100:103], v[36:39]
    v_add_u32 v24, 3776, v21
    v_mfma_f32_16x16x32_bf16 v[40:43], v[64:67], v[104:107], v[40:43]
    v_cndmask_b32 v24, v23, v24, vcc
    v_mfma_f32_16x16x32_bf16 v[44:47], v[64:67], v[108:111], v[44:47]
    ds_read_b128 v[128:131], v20 offset:192
    v_mfma_f32_16x16x32_bf16 v[48:51], v[64:67], v[112:115], v[48:51]
    ds_read_b128 v[160:163], v24
    v_mfma_f32_16x16x32_bf16 v[52:55], v[64:67], v[116:119], v[52:55]
    ds_read_b128 v[132:135], v20 offset:704
    v_mfma_f32_16x16x32_bf16 v[56:59], v[64:67], v[120:123], v[56:59]
    ds_read_b128 v[164:167], v21 offset:3264
    v_mfma_f32_16x16x32_bf16 v[60:63], v[64:67], v[124:127], v[60:63]
    ds_read_b128 v[136:139], v20 offset:1216
    v_mfma_f32_16x16x32_bf16 v[36:39], v[68:71], v[96:99], v[36:39]
    ds_read_b128 v[168:171], v21 offset:2752
    v_mfma_f32_16x16x32_bf16 v[40:43], v[68:71], v[100:103], v[40:43]
    ds_read_b128 v[140:143], v20 offset:1728
    v_mfma_f32_16x16x32_bf16 v[44:47], v[68:71], v[104:107], v[44:47]
    ds_read_b128 v[172:175], v21 offset:2240
    v_mfma_f32_16x16x32_bf16 v[48:51], v[68:71], v[108:111], v[48:51]
    ds_read_b128 v[144:147], v20 offset:2240
    v_mfma_f32_16x16x32_bf16 v[52:55], v[68:71], v[112:115], v[52:55]
    ds_read_b128 v[176:179], v21 offset:1728
    v_mfma_f32_16x16x32_bf16 v[56:59], v[68:71], v[116:119], v[56:59]
    ds_read_b128 v[148:151], v20 offset:2752
    v_mfma_f32_16x16x32_bf16 v[60:63], v[68:71], v[120:123], v[60:63]
    ds_read_b128 v[180:183], v21 offset:1216
    v_mfma_f32_16x16x32_bf16 v[40:43], v[72:75], v[96:99], v[40:43]
    ds_read_b128 v[152:155], v20 offset:3264
    v_mfma_f32_16x16x32_bf16 v[44:47], v[72:75], v[100:103], v[44:47]
    ds_read_b128 v[184:187], v21 offset:704
    v_mfma_f32_16x16x32_bf16 v[48:51], v[72:75], v[104:107], v[48:51]
    ds_read_b128 v[156:159], v20 offset:3776
    v_mfma_f32_16x16x32_bf16 v[52:55], v[72:75], v[108:111], v[52:55]
    ds_read_b128 v[188:191], v21 offset:192
    v_mfma_f32_16x16x32_bf16 v[56:59], v[72:75], v[112:115], v[56:59]
    v_mfma_f32_16x16x32_bf16 v[60:63], v[72:75], v[116:119], v[60:63]
    buffer_load_dwordx4 a[224:227], v10, s[12:15], s64 offen offset:0 sc0 sc1
    v_mfma_f32_16x16x32_bf16 v[44:47], v[76:79], v[96:99], v[44:47]
    v_mfma_f32_16x16x32_bf16 v[48:51], v[76:79], v[100:103], v[48:51]
    v_mfma_f32_16x16x32_bf16 v[52:55], v[76:79], v[104:107], v[52:55]
    v_mfma_f32_16x16x32_bf16 v[56:59], v[76:79], v[108:111], v[56:59]
    v_mfma_f32_16x16x32_bf16 v[60:63], v[76:79], v[112:115], v[60:63]
    v_mfma_f32_16x16x32_bf16 v[48:51], v[80:83], v[96:99], v[48:51]
    v_mfma_f32_16x16x32_bf16 v[52:55], v[80:83], v[100:103], v[52:55]
    v_mfma_f32_16x16x32_bf16 v[56:59], v[80:83], v[104:107], v[56:59]
    buffer_load_dwordx4 a[228:231], v10, s[12:15], s64 offen offset:1024 sc0 sc1
    v_mfma_f32_16x16x32_bf16 v[60:63], v[80:83], v[108:111], v[60:63]
    v_mfma_f32_16x16x32_bf16 v[52:55], v[84:87], v[96:99], v[52:55]
    v_mfma_f32_16x16x32_bf16 v[56:59], v[84:87], v[100:103], v[56:59]
    v_mfma_f32_16x16x32_bf16 v[60:63], v[84:87], v[104:107], v[60:63]
    v_mfma_f32_16x16x32_bf16 v[56:59], v[88:91], v[96:99], v[56:59]
    v_mfma_f32_16x16x32_bf16 v[60:63], v[88:91], v[100:103], v[60:63]
    v_mfma_f32_16x16x32_bf16 v[60:63], v[92:95], v[96:99], v[60:63]
    s_waitcnt lgkmcnt(0)
    v_mfma_f32_16x16x32_bf16 v[32:35], v[128:131], v[160:163], v[32:35]
    v_cmp_lt_i32 vcc, 14, v22
    v_mfma_f32_16x16x32_bf16 v[36:39], v[128:131], v[164:167], v[36:39]
    v_add_u32 v24, 3840, v21
    v_mfma_f32_16x16x32_bf16 v[40:43], v[128:131], v[168:171], v[40:43]
    v_cndmask_b32 v24, v23, v24, vcc
    v_mfma_f32_16x16x32_bf16 v[44:47], v[128:131], v[172:175], v[44:47]
    ds_read_b128 v[64:67], v20 offset:256
    v_mfma_f32_16x16x32_bf16 v[48:51], v[128:131], v[176:179], v[48:51]
    ds_read_b128 v[96:99], v24
    v_mfma_f32_16x16x32_bf16 v[52:55], v[128:131], v[180:183], v[52:55]
    ds_read_b128 v[68:71], v20 offset:768
    v_mfma_f32_16x16x32_bf16 v[56:59], v[128:131], v[184:187], v[56:59]
    ds_read_b128 v[100:103], v21 offset:3328
    v_mfma_f32_16x16x32_bf16 v[60:63], v[128:131], v[188:191], v[60:63]
    ds_read_b128 v[72:75], v20 offset:1280
    v_mfma_f32_16x16x32_bf16 v[36:39], v[132:135], v[160:163], v[36:39]
    ds_read_b128 v[104:107], v21 offset:2816
    v_mfma_f32_16x16x32_bf16 v[40:43], v[132:135], v[164:167], v[40:43]
    ds_read_b128 v[76:79], v20 offset:1792
    v_mfma_f32_16x16x32_bf16 v[44:47], v[132:135], v[168:171], v[44:47]
    ds_read_b128 v[108:111], v21 offset:2304
    v_mfma_f32_16x16x32_bf16 v[48:51], v[132:135], v[172:175], v[48:51]
    ds_read_b128 v[80:83], v20 offset:2304
    v_mfma_f32_16x16x32_bf16 v[52:55], v[132:135], v[176:179], v[52:55]
    ds_read_b128 v[112:115], v21 offset:1792
    v_mfma_f32_16x16x32_bf16 v[56:59], v[132:135], v[180:183], v[56:59]
    ds_read_b128 v[84:87], v20 offset:2816
    v_mfma_f32_16x16x32_bf16 v[60:63], v[132:135], v[184:187], v[60:63]
    ds_read_b128 v[116:119], v21 offset:1280
    v_mfma_f32_16x16x32_bf16 v[40:43], v[136:139], v[160:163], v[40:43]
    ds_read_b128 v[88:91], v20 offset:3328
    v_mfma_f32_16x16x32_bf16 v[44:47], v[136:139], v[164:167], v[44:47]
    ds_read_b128 v[120:123], v21 offset:768
    v_mfma_f32_16x16x32_bf16 v[48:51], v[136:139], v[168:171], v[48:51]
    ds_read_b128 v[92:95], v20 offset:3840
    v_mfma_f32_16x16x32_bf16 v[52:55], v[136:139], v[172:175], v[52:55]
    ds_read_b128 v[124:127], v21 offset:256
    v_mfma_f32_16x16x32_bf16 v[56:59], v[136:139], v[176:179], v[56:59]
    v_mfma_f32_16x16x32_bf16 v[60:63], v[136:139], v[180:183], v[60:63]
    buffer_load_dwordx4 a[232:235], v10, s[12:15], s64 offen offset:2048 sc0 sc1
    v_mfma_f32_16x16x32_bf16 v[44:47], v[140:143], v[160:163], v[44:47]
    v_mfma_f32_16x16x32_bf16 v[48:51], v[140:143], v[164:167], v[48:51]
    v_mfma_f32_16x16x32_bf16 v[52:55], v[140:143], v[168:171], v[52:55]
    v_mfma_f32_16x16x32_bf16 v[56:59], v[140:143], v[172:175], v[56:59]
    v_mfma_f32_16x16x32_bf16 v[60:63], v[140:143], v[176:179], v[60:63]
    v_mfma_f32_16x16x32_bf16 v[48:51], v[144:147], v[160:163], v[48:51]
    v_mfma_f32_16x16x32_bf16 v[52:55], v[144:147], v[164:167], v[52:55]
    v_mfma_f32_16x16x32_bf16 v[56:59], v[144:147], v[168:171], v[56:59]
    buffer_load_dwordx4 a[236:239], v10, s[12:15], s64 offen offset:3072 sc0 sc1
    v_mfma_f32_16x16x32_bf16 v[60:63], v[144:147], v[172:175], v[60:63]
    v_mfma_f32_16x16x32_bf16 v[52:55], v[148:151], v[160:163], v[52:55]
    v_mfma_f32_16x16x32_bf16 v[56:59], v[148:151], v[164:167], v[56:59]
    v_mfma_f32_16x16x32_bf16 v[60:63], v[148:151], v[168:171], v[60:63]
    v_mfma_f32_16x16x32_bf16 v[56:59], v[152:155], v[160:163], v[56:59]
    v_mfma_f32_16x16x32_bf16 v[60:63], v[152:155], v[164:167], v[60:63]
    v_mfma_f32_16x16x32_bf16 v[60:63], v[156:159], v[160:163], v[60:63]
    s_waitcnt lgkmcnt(0)
    v_mfma_f32_16x16x32_bf16 v[32:35], v[64:67], v[96:99], v[32:35]
    v_cmp_lt_i32 vcc, 18, v22
    v_mfma_f32_16x16x32_bf16 v[36:39], v[64:67], v[100:103], v[36:39]
    v_add_u32 v24, 3904, v21
    v_mfma_f32_16x16x32_bf16 v[40:43], v[64:67], v[104:107], v[40:43]
    v_cndmask_b32 v24, v23, v24, vcc
    v_mfma_f32_16x16x32_bf16 v[44:47], v[64:67], v[108:111], v[44:47]
    ds_read_b128 v[128:131], v20 offset:320
    v_mfma_f32_16x16x32_bf16 v[48:51], v[64:67], v[112:115], v[48:51]
    ds_read_b128 v[160:163], v24
    v_mfma_f32_16x16x32_bf16 v[52:55], v[64:67], v[116:119], v[52:55]
    ds_read_b128 v[132:135], v20 offset:832
    v_mfma_f32_16x16x32_bf16 v[56:59], v[64:67], v[120:123], v[56:59]
    ds_read_b128 v[164:167], v21 offset:3392
    v_mfma_f32_16x16x32_bf16 v[60:63], v[64:67], v[124:127], v[60:63]
    ds_read_b128 v[136:139], v20 offset:1344
    v_mfma_f32_16x16x32_bf16 v[36:39], v[68:71], v[96:99], v[36:39]
    ds_read_b128 v[168:171], v21 offset:2880
    v_mfma_f32_16x16x32_bf16 v[40:43], v[68:71], v[100:103], v[40:43]
    ds_read_b128 v[140:143], v20 offset:1856
    v_mfma_f32_16x16x32_bf16 v[44:47], v[68:71], v[104:107], v[44:47]
    ds_read_b128 v[172:175], v21 offset:2368
    v_mfma_f32_16x16x32_bf16 v[48:51], v[68:71], v[108:111], v[48:51]
    ds_read_b128 v[144:147], v20 offset:2368
    v_mfma_f32_16x16x32_bf16 v[52:55], v[68:71], v[112:115], v[52:55]
    ds_read_b128 v[176:179], v21 offset:1856
    v_mfma_f32_16x16x32_bf16 v[56:59], v[68:71], v[116:119], v[56:59]
    ds_read_b128 v[148:151], v20 offset:2880
    v_mfma_f32_16x16x32_bf16 v[60:63], v[68:71], v[120:123], v[60:63]
    ds_read_b128 v[180:183], v21 offset:1344
    v_mfma_f32_16x16x32_bf16 v[40:43], v[72:75], v[96:99], v[40:43]
    ds_read_b128 v[152:155], v20 offset:3392
    v_mfma_f32_16x16x32_bf16 v[44:47], v[72:75], v[100:103], v[44:47]
    ds_read_b128 v[184:187], v21 offset:832
    v_mfma_f32_16x16x32_bf16 v[48:51], v[72:75], v[104:107], v[48:51]
    ds_read_b128 v[156:159], v20 offset:3904
    v_mfma_f32_16x16x32_bf16 v[52:55], v[72:75], v[108:111], v[52:55]
    ds_read_b128 v[188:191], v21 offset:320
    v_mfma_f32_16x16x32_bf16 v[56:59], v[72:75], v[112:115], v[56:59]
    v_mfma_f32_16x16x32_bf16 v[60:63], v[72:75], v[116:119], v[60:63]
    buffer_load_dwordx4 a[240:243], v11, s[12:15], s64 offen offset:0 sc0 sc1
    v_mfma_f32_16x16x32_bf16 v[44:47], v[76:79], v[96:99], v[44:47]
    v_mfma_f32_16x16x32_bf16 v[48:51], v[76:79], v[100:103], v[48:51]
    v_mfma_f32_16x16x32_bf16 v[52:55], v[76:79], v[104:107], v[52:55]
    v_mfma_f32_16x16x32_bf16 v[56:59], v[76:79], v[108:111], v[56:59]
    v_mfma_f32_16x16x32_bf16 v[60:63], v[76:79], v[112:115], v[60:63]
    v_mfma_f32_16x16x32_bf16 v[48:51], v[80:83], v[96:99], v[48:51]
    v_mfma_f32_16x16x32_bf16 v[52:55], v[80:83], v[100:103], v[52:55]
    v_mfma_f32_16x16x32_bf16 v[56:59], v[80:83], v[104:107], v[56:59]
    buffer_load_dwordx4 a[244:247], v11, s[12:15], s64 offen offset:1024 sc0 sc1
    v_mfma_f32_16x16x32_bf16 v[60:63], v[80:83], v[108:111], v[60:63]
    v_mfma_f32_16x16x32_bf16 v[52:55], v[84:87], v[96:99], v[52:55]
    v_mfma_f32_16x16x32_bf16 v[56:59], v[84:87], v[100:103], v[56:59]
    v_mfma_f32_16x16x32_bf16 v[60:63], v[84:87], v[104:107], v[60:63]
    v_mfma_f32_16x16x32_bf16 v[56:59], v[88:91], v[96:99], v[56:59]
    v_mfma_f32_16x16x32_bf16 v[60:63], v[88:91], v[100:103], v[60:63]
    v_mfma_f32_16x16x32_bf16 v[60:63], v[92:95], v[96:99], v[60:63]
    s_waitcnt lgkmcnt(0)
    v_mfma_f32_16x16x32_bf16 v[32:35], v[128:131], v[160:163], v[32:35]
    v_cmp_lt_i32 vcc, 22, v22
    v_mfma_f32_16x16x32_bf16 v[36:39], v[128:131], v[164:167], v[36:39]
    v_add_u32 v24, 3968, v21
    v_mfma_f32_16x16x32_bf16 v[40:43], v[128:131], v[168:171], v[40:43]
    v_cndmask_b32 v24, v23, v24, vcc
    v_mfma_f32_16x16x32_bf16 v[44:47], v[128:131], v[172:175], v[44:47]
    ds_read_b128 v[64:67], v20 offset:384
    v_mfma_f32_16x16x32_bf16 v[48:51], v[128:131], v[176:179], v[48:51]
    ds_read_b128 v[96:99], v24
    v_mfma_f32_16x16x32_bf16 v[52:55], v[128:131], v[180:183], v[52:55]
    ds_read_b128 v[68:71], v20 offset:896
    v_mfma_f32_16x16x32_bf16 v[56:59], v[128:131], v[184:187], v[56:59]
    ds_read_b128 v[100:103], v21 offset:3456
    v_mfma_f32_16x16x32_bf16 v[60:63], v[128:131], v[188:191], v[60:63]
    ds_read_b128 v[72:75], v20 offset:1408
    v_mfma_f32_16x16x32_bf16 v[36:39], v[132:135], v[160:163], v[36:39]
    ds_read_b128 v[104:107], v21 offset:2944
    v_mfma_f32_16x16x32_bf16 v[40:43], v[132:135], v[164:167], v[40:43]
    ds_read_b128 v[76:79], v20 offset:1920
    v_mfma_f32_16x16x32_bf16 v[44:47], v[132:135], v[168:171], v[44:47]
    ds_read_b128 v[108:111], v21 offset:2432
    v_mfma_f32_16x16x32_bf16 v[48:51], v[132:135], v[172:175], v[48:51]
    ds_read_b128 v[80:83], v20 offset:2432
    v_mfma_f32_16x16x32_bf16 v[52:55], v[132:135], v[176:179], v[52:55]
    ds_read_b128 v[112:115], v21 offset:1920
    v_mfma_f32_16x16x32_bf16 v[56:59], v[132:135], v[180:183], v[56:59]
    ds_read_b128 v[84:87], v20 offset:2944
    v_mfma_f32_16x16x32_bf16 v[60:63], v[132:135], v[184:187], v[60:63]
    ds_read_b128 v[116:119], v21 offset:1408
    v_mfma_f32_16x16x32_bf16 v[40:43], v[136:139], v[160:163], v[40:43]
    ds_read_b128 v[88:91], v20 offset:3456
    v_mfma_f32_16x16x32_bf16 v[44:47], v[136:139], v[164:167], v[44:47]
    ds_read_b128 v[120:123], v21 offset:896
    v_mfma_f32_16x16x32_bf16 v[48:51], v[136:139], v[168:171], v[48:51]
    ds_read_b128 v[92:95], v20 offset:3968
    v_mfma_f32_16x16x32_bf16 v[52:55], v[136:139], v[172:175], v[52:55]
    ds_read_b128 v[124:127], v21 offset:384
    v_mfma_f32_16x16x32_bf16 v[56:59], v[136:139], v[176:179], v[56:59]
    v_mfma_f32_16x16x32_bf16 v[60:63], v[136:139], v[180:183], v[60:63]
    buffer_load_dwordx4 a[248:251], v11, s[12:15], s64 offen offset:2048 sc0 sc1
    v_mfma_f32_16x16x32_bf16 v[44:47], v[140:143], v[160:163], v[44:47]
    v_mfma_f32_16x16x32_bf16 v[48:51], v[140:143], v[164:167], v[48:51]
    v_mfma_f32_16x16x32_bf16 v[52:55], v[140:143], v[168:171], v[52:55]
    v_mfma_f32_16x16x32_bf16 v[56:59], v[140:143], v[172:175], v[56:59]
    v_mfma_f32_16x16x32_bf16 v[60:63], v[140:143], v[176:179], v[60:63]
    v_mfma_f32_16x16x32_bf16 v[48:51], v[144:147], v[160:163], v[48:51]
    v_mfma_f32_16x16x32_bf16 v[52:55], v[144:147], v[164:167], v[52:55]
    v_mfma_f32_16x16x32_bf16 v[56:59], v[144:147], v[168:171], v[56:59]
    buffer_load_dwordx4 a[252:255], v11, s[12:15], s64 offen offset:3072 sc0 sc1
    v_mfma_f32_16x16x32_bf16 v[60:63], v[144:147], v[172:175], v[60:63]
    v_mfma_f32_16x16x32_bf16 v[52:55], v[148:151], v[160:163], v[52:55]
    v_mfma_f32_16x16x32_bf16 v[56:59], v[148:151], v[164:167], v[56:59]
    v_mfma_f32_16x16x32_bf16 v[60:63], v[148:151], v[168:171], v[60:63]
    v_mfma_f32_16x16x32_bf16 v[56:59], v[152:155], v[160:163], v[56:59]
    v_mfma_f32_16x16x32_bf16 v[60:63], v[152:155], v[164:167], v[60:63]
    v_mfma_f32_16x16x32_bf16 v[60:63], v[156:159], v[160:163], v[60:63]
    s_waitcnt lgkmcnt(0)
    v_mfma_f32_16x16x32_bf16 v[32:35], v[64:67], v[96:99], v[32:35]
    v_cmp_lt_i32 vcc, 26, v22
    v_mfma_f32_16x16x32_bf16 v[36:39], v[64:67], v[100:103], v[36:39]
    v_add_u32 v24, 4032, v21
    v_mfma_f32_16x16x32_bf16 v[40:43], v[64:67], v[104:107], v[40:43]
    v_cndmask_b32 v24, v23, v24, vcc
    v_mfma_f32_16x16x32_bf16 v[44:47], v[64:67], v[108:111], v[44:47]
    ds_read_b128 v[128:131], v20 offset:448
    v_mfma_f32_16x16x32_bf16 v[48:51], v[64:67], v[112:115], v[48:51]
    ds_read_b128 v[160:163], v24
    v_mfma_f32_16x16x32_bf16 v[52:55], v[64:67], v[116:119], v[52:55]
    ds_read_b128 v[132:135], v20 offset:960
    v_mfma_f32_16x16x32_bf16 v[56:59], v[64:67], v[120:123], v[56:59]
    ds_read_b128 v[164:167], v21 offset:3520
    v_mfma_f32_16x16x32_bf16 v[60:63], v[64:67], v[124:127], v[60:63]
    ds_read_b128 v[136:139], v20 offset:1472
    v_mfma_f32_16x16x32_bf16 v[36:39], v[68:71], v[96:99], v[36:39]
    ds_read_b128 v[168:171], v21 offset:3008
    v_mfma_f32_16x16x32_bf16 v[40:43], v[68:71], v[100:103], v[40:43]
    ds_read_b128 v[140:143], v20 offset:1984
    v_mfma_f32_16x16x32_bf16 v[44:47], v[68:71], v[104:107], v[44:47]
    ds_read_b128 v[172:175], v21 offset:2496
    v_mfma_f32_16x16x32_bf16 v[48:51], v[68:71], v[108:111], v[48:51]
    ds_read_b128 v[144:147], v20 offset:2496
    v_mfma_f32_16x16x32_bf16 v[52:55], v[68:71], v[112:115], v[52:55]
    ds_read_b128 v[176:179], v21 offset:1984
    v_mfma_f32_16x16x32_bf16 v[56:59], v[68:71], v[116:119], v[56:59]
    ds_read_b128 v[148:151], v20 offset:3008
    v_mfma_f32_16x16x32_bf16 v[60:63], v[68:71], v[120:123], v[60:63]
    ds_read_b128 v[180:183], v21 offset:1472
    v_mfma_f32_16x16x32_bf16 v[40:43], v[72:75], v[96:99], v[40:43]
    ds_read_b128 v[152:155], v20 offset:3520
    v_mfma_f32_16x16x32_bf16 v[44:47], v[72:75], v[100:103], v[44:47]
    ds_read_b128 v[184:187], v21 offset:960
    v_mfma_f32_16x16x32_bf16 v[48:51], v[72:75], v[104:107], v[48:51]
    ds_read_b128 v[156:159], v20 offset:4032
    v_mfma_f32_16x16x32_bf16 v[52:55], v[72:75], v[108:111], v[52:55]
    ds_read_b128 v[188:191], v21 offset:448
    v_mfma_f32_16x16x32_bf16 v[56:59], v[72:75], v[112:115], v[56:59]
    v_mfma_f32_16x16x32_bf16 v[60:63], v[72:75], v[116:119], v[60:63]
    buffer_load_dwordx4 v[192:195], v12, s[12:15], s64 offen offset:0 sc0 sc1
    v_mfma_f32_16x16x32_bf16 v[44:47], v[76:79], v[96:99], v[44:47]
    v_mfma_f32_16x16x32_bf16 v[48:51], v[76:79], v[100:103], v[48:51]
    v_mfma_f32_16x16x32_bf16 v[52:55], v[76:79], v[104:107], v[52:55]
    v_mfma_f32_16x16x32_bf16 v[56:59], v[76:79], v[108:111], v[56:59]
    v_mfma_f32_16x16x32_bf16 v[60:63], v[76:79], v[112:115], v[60:63]
    v_mfma_f32_16x16x32_bf16 v[48:51], v[80:83], v[96:99], v[48:51]
    v_mfma_f32_16x16x32_bf16 v[52:55], v[80:83], v[100:103], v[52:55]
    v_mfma_f32_16x16x32_bf16 v[56:59], v[80:83], v[104:107], v[56:59]
    buffer_load_dwordx4 v[196:199], v12, s[12:15], s64 offen offset:1024 sc0 sc1
    v_mfma_f32_16x16x32_bf16 v[60:63], v[80:83], v[108:111], v[60:63]
    v_mfma_f32_16x16x32_bf16 v[52:55], v[84:87], v[96:99], v[52:55]
    v_mfma_f32_16x16x32_bf16 v[56:59], v[84:87], v[100:103], v[56:59]
    v_mfma_f32_16x16x32_bf16 v[60:63], v[84:87], v[104:107], v[60:63]
    v_mfma_f32_16x16x32_bf16 v[56:59], v[88:91], v[96:99], v[56:59]
    v_mfma_f32_16x16x32_bf16 v[60:63], v[88:91], v[100:103], v[60:63]
    v_mfma_f32_16x16x32_bf16 v[60:63], v[92:95], v[96:99], v[60:63]
    s_waitcnt lgkmcnt(0)
    v_mfma_f32_16x16x32_bf16 v[32:35], v[128:131], v[160:163], v[32:35]
    v_mfma_f32_16x16x32_bf16 v[36:39], v[128:131], v[164:167], v[36:39]
    v_mfma_f32_16x16x32_bf16 v[40:43], v[128:131], v[168:171], v[40:43]
    v_mfma_f32_16x16x32_bf16 v[44:47], v[128:131], v[172:175], v[44:47]
    v_mfma_f32_16x16x32_bf16 v[48:51], v[128:131], v[176:179], v[48:51]
    v_mfma_f32_16x16x32_bf16 v[52:55], v[128:131], v[180:183], v[52:55]
    v_mfma_f32_16x16x32_bf16 v[56:59], v[128:131], v[184:187], v[56:59]
    v_mfma_f32_16x16x32_bf16 v[60:63], v[128:131], v[188:191], v[60:63]
    v_mfma_f32_16x16x32_bf16 v[36:39], v[132:135], v[160:163], v[36:39]
    v_mfma_f32_16x16x32_bf16 v[40:43], v[132:135], v[164:167], v[40:43]
    v_mfma_f32_16x16x32_bf16 v[44:47], v[132:135], v[168:171], v[44:47]
    v_mfma_f32_16x16x32_bf16 v[48:51], v[132:135], v[172:175], v[48:51]
    v_mfma_f32_16x16x32_bf16 v[52:55], v[132:135], v[176:179], v[52:55]
    v_mfma_f32_16x16x32_bf16 v[56:59], v[132:135], v[180:183], v[56:59]
    v_mfma_f32_16x16x32_bf16 v[60:63], v[132:135], v[184:187], v[60:63]
    v_mfma_f32_16x16x32_bf16 v[40:43], v[136:139], v[160:163], v[40:43]
    v_mfma_f32_16x16x32_bf16 v[44:47], v[136:139], v[164:167], v[44:47]
    v_mfma_f32_16x16x32_bf16 v[48:51], v[136:139], v[168:171], v[48:51]
    v_mfma_f32_16x16x32_bf16 v[52:55], v[136:139], v[172:175], v[52:55]
    v_mfma_f32_16x16x32_bf16 v[56:59], v[136:139], v[176:179], v[56:59]
    v_mfma_f32_16x16x32_bf16 v[60:63], v[136:139], v[180:183], v[60:63]
    buffer_load_dwordx4 v[200:203], v12, s[12:15], s64 offen offset:2048 sc0 sc1
    v_mfma_f32_16x16x32_bf16 v[44:47], v[140:143], v[160:163], v[44:47]
    v_mfma_f32_16x16x32_bf16 v[48:51], v[140:143], v[164:167], v[48:51]
    v_mfma_f32_16x16x32_bf16 v[52:55], v[140:143], v[168:171], v[52:55]
    v_mfma_f32_16x16x32_bf16 v[56:59], v[140:143], v[172:175], v[56:59]
    v_mfma_f32_16x16x32_bf16 v[60:63], v[140:143], v[176:179], v[60:63]
    v_mfma_f32_16x16x32_bf16 v[48:51], v[144:147], v[160:163], v[48:51]
    v_mfma_f32_16x16x32_bf16 v[52:55], v[144:147], v[164:167], v[52:55]
    v_mfma_f32_16x16x32_bf16 v[56:59], v[144:147], v[168:171], v[56:59]
    buffer_load_dwordx4 v[204:207], v12, s[12:15], s64 offen offset:3072 sc0 sc1
    v_mfma_f32_16x16x32_bf16 v[60:63], v[144:147], v[172:175], v[60:63]
    v_mfma_f32_16x16x32_bf16 v[52:55], v[148:151], v[160:163], v[52:55]
    v_mfma_f32_16x16x32_bf16 v[56:59], v[148:151], v[164:167], v[56:59]
    v_mfma_f32_16x16x32_bf16 v[60:63], v[148:151], v[168:171], v[60:63]
    v_mfma_f32_16x16x32_bf16 v[56:59], v[152:155], v[160:163], v[56:59]
    v_mfma_f32_16x16x32_bf16 v[60:63], v[152:155], v[164:167], v[60:63]
    v_mfma_f32_16x16x32_bf16 v[60:63], v[156:159], v[160:163], v[60:63]
    v_lshlrev_b32 v19, 3, v18
    v_lshl_add_u32 v19, v17, 5, v19
    v_add_u32 v19, s34, v19
    s_nop 5
    v_cvt_pk_bf16_f32 v32, v32, v33
    v_cvt_pk_bf16_f32 v33, v34, v35
    ds_write_b64 v19, v[32:33] offset:8192
    v_cvt_pk_bf16_f32 v36, v36, v37
    v_cvt_pk_bf16_f32 v37, v38, v39
    ds_write_b64 v19, v[36:37] offset:8704
    v_cvt_pk_bf16_f32 v40, v40, v41
    v_cvt_pk_bf16_f32 v41, v42, v43
    ds_write_b64 v19, v[40:41] offset:9216
    v_cvt_pk_bf16_f32 v44, v44, v45
    v_cvt_pk_bf16_f32 v45, v46, v47
    ds_write_b64 v19, v[44:45] offset:9728
    v_cvt_pk_bf16_f32 v48, v48, v49
    v_cvt_pk_bf16_f32 v49, v50, v51
    ds_write_b64 v19, v[48:49] offset:10240
    v_cvt_pk_bf16_f32 v52, v52, v53
    v_cvt_pk_bf16_f32 v53, v54, v55
    ds_write_b64 v19, v[52:53] offset:10752
    v_cvt_pk_bf16_f32 v56, v56, v57
    v_cvt_pk_bf16_f32 v57, v58, v59
    ds_write_b64 v19, v[56:57] offset:11264
    v_cvt_pk_bf16_f32 v60, v60, v61
    v_cvt_pk_bf16_f32 v61, v62, v63
    ds_write_b64 v19, v[60:61] offset:11776
    v_bfe_u32 v19, v1, 2, 2
    v_mul_u32_u24 v19, 36864, v19
    v_lshl_add_u32 v19, v18, 5, v19
    v_and_b32 v20, 3, v1
    v_lshl_add_u32 v19, v20, 3, v19
    s_lshl_b32 s29, s22, 10
    v_add_u32 v19, s29, v19
    v_lshlrev_b32 v20, 3, v1
    s_lshl_b32 s29, s48, 14
    s_lshl_b32 s30, s22, 12
    s_add_u32 s29, s29, s30
    s_add_u32 s29, s29, 1048576
    s_waitcnt lgkmcnt(0)
    s_barrier
    ds_read_b64_tr_b16 v[64:65], v19 offset:8192
    ds_read_b64_tr_b16 v[66:67], v19 offset:8320
    ds_read_b64_tr_b16 v[68:69], v19 offset:8448
    ds_read_b64_tr_b16 v[70:71], v19 offset:8576
    ds_read_b64_tr_b16 v[72:73], v19 offset:8704
    ds_read_b64_tr_b16 v[74:75], v19 offset:8832
    ds_read_b64_tr_b16 v[76:77], v19 offset:8960
    ds_read_b64_tr_b16 v[78:79], v19 offset:9088
    s_waitcnt lgkmcnt(7)
    v_min_u32 v64, -2, v64
    v_min_u32 v65, -2, v65
    buffer_store_dwordx2 v[64:65], v20, s[16:19], s29 offen offset:0 sc0 sc1
    s_waitcnt lgkmcnt(6)
    v_min_u32 v66, -2, v66
    v_min_u32 v67, -2, v67
    buffer_store_dwordx2 v[66:67], v20, s[16:19], s29 offen offset:512 sc0 sc1
    s_waitcnt lgkmcnt(5)
    v_min_u32 v68, -2, v68
    v_min_u32 v69, -2, v69
    buffer_store_dwordx2 v[68:69], v20, s[16:19], s29 offen offset:1024 sc0 sc1
    s_waitcnt lgkmcnt(4)
    v_min_u32 v70, -2, v70
    v_min_u32 v71, -2, v71
    buffer_store_dwordx2 v[70:71], v20, s[16:19], s29 offen offset:1536 sc0 sc1
    s_waitcnt lgkmcnt(3)
    v_min_u32 v72, -2, v72
    v_min_u32 v73, -2, v73
    buffer_store_dwordx2 v[72:73], v20, s[16:19], s29 offen offset:2048 sc0 sc1
    s_waitcnt lgkmcnt(2)
    v_min_u32 v74, -2, v74
    v_min_u32 v75, -2, v75
    buffer_store_dwordx2 v[74:75], v20, s[16:19], s29 offen offset:2560 sc0 sc1
    s_waitcnt lgkmcnt(1)
    v_min_u32 v76, -2, v76
    v_min_u32 v77, -2, v77
    buffer_store_dwordx2 v[76:77], v20, s[16:19], s29 offen offset:3072 sc0 sc1
    s_waitcnt lgkmcnt(0)
    v_min_u32 v78, -2, v78
    v_min_u32 v79, -2, v79
    buffer_store_dwordx2 v[78:79], v20, s[16:19], s29 offen offset:3584 sc0 sc1
    v_lshrrev_b32 v6, 4, v1
    v_lshlrev_b32 v6, 4, v6
    s_lshl_b32 s30, s50, 7
    buffer_load_dwordx4 v[64:67], v6, s[36:39], s30 offen offset:0
    buffer_load_dwordx4 v[68:71], v6, s[36:39], s30 offen offset:64
    s_add_u32 s30, s30, 128
    s_cmp_eq_u32 s30, 1152
    s_cselect_b32 s30, 0, s30
    buffer_load_dwordx4 v[72:75], v6, s[36:39], s30 offen offset:0
    buffer_load_dwordx4 v[76:79], v6, s[36:39], s30 offen offset:64
    s_add_u32 s30, s30, 128
    s_cmp_eq_u32 s30, 1152
    s_cselect_b32 s30, 0, s30
    buffer_load_dwordx4 v[80:83], v6, s[36:39], s30 offen offset:0
    buffer_load_dwordx4 v[84:87], v6, s[36:39], s30 offen offset:64
    s_add_u32 s30, s30, 128
    s_cmp_eq_u32 s30, 1152
    s_cselect_b32 s30, 0, s30
    buffer_load_dwordx4 v[88:91], v6, s[36:39], s30 offen offset:0
    buffer_load_dwordx4 v[92:95], v6, s[36:39], s30 offen offset:64
    s_add_u32 s30, s30, 128
    s_cmp_eq_u32 s30, 1152
    s_cselect_b32 s30, 0, s30
    buffer_load_dwordx4 v[96:99], v6, s[36:39], s30 offen offset:0
    buffer_load_dwordx4 v[100:103], v6, s[36:39], s30 offen offset:64
    s_add_u32 s30, s30, 128
    s_cmp_eq_u32 s30, 1152
    s_cselect_b32 s30, 0, s30
    buffer_load_dwordx4 v[104:107], v6, s[36:39], s30 offen offset:0
    buffer_load_dwordx4 v[108:111], v6, s[36:39], s30 offen offset:64
    s_add_u32 s30, s30, 128
    s_cmp_eq_u32 s30, 1152
    s_cselect_b32 s30, 0, s30
    buffer_load_dwordx4 v[112:115], v6, s[36:39], s30 offen offset:0
    buffer_load_dwordx4 v[116:119], v6, s[36:39], s30 offen offset:64
    s_add_u32 s30, s30, 128
    s_cmp_eq_u32 s30, 1152
    s_cselect_b32 s30, 0, s30
    buffer_load_dwordx4 v[120:123], v6, s[36:39], s30 offen offset:0
    buffer_load_dwordx4 v[124:127], v6, s[36:39], s30 offen offset:64
    s_add_u32 s30, s30, 128
    s_cmp_eq_u32 s30, 1152
    s_cselect_b32 s30, 0, s30
    buffer_load_dwordx4 v[128:131], v6, s[36:39], s30 offen offset:0
    buffer_load_dwordx4 v[132:135], v6, s[36:39], s30 offen offset:64
    buffer_load_dwordx2 v[160:161], v8, s[16:19], s62 offen sc0 sc1
    buffer_load_dwordx2 v[162:163], v9, s[16:19], s62 offen sc0 sc1
    buffer_load_dwordx2 v[164:165], v8, s[16:19], s66 offen sc0 sc1
    buffer_load_dwordx2 v[166:167], v9, s[16:19], s66 offen sc0 sc1
    s_waitcnt vmcnt(30)
    v_lshlrev_b32 v56, 16, v216
    v_and_b32 v57, 0xffff0000, v216
    v_lshlrev_b32 v58, 16, v220
    v_and_b32 v59, 0xffff0000, v220
    v_pk_mul_f32 v[56:57], v[56:57], v[58:59]
    v_cvt_pk_bf16_f32 v60, v56, v57
    v_lshlrev_b32 v56, 16, v217
    v_and_b32 v57, 0xffff0000, v217
    v_lshlrev_b32 v58, 16, v221
    v_and_b32 v59, 0xffff0000, v221
    v_pk_mul_f32 v[56:57], v[56:57], v[58:59]
    v_cvt_pk_bf16_f32 v61, v56, v57
    v_lshlrev_b32 v56, 16, v218
    v_and_b32 v57, 0xffff0000, v218
    v_lshlrev_b32 v58, 16, v222
    v_and_b32 v59, 0xffff0000, v222
    v_pk_mul_f32 v[56:57], v[56:57], v[58:59]
    v_cvt_pk_bf16_f32 v62, v56, v57
    v_lshlrev_b32 v56, 16, v219
    v_and_b32 v57, 0xffff0000, v219
    v_lshlrev_b32 v58, 16, v223
    v_and_b32 v59, 0xffff0000, v223
    v_pk_mul_f32 v[56:57], v[56:57], v[58:59]
    v_cvt_pk_bf16_f32 v63, v56, v57
    v_lshlrev_b32 v216, 16, v60
    v_and_b32 v217, 0xffff0000, v60
    v_lshlrev_b32 v218, 16, v61
    v_and_b32 v219, 0xffff0000, v61
    v_lshlrev_b32 v220, 16, v62
    v_and_b32 v221, 0xffff0000, v62
    v_lshlrev_b32 v222, 16, v63
    v_and_b32 v223, 0xffff0000, v63
    v_lshlrev_b32 v56, 16, v224
    v_and_b32 v57, 0xffff0000, v224
    v_lshlrev_b32 v58, 16, v228
    v_and_b32 v59, 0xffff0000, v228
    v_pk_mul_f32 v[56:57], v[56:57], v[58:59]
    v_cvt_pk_bf16_f32 v60, v56, v57
    v_lshlrev_b32 v56, 16, v225
    v_and_b32 v57, 0xffff0000, v225
    v_lshlrev_b32 v58, 16, v229
    v_and_b32 v59, 0xffff0000, v229
    v_pk_mul_f32 v[56:57], v[56:57], v[58:59]
    v_cvt_pk_bf16_f32 v61, v56, v57
    v_lshlrev_b32 v56, 16, v226
    v_and_b32 v57, 0xffff0000, v226
    v_lshlrev_b32 v58, 16, v230
    v_and_b32 v59, 0xffff0000, v230
    v_pk_mul_f32 v[56:57], v[56:57], v[58:59]
    v_cvt_pk_bf16_f32 v62, v56, v57
    v_lshlrev_b32 v56, 16, v227
    v_and_b32 v57, 0xffff0000, v227
    v_lshlrev_b32 v58, 16, v231
    v_and_b32 v59, 0xffff0000, v231
    v_pk_mul_f32 v[56:57], v[56:57], v[58:59]
    v_cvt_pk_bf16_f32 v63, v56, v57
    v_lshlrev_b32 v224, 16, v60
    v_and_b32 v225, 0xffff0000, v60
    v_lshlrev_b32 v226, 16, v61
    v_and_b32 v227, 0xffff0000, v61
    v_lshlrev_b32 v228, 16, v62
    v_and_b32 v229, 0xffff0000, v62
    v_lshlrev_b32 v230, 16, v63
    v_and_b32 v231, 0xffff0000, v63
    v_mfma_f32_16x16x32_bf16 v[32:35], v[208:211], a[144:147], 0
    v_mfma_f32_16x16x32_bf16 v[36:39], v[212:215], a[144:147], 0
    v_mfma_f32_16x16x32_bf16 v[32:35], v[208:211], a[148:151], v[32:35]
    v_mfma_f32_16x16x32_bf16 v[36:39], v[212:215], a[148:151], v[36:39]
    v_mfma_f32_16x16x32_bf16 v[32:35], v[208:211], a[152:155], v[32:35]
    v_mfma_f32_16x16x32_bf16 v[36:39], v[212:215], a[152:155], v[36:39]
    v_mfma_f32_16x16x32_bf16 v[32:35], v[208:211], a[156:159], v[32:35]
    v_mfma_f32_16x16x32_bf16 v[36:39], v[212:215], a[156:159], v[36:39]
    v_mfma_f32_16x16x32_bf16 v[32:35], v[208:211], a[160:163], v[32:35]
    v_mfma_f32_16x16x32_bf16 v[36:39], v[212:215], a[160:163], v[36:39]
    v_mfma_f32_16x16x32_bf16 v[32:35], v[208:211], a[164:167], v[32:35]
    v_mfma_f32_16x16x32_bf16 v[36:39], v[212:215], a[164:167], v[36:39]
    v_mfma_f32_16x16x32_bf16 v[32:35], v[208:211], a[168:171], v[32:35]
    v_mfma_f32_16x16x32_bf16 v[36:39], v[212:215], a[168:171], v[36:39]
    v_mfma_f32_16x16x32_bf16 v[32:35], v[208:211], a[172:175], v[32:35]
    v_mfma_f32_16x16x32_bf16 v[36:39], v[212:215], a[172:175], v[36:39]
    v_mfma_f32_16x16x32_bf16 v[32:35], v[208:211], a[176:179], v[32:35]
    v_mfma_f32_16x16x32_bf16 v[36:39], v[212:215], a[176:179], v[36:39]
    v_mfma_f32_16x16x32_bf16 v[32:35], v[208:211], a[180:183], v[32:35]
    v_mfma_f32_16x16x32_bf16 v[36:39], v[212:215], a[180:183], v[36:39]
    v_mfma_f32_16x16x32_bf16 v[32:35], v[208:211], a[184:187], v[32:35]
    v_mfma_f32_16x16x32_bf16 v[36:39], v[212:215], a[184:187], v[36:39]
    v_mfma_f32_16x16x32_bf16 v[32:35], v[208:211], a[188:191], v[32:35]
    v_mfma_f32_16x16x32_bf16 v[36:39], v[212:215], a[188:191], v[36:39]
    v_mfma_f32_16x16x32_bf16 v[32:35], v[208:211], a[192:195], v[32:35]
    v_mfma_f32_16x16x32_bf16 v[36:39], v[212:215], a[192:195], v[36:39]
    v_mfma_f32_16x16x32_bf16 v[32:35], v[208:211], a[196:199], v[32:35]
    v_mfma_f32_16x16x32_bf16 v[36:39], v[212:215], a[196:199], v[36:39]
    v_mfma_f32_16x16x32_bf16 v[32:35], v[208:211], a[200:203], v[32:35]
    v_mfma_f32_16x16x32_bf16 v[36:39], v[212:215], a[200:203], v[36:39]
    v_mfma_f32_16x16x32_bf16 v[32:35], v[208:211], a[204:207], v[32:35]
    v_mfma_f32_16x16x32_bf16 v[36:39], v[212:215], a[204:207], v[36:39]
    v_mfma_f32_16x16x32_bf16 v[40:43], v[208:211], a[208:211], 0
    v_mfma_f32_16x16x32_bf16 v[44:47], v[212:215], a[208:211], 0
    v_mfma_f32_16x16x32_bf16 v[40:43], v[208:211], a[212:215], v[40:43]
    v_mfma_f32_16x16x32_bf16 v[44:47], v[212:215], a[212:215], v[44:47]
    v_mfma_f32_16x16x32_bf16 v[40:43], v[208:211], a[216:219], v[40:43]
    v_mfma_f32_16x16x32_bf16 v[44:47], v[212:215], a[216:219], v[44:47]
    v_mfma_f32_16x16x32_bf16 v[40:43], v[208:211], a[220:223], v[40:43]
    v_mfma_f32_16x16x32_bf16 v[44:47], v[212:215], a[220:223], v[44:47]
    v_mfma_f32_16x16x32_bf16 v[40:43], v[208:211], a[224:227], v[40:43]
    v_mfma_f32_16x16x32_bf16 v[44:47], v[212:215], a[224:227], v[44:47]
    v_mfma_f32_16x16x32_bf16 v[40:43], v[208:211], a[228:231], v[40:43]
    v_mfma_f32_16x16x32_bf16 v[44:47], v[212:215], a[228:231], v[44:47]
    v_mfma_f32_16x16x32_bf16 v[40:43], v[208:211], a[232:235], v[40:43]
    v_mfma_f32_16x16x32_bf16 v[44:47], v[212:215], a[232:235], v[44:47]
    v_mfma_f32_16x16x32_bf16 v[40:43], v[208:211], a[236:239], v[40:43]
    v_mfma_f32_16x16x32_bf16 v[44:47], v[212:215], a[236:239], v[44:47]
    v_mfma_f32_16x16x32_bf16 v[40:43], v[208:211], a[240:243], v[40:43]
    v_mfma_f32_16x16x32_bf16 v[44:47], v[212:215], a[240:243], v[44:47]
    v_mfma_f32_16x16x32_bf16 v[40:43], v[208:211], a[244:247], v[40:43]
    v_mfma_f32_16x16x32_bf16 v[44:47], v[212:215], a[244:247], v[44:47]
    v_mfma_f32_16x16x32_bf16 v[40:43], v[208:211], a[248:251], v[40:43]
    v_mfma_f32_16x16x32_bf16 v[44:47], v[212:215], a[248:251], v[44:47]
    v_mfma_f32_16x16x32_bf16 v[40:43], v[208:211], a[252:255], v[40:43]
    v_mfma_f32_16x16x32_bf16 v[44:47], v[212:215], a[252:255], v[44:47]
    v_mfma_f32_16x16x32_bf16 v[40:43], v[208:211], v[192:195], v[40:43]
    v_mfma_f32_16x16x32_bf16 v[44:47], v[212:215], v[192:195], v[44:47]
    v_mfma_f32_16x16x32_bf16 v[40:43], v[208:211], v[196:199], v[40:43]
    v_mfma_f32_16x16x32_bf16 v[44:47], v[212:215], v[196:199], v[44:47]
    v_mfma_f32_16x16x32_bf16 v[40:43], v[208:211], v[200:203], v[40:43]
    v_mfma_f32_16x16x32_bf16 v[44:47], v[212:215], v[200:203], v[44:47]
    v_mfma_f32_16x16x32_bf16 v[40:43], v[208:211], v[204:207], v[40:43]
    v_mfma_f32_16x16x32_bf16 v[44:47], v[212:215], v[204:207], v[44:47]
    s_waitcnt vmcnt(4)
    v_mfma_f32_16x16x32_bf16 v[16:19], v[64:67], a[0:3], 0
    v_mfma_f32_16x16x32_bf16 v[20:23], v[64:67], a[4:7], 0
    v_mfma_f32_16x16x32_bf16 v[16:19], v[68:71], a[8:11], v[16:19]
    v_mfma_f32_16x16x32_bf16 v[20:23], v[68:71], a[12:15], v[20:23]
    v_mfma_f32_16x16x32_bf16 v[16:19], v[72:75], a[16:19], v[16:19]
    v_mfma_f32_16x16x32_bf16 v[20:23], v[72:75], a[20:23], v[20:23]
    v_mfma_f32_16x16x32_bf16 v[16:19], v[76:79], a[24:27], v[16:19]
    v_mfma_f32_16x16x32_bf16 v[20:23], v[76:79], a[28:31], v[20:23]
    v_mfma_f32_16x16x32_bf16 v[16:19], v[80:83], a[32:35], v[16:19]
    v_mfma_f32_16x16x32_bf16 v[20:23], v[80:83], a[36:39], v[20:23]
    v_mfma_f32_16x16x32_bf16 v[16:19], v[84:87], a[40:43], v[16:19]
    v_mfma_f32_16x16x32_bf16 v[20:23], v[84:87], a[44:47], v[20:23]
    v_mfma_f32_16x16x32_bf16 v[16:19], v[88:91], a[48:51], v[16:19]
    v_mfma_f32_16x16x32_bf16 v[20:23], v[88:91], a[52:55], v[20:23]
    v_mfma_f32_16x16x32_bf16 v[16:19], v[92:95], a[56:59], v[16:19]
    v_mfma_f32_16x16x32_bf16 v[20:23], v[92:95], a[60:63], v[20:23]
    v_mfma_f32_16x16x32_bf16 v[16:19], v[96:99], a[64:67], v[16:19]
    v_mfma_f32_16x16x32_bf16 v[20:23], v[96:99], a[68:71], v[20:23]
    v_mfma_f32_16x16x32_bf16 v[16:19], v[100:103], a[72:75], v[16:19]
    v_mfma_f32_16x16x32_bf16 v[20:23], v[100:103], a[76:79], v[20:23]
    v_mfma_f32_16x16x32_bf16 v[16:19], v[104:107], a[80:83], v[16:19]
    v_mfma_f32_16x16x32_bf16 v[20:23], v[104:107], a[84:87], v[20:23]
    v_mfma_f32_16x16x32_bf16 v[16:19], v[108:111], a[88:91], v[16:19]
    v_mfma_f32_16x16x32_bf16 v[20:23], v[108:111], a[92:95], v[20:23]
    v_mfma_f32_16x16x32_bf16 v[16:19], v[112:115], a[96:99], v[16:19]
    v_mfma_f32_16x16x32_bf16 v[20:23], v[112:115], a[100:103], v[20:23]
    v_mfma_f32_16x16x32_bf16 v[16:19], v[116:119], a[104:107], v[16:19]
    v_mfma_f32_16x16x32_bf16 v[20:23], v[116:119], a[108:111], v[20:23]
    v_mfma_f32_16x16x32_bf16 v[16:19], v[120:123], a[112:115], v[16:19]
    v_mfma_f32_16x16x32_bf16 v[20:23], v[120:123], a[116:119], v[20:23]
    v_mfma_f32_16x16x32_bf16 v[16:19], v[124:127], a[120:123], v[16:19]
    v_mfma_f32_16x16x32_bf16 v[20:23], v[124:127], a[124:127], v[20:23]
    v_mfma_f32_16x16x32_bf16 v[16:19], v[128:131], a[128:131], v[16:19]
    v_mfma_f32_16x16x32_bf16 v[20:23], v[128:131], a[132:135], v[20:23]
    v_mfma_f32_16x16x32_bf16 v[16:19], v[132:135], a[136:139], v[16:19]
    v_mfma_f32_16x16x32_bf16 v[20:23], v[132:135], a[140:143], v[20:23]
    s_nop 7
    v_cvt_pk_bf16_f32 v16, v16, v16
    v_lshlrev_b32 v16, 16, v16
    v_mul_f32 v16, 0xbfb8aa3b, v16
    v_exp_f32 v16, v16
    s_nop 0
    v_add_f32 v16, 1.0, v16
    v_rcp_f32 v16, v16
    s_nop 0
    v_cvt_pk_bf16_f32 v16, v16, v16
    v_lshlrev_b32 v16, 16, v16
    v_sub_f32 v17, 1.0, v16
    v_cvt_pk_bf16_f32 v17, v17, v17
    v_lshlrev_b32 v17, 16, v17
    v_cvt_pk_bf16_f32 v20, v20, v20
    v_lshlrev_b32 v20, 16, v20
    v_mul_f32 v20, 0xbfb8aa3b, v20
    v_exp_f32 v20, v20
    s_nop 0
    v_add_f32 v20, 1.0, v20
    v_rcp_f32 v20, v20
    s_nop 0
    v_cvt_pk_bf16_f32 v20, v20, v20
    v_lshlrev_b32 v20, 16, v20
    v_sub_f32 v21, 1.0, v20
    v_cvt_pk_bf16_f32 v21, v21, v21
    v_lshlrev_b32 v21, 16, v21
    s_cmp_eq_u32 s63, 0
    s_cselect_b64 vcc, -1, 0
    v_cndmask_b32 v48, v20, v16, vcc
    v_cndmask_b32 v63, v21, v17, vcc
    v_mov_b32 v49, v48
    v_cvt_pk_bf16_f32 v60, v32, v33
    v_lshlrev_b32 v56, 16, v60
    v_and_b32 v57, 0xffff0000, v60
    v_mul_f32 v56, v63, v56
    v_mul_f32 v57, v63, v57
    v_cvt_pk_bf16_f32 v60, v56, v57
    v_lshlrev_b32 v32, 16, v60
    v_and_b32 v33, 0xffff0000, v60
    v_cvt_pk_bf16_f32 v60, v34, v35
    v_lshlrev_b32 v56, 16, v60
    v_and_b32 v57, 0xffff0000, v60
    v_mul_f32 v56, v63, v56
    v_mul_f32 v57, v63, v57
    v_cvt_pk_bf16_f32 v60, v56, v57
    v_lshlrev_b32 v34, 16, v60
    v_and_b32 v35, 0xffff0000, v60
    v_cvt_pk_bf16_f32 v60, v36, v37
    v_lshlrev_b32 v56, 16, v60
    v_and_b32 v57, 0xffff0000, v60
    v_mul_f32 v56, v63, v56
    v_mul_f32 v57, v63, v57
    v_cvt_pk_bf16_f32 v60, v56, v57
    v_lshlrev_b32 v36, 16, v60
    v_and_b32 v37, 0xffff0000, v60
    v_cvt_pk_bf16_f32 v60, v38, v39
    v_lshlrev_b32 v56, 16, v60
    v_and_b32 v57, 0xffff0000, v60
    v_mul_f32 v56, v63, v56
    v_mul_f32 v57, v63, v57
    v_cvt_pk_bf16_f32 v60, v56, v57
    v_lshlrev_b32 v38, 16, v60
    v_and_b32 v39, 0xffff0000, v60
    s_cmp_eq_u32 s67, 0
    s_cselect_b64 vcc, -1, 0
    v_cndmask_b32 v50, v20, v16, vcc
    v_cndmask_b32 v63, v21, v17, vcc
    v_mov_b32 v51, v50
    v_cvt_pk_bf16_f32 v60, v40, v41
    v_lshlrev_b32 v56, 16, v60
    v_and_b32 v57, 0xffff0000, v60
    v_mul_f32 v56, v63, v56
    v_mul_f32 v57, v63, v57
    v_cvt_pk_bf16_f32 v60, v56, v57
    v_lshlrev_b32 v40, 16, v60
    v_and_b32 v41, 0xffff0000, v60
    v_cvt_pk_bf16_f32 v60, v42, v43
    v_lshlrev_b32 v56, 16, v60
    v_and_b32 v57, 0xffff0000, v60
    v_mul_f32 v56, v63, v56
    v_mul_f32 v57, v63, v57
    v_cvt_pk_bf16_f32 v60, v56, v57
    v_lshlrev_b32 v42, 16, v60
    v_and_b32 v43, 0xffff0000, v60
    v_cvt_pk_bf16_f32 v60, v44, v45
    v_lshlrev_b32 v56, 16, v60
    v_and_b32 v57, 0xffff0000, v60
    v_mul_f32 v56, v63, v56
    v_mul_f32 v57, v63, v57
    v_cvt_pk_bf16_f32 v60, v56, v57
    v_lshlrev_b32 v44, 16, v60
    v_and_b32 v45, 0xffff0000, v60
    v_cvt_pk_bf16_f32 v60, v46, v47
    v_lshlrev_b32 v56, 16, v60
    v_and_b32 v57, 0xffff0000, v60
    v_mul_f32 v56, v63, v56
    v_mul_f32 v57, v63, v57
    v_cvt_pk_bf16_f32 v60, v56, v57
    v_lshlrev_b32 v46, 16, v60
    v_and_b32 v47, 0xffff0000, v60
    s_waitcnt vmcnt(0)
    s_mov_b32 s29, 262144
L_pc1:
    v_max_u32 v15, v160, v161
    v_max3_u32 v15, v15, v162, v163
    v_max3_u32 v15, v15, v164, v165
    v_max3_u32 v15, v15, v166, v167
    v_cmp_eq_u32 vcc, -1, v15
    s_cbranch_vccz L_pc1_ok
    s_sub_u32 s29, s29, 1
    s_cbranch_scc1 L_pc1_ok
    buffer_load_dwordx2 v[160:161], v8, s[16:19], s62 offen sc0 sc1
    buffer_load_dwordx2 v[162:163], v9, s[16:19], s62 offen sc0 sc1
    buffer_load_dwordx2 v[164:165], v8, s[16:19], s66 offen sc0 sc1
    buffer_load_dwordx2 v[166:167], v9, s[16:19], s66 offen sc0 sc1
    s_waitcnt vmcnt(0)
    s_branch L_pc1
L_pc1_ok:
    v_lshlrev_b32 v56, 16, v160
    v_and_b32 v57, 0xffff0000, v160
    v_lshlrev_b32 v58, 16, v161
    v_and_b32 v59, 0xffff0000, v161
    v_lshlrev_b32 v60, 16, v162
    v_and_b32 v61, 0xffff0000, v162
    v_lshlrev_b32 v62, 16, v163
    v_and_b32 v63, 0xffff0000, v163
    v_pk_add_f32 v[56:57], v[56:57], v[216:217]
    v_pk_add_f32 v[58:59], v[58:59], v[218:219]
    v_pk_add_f32 v[60:61], v[60:61], v[220:221]
    v_pk_add_f32 v[62:63], v[62:63], v[222:223]
    v_cvt_pk_bf16_f32 v160, v56, v57
    v_cvt_pk_bf16_f32 v161, v58, v59
    v_cvt_pk_bf16_f32 v162, v60, v61
    v_cvt_pk_bf16_f32 v163, v62, v63
    v_lshlrev_b32 v56, 16, v160
    v_and_b32 v57, 0xffff0000, v160
    v_lshlrev_b32 v58, 16, v161
    v_and_b32 v59, 0xffff0000, v161
    v_lshlrev_b32 v60, 16, v162
    v_and_b32 v61, 0xffff0000, v162
    v_lshlrev_b32 v62, 16, v163
    v_and_b32 v63, 0xffff0000, v163
    v_pk_mul_f32 v[56:57], v[56:57], v[48:49]
    v_pk_mul_f32 v[58:59], v[58:59], v[48:49]
    v_pk_mul_f32 v[60:61], v[60:61], v[48:49]
    v_pk_mul_f32 v[62:63], v[62:63], v[48:49]
    v_cvt_pk_bf16_f32 v160, v56, v57
    v_cvt_pk_bf16_f32 v161, v58, v59
    v_cvt_pk_bf16_f32 v162, v60, v61
    v_cvt_pk_bf16_f32 v163, v62, v63
    v_lshlrev_b32 v56, 16, v160
    v_and_b32 v57, 0xffff0000, v160
    v_lshlrev_b32 v58, 16, v161
    v_and_b32 v59, 0xffff0000, v161
    v_lshlrev_b32 v60, 16, v162
    v_and_b32 v61, 0xffff0000, v162
    v_lshlrev_b32 v62, 16, v163
    v_and_b32 v63, 0xffff0000, v163
    v_pk_add_f32 v[56:57], v[56:57], v[32:33]
    v_pk_add_f32 v[58:59], v[58:59], v[34:35]
    v_pk_add_f32 v[60:61], v[60:61], v[36:37]
    v_pk_add_f32 v[62:63], v[62:63], v[38:39]
    v_cvt_pk_bf16_f32 v160, v56, v57
    v_cvt_pk_bf16_f32 v161, v58, v59
    v_cvt_pk_bf16_f32 v162, v60, v61
    v_cvt_pk_bf16_f32 v163, v62, v63
    buffer_store_dwordx4 v[160:163], v5, s[44:47], s61 offen
    s_cmp_ge_u32 s49, 6
    s_cbranch_scc1 L_done
    v_lshlrev_b32 v56, 16, v164
    v_and_b32 v57, 0xffff0000, v164
    v_lshlrev_b32 v58, 16, v165
    v_and_b32 v59, 0xffff0000, v165
    v_lshlrev_b32 v60, 16, v166
    v_and_b32 v61, 0xffff0000, v166
    v_lshlrev_b32 v62, 16, v167
    v_and_b32 v63, 0xffff0000, v167
    v_pk_add_f32 v[56:57], v[56:57], v[224:225]
    v_pk_add_f32 v[58:59], v[58:59], v[226:227]
    v_pk_add_f32 v[60:61], v[60:61], v[228:229]
    v_pk_add_f32 v[62:63], v[62:63], v[230:231]
    v_cvt_pk_bf16_f32 v164, v56, v57
    v_cvt_pk_bf16_f32 v165, v58, v59
    v_cvt_pk_bf16_f32 v166, v60, v61
    v_cvt_pk_bf16_f32 v167, v62, v63
    v_lshlrev_b32 v56, 16, v164
    v_and_b32 v57, 0xffff0000, v164
    v_lshlrev_b32 v58, 16, v165
    v_and_b32 v59, 0xffff0000, v165
    v_lshlrev_b32 v60, 16, v166
    v_and_b32 v61, 0xffff0000, v166
    v_lshlrev_b32 v62, 16, v167
    v_and_b32 v63, 0xffff0000, v167
    v_pk_mul_f32 v[56:57], v[56:57], v[50:51]
    v_pk_mul_f32 v[58:59], v[58:59], v[50:51]
    v_pk_mul_f32 v[60:61], v[60:61], v[50:51]
    v_pk_mul_f32 v[62:63], v[62:63], v[50:51]
    v_cvt_pk_bf16_f32 v164, v56, v57
    v_cvt_pk_bf16_f32 v165, v58, v59
    v_cvt_pk_bf16_f32 v166, v60, v61
    v_cvt_pk_bf16_f32 v167, v62, v63
    v_lshlrev_b32 v56, 16, v164
    v_and_b32 v57, 0xffff0000, v164
    v_lshlrev_b32 v58, 16, v165
    v_and_b32 v59, 0xffff0000, v165
    v_lshlrev_b32 v60, 16, v166
    v_and_b32 v61, 0xffff0000, v166
    v_lshlrev_b32 v62, 16, v167
    v_and_b32 v63, 0xffff0000, v167
    v_pk_add_f32 v[56:57], v[56:57], v[40:41]
    v_pk_add_f32 v[58:59], v[58:59], v[42:43]
    v_pk_add_f32 v[60:61], v[60:61], v[44:45]
    v_pk_add_f32 v[62:63], v[62:63], v[46:47]
    v_cvt_pk_bf16_f32 v164, v56, v57
    v_cvt_pk_bf16_f32 v165, v58, v59
    v_cvt_pk_bf16_f32 v166, v60, v61
    v_cvt_pk_bf16_f32 v167, v62, v63
    buffer_store_dwordx4 v[164:167], v5, s[44:47], s65 offen
    s_branch L_done
L_red4:
    v_mov_b32 v56, v41
    v_mov_b32 v57, 3
    v_mov_b32 v15, v47
    s_add_u32 s30, s49, 15
    s_and_b32 s63, s30, 1
    s_mul_i32 s31, s30, 43
    s_lshr_b32 s31, s31, 9
    s_add_u32 s96, s31, 1
    s_lshr_b32 s30, s30, 1
    s_lshl_b32 s31, s51, 1
    s_add_u32 s30, s30, s31
    s_sub_u32 s31, s30, 18
    s_cmp_ge_u32 s30, 18
    s_cselect_b32 s30, s31, s30
    s_lshl_b32 s31, s21, 3
    s_lshl_b32 s32, s22, 1
    s_add_u32 s31, s31, s32
    s_add_u32 s31, s31, s63
    s_mul_i32 s32, s31, 18
    s_add_u32 s32, s32, s30
    s_lshl_b32 s32, s32, 14
    s_add_u32 s60, s32, 8388608
    s_mul_i32 s32, s31, 18432
    s_lshl_b32 s33, s30, 6
    s_add_u32 s61, s32, s33
    s_lshl_b32 s32, s30, 17
    s_lshl_b32 s31, s31, 7
    s_add_u32 s32, s32, s31
    s_add_u32 s62, s32, 1048576
    s_add_u32 s30, s49, 22
    s_and_b32 s67, s30, 1
    s_mul_i32 s31, s30, 43
    s_lshr_b32 s31, s31, 9
    s_add_u32 s97, s31, 1
    s_lshr_b32 s30, s30, 1
    s_lshl_b32 s31, s51, 1
    s_add_u32 s30, s30, s31
    s_sub_u32 s31, s30, 18
    s_cmp_ge_u32 s30, 18
    s_cselect_b32 s30, s31, s30
    s_lshl_b32 s31, s21, 3
    s_lshl_b32 s32, s22, 1
    s_add_u32 s31, s31, s32
    s_add_u32 s31, s31, s67
    s_mul_i32 s32, s31, 18
    s_add_u32 s32, s32, s30
    s_lshl_b32 s32, s32, 14
    s_add_u32 s64, s32, 8388608
    s_mul_i32 s32, s31, 18432
    s_lshl_b32 s33, s30, 6
    s_add_u32 s65, s32, s33
    s_lshl_b32 s32, s30, 17
    s_lshl_b32 s31, s31, 7
    s_add_u32 s32, s32, s31
    s_add_u32 s66, s32, 1048576
    s_add_u32 s30, s49, 29
    s_and_b32 s71, s30, 1
    s_mul_i32 s31, s30, 43
    s_lshr_b32 s31, s31, 9
    s_add_u32 s98, s31, 1
    s_lshr_b32 s30, s30, 1
    s_lshl_b32 s31, s51, 1
    s_add_u32 s30, s30, s31
    s_sub_u32 s31, s30, 18
    s_cmp_ge_u32 s30, 18
    s_cselect_b32 s30, s31, s30
    s_lshl_b32 s31, s21, 3
    s_lshl_b32 s32, s22, 1
    s_add_u32 s31, s31, s32
    s_add_u32 s31, s31, s71
    s_mul_i32 s32, s31, 18
    s_add_u32 s32, s32, s30
    s_lshl_b32 s32, s32, 14
    s_add_u32 s68, s32, 8388608
    s_mul_i32 s32, s31, 18432
    s_lshl_b32 s33, s30, 6
    s_add_u32 s69, s32, s33
    s_lshl_b32 s32, s30, 17
    s_lshl_b32 s31, s31, 7
    s_add_u32 s32, s32, s31
    s_add_u32 s70, s32, 1048576
    v_lshlrev_b32 v2, 4, v1
    v_and_b32 v3, 15, v1
    v_lshrrev_b32 v4, 4, v1
    v_mul_u32_u24 v5, 1152, v3
    v_lshl_add_u32 v5, v4, 4, v5
    v_lshlrev_b32 v7, 4, v4
    v_lshlrev_b32 v8, 15, v4
    v_lshl_add_u32 v8, v3, 3, v8
    v_add_u32 v9, 16384, v8
    v_add_u32 v10, 4096, v2
    v_add_u32 v11, 8192, v2
    v_add_u32 v12, 12288, v2
    s_lshl_b32 s30, s21, 7
    s_add_u32 s30, s30, 4096
    v_lshl_add_u32 v13, v3, 2, s30
    v_cmp_gt_u32 vcc, s96, v15
    s_cbranch_vccnz L_late
    buffer_load_dwordx4 a[144:147], v2, s[16:19], s60 offen offset:0 sc0 sc1
    buffer_load_dwordx4 a[148:151], v2, s[16:19], s60 offen offset:1024 sc0 sc1
    buffer_load_dwordx4 a[152:155], v2, s[16:19], s60 offen offset:2048 sc0 sc1
    buffer_load_dwordx4 a[156:159], v2, s[16:19], s60 offen offset:3072 sc0 sc1
    buffer_load_dwordx4 a[160:163], v10, s[16:19], s60 offen offset:0 sc0 sc1
    buffer_load_dwordx4 a[164:167], v10, s[16:19], s60 offen offset:1024 sc0 sc1
    buffer_load_dwordx4 a[168:171], v10, s[16:19], s60 offen offset:2048 sc0 sc1
    buffer_load_dwordx4 a[172:175], v10, s[16:19], s60 offen offset:3072 sc0 sc1
    buffer_load_dwordx4 a[176:179], v11, s[16:19], s60 offen offset:0 sc0 sc1
    buffer_load_dwordx4 a[180:183], v11, s[16:19], s60 offen offset:1024 sc0 sc1
    buffer_load_dwordx4 a[184:187], v11, s[16:19], s60 offen offset:2048 sc0 sc1
    buffer_load_dwordx4 a[188:191], v11, s[16:19], s60 offen offset:3072 sc0 sc1
    buffer_load_dwordx4 a[192:195], v12, s[16:19], s60 offen offset:0 sc0 sc1
    buffer_load_dwordx4 a[196:199], v12, s[16:19], s60 offen offset:1024 sc0 sc1
    buffer_load_dwordx4 a[200:203], v12, s[16:19], s60 offen offset:2048 sc0 sc1
    buffer_load_dwordx4 a[204:207], v12, s[16:19], s60 offen offset:3072 sc0 sc1
    s_waitcnt vmcnt(16)
    s_barrier
    buffer_store_dword v57, v56, s[16:19], 0 offen sc0 sc1
    s_branch L_join
L_late:
    s_waitcnt vmcnt(0)
    s_barrier
    buffer_store_dword v57, v56, s[16:19], 0 offen sc0 sc1
    s_mov_b32 s29, 262144
L_pb4_0:
    v_cmp_gt_u32 vcc, s96, v15
    s_cbranch_vccz L_pb4_0_ok
    s_sub_u32 s29, s29, 1
    s_cbranch_scc1 L_pb4_0_ok
    buffer_load_dword v15, v13, s[16:19], 0 offen sc0 sc1
    s_waitcnt vmcnt(0)
    s_branch L_pb4_0
L_pb4_0_ok:
    buffer_load_dwordx4 a[144:147], v2, s[16:19], s60 offen offset:0 sc0 sc1
    buffer_load_dwordx4 a[148:151], v2, s[16:19], s60 offen offset:1024 sc0 sc1
    buffer_load_dwordx4 a[152:155], v2, s[16:19], s60 offen offset:2048 sc0 sc1
    buffer_load_dwordx4 a[156:159], v2, s[16:19], s60 offen offset:3072 sc0 sc1
    buffer_load_dwordx4 a[160:163], v10, s[16:19], s60 offen offset:0 sc0 sc1
    buffer_load_dwordx4 a[164:167], v10, s[16:19], s60 offen offset:1024 sc0 sc1
    buffer_load_dwordx4 a[168:171], v10, s[16:19], s60 offen offset:2048 sc0 sc1
    buffer_load_dwordx4 a[172:175], v10, s[16:19], s60 offen offset:3072 sc0 sc1
    buffer_load_dwordx4 a[176:179], v11, s[16:19], s60 offen offset:0 sc0 sc1
    buffer_load_dwordx4 a[180:183], v11, s[16:19], s60 offen offset:1024 sc0 sc1
    buffer_load_dwordx4 a[184:187], v11, s[16:19], s60 offen offset:2048 sc0 sc1
    buffer_load_dwordx4 a[188:191], v11, s[16:19], s60 offen offset:3072 sc0 sc1
    buffer_load_dwordx4 a[192:195], v12, s[16:19], s60 offen offset:0 sc0 sc1
    buffer_load_dwordx4 a[196:199], v12, s[16:19], s60 offen offset:1024 sc0 sc1
    buffer_load_dwordx4 a[200:203], v12, s[16:19], s60 offen offset:2048 sc0 sc1
    buffer_load_dwordx4 a[204:207], v12, s[16:19], s60 offen offset:3072 sc0 sc1
L_join:
    v_lshrrev_b32 v6, 4, v1
    v_lshlrev_b32 v6, 4, v6
    s_lshl_b32 s30, s50, 7
    buffer_load_dwordx4 v[64:67], v6, s[36:39], s30 offen offset:0
    buffer_load_dwordx4 v[68:71], v6, s[36:39], s30 offen offset:64
    s_add_u32 s30, s30, 128
    s_cmp_eq_u32 s30, 1152
    s_cselect_b32 s30, 0, s30
    buffer_load_dwordx4 v[72:75], v6, s[36:39], s30 offen offset:0
    buffer_load_dwordx4 v[76:79], v6, s[36:39], s30 offen offset:64
    s_add_u32 s30, s30, 128
    s_cmp_eq_u32 s30, 1152
    s_cselect_b32 s30, 0, s30
    buffer_load_dwordx4 v[80:83], v6, s[36:39], s30 offen offset:0
    buffer_load_dwordx4 v[84:87], v6, s[36:39], s30 offen offset:64
    s_add_u32 s30, s30, 128
    s_cmp_eq_u32 s30, 1152
    s_cselect_b32 s30, 0, s30
    buffer_load_dwordx4 v[88:91], v6, s[36:39], s30 offen offset:0
    buffer_load_dwordx4 v[92:95], v6, s[36:39], s30 offen offset:64
    s_add_u32 s30, s30, 128
    s_cmp_eq_u32 s30, 1152
    s_cselect_b32 s30, 0, s30
    buffer_load_dwordx4 v[96:99], v6, s[36:39], s30 offen offset:0
    buffer_load_dwordx4 v[100:103], v6, s[36:39], s30 offen offset:64
    s_add_u32 s30, s30, 128
    s_cmp_eq_u32 s30, 1152
    s_cselect_b32 s30, 0, s30
    buffer_load_dwordx4 v[104:107], v6, s[36:39], s30 offen offset:0
    buffer_load_dwordx4 v[108:111], v6, s[36:39], s30 offen offset:64
    s_add_u32 s30, s30, 128
    s_cmp_eq_u32 s30, 1152
    s_cselect_b32 s30, 0, s30
    buffer_load_dwordx4 v[112:115], v6, s[36:39], s30 offen offset:0
    buffer_load_dwordx4 v[116:119], v6, s[36:39], s30 offen offset:64
    s_add_u32 s30, s30, 128
    s_cmp_eq_u32 s30, 1152
    s_cselect_b32 s30, 0, s30
    buffer_load_dwordx4 v[120:123], v6, s[36:39], s30 offen offset:0
    buffer_load_dwordx4 v[124:127], v6, s[36:39], s30 offen offset:64
    s_add_u32 s30, s30, 128
    s_cmp_eq_u32 s30, 1152
    s_cselect_b32 s30, 0, s30
    buffer_load_dwordx4 v[128:131], v6, s[36:39], s30 offen offset:0
    buffer_load_dwordx4 v[132:135], v6, s[36:39], s30 offen offset:64
    s_waitcnt lgkmcnt(0)
    s_and_b32 s9, s9, 0xffff
    s_mov_b32 s10, 1152
    s_mov_b32 s11, 0x00020000
    buffer_load_dwordx4 v[24:27], v5, s[4:7], s61 offen
    s_lshr_b32 s30, s62, 17
    s_sub_u32 s30, s30, 8
    s_lshl_b32 s30, s30, 6
    buffer_load_dwordx4 v[28:31], v7, s[8:11], s30 offen
    buffer_load_dwordx4 v[32:35], v5, s[4:7], s65 offen
    s_lshr_b32 s30, s66, 17
    s_sub_u32 s30, s30, 8
    s_lshl_b32 s30, s30, 6
    buffer_load_dwordx4 v[36:39], v7, s[8:11], s30 offen
    buffer_load_dwordx4 v[40:43], v5, s[4:7], s69 offen
    s_lshr_b32 s30, s70, 17
    s_sub_u32 s30, s30, 8
    s_lshl_b32 s30, s30, 6
    buffer_load_dwordx4 v[44:47], v7, s[8:11], s30 offen
    s_mov_b32 s29, 262144
L_pb4_1:
    v_cmp_gt_u32 vcc, s97, v15
    s_cbranch_vccz L_pb4_1_ok
    s_sub_u32 s29, s29, 1
    s_cbranch_scc1 L_pb4_1_ok
    buffer_load_dword v15, v13, s[16:19], 0 offen sc0 sc1
    s_waitcnt vmcnt(0)
    s_branch L_pb4_1
L_pb4_1_ok:
    buffer_load_dwordx4 v[136:139], v2, s[16:19], s64 offen offset:0 sc0 sc1
    buffer_load_dwordx4 v[140:143], v2, s[16:19], s64 offen offset:1024 sc0 sc1
    buffer_load_dwordx4 v[144:147], v2, s[16:19], s64 offen offset:2048 sc0 sc1
    buffer_load_dwordx4 v[148:151], v2, s[16:19], s64 offen offset:3072 sc0 sc1
    buffer_load_dwordx4 v[152:155], v10, s[16:19], s64 offen offset:0 sc0 sc1
    buffer_load_dwordx4 v[156:159], v10, s[16:19], s64 offen offset:1024 sc0 sc1
    buffer_load_dwordx4 v[160:163], v10, s[16:19], s64 offen offset:2048 sc0 sc1
    buffer_load_dwordx4 v[164:167], v10, s[16:19], s64 offen offset:3072 sc0 sc1
    buffer_load_dwordx4 v[168:171], v11, s[16:19], s64 offen offset:0 sc0 sc1
    buffer_load_dwordx4 v[172:175], v11, s[16:19], s64 offen offset:1024 sc0 sc1
    buffer_load_dwordx4 v[176:179], v11, s[16:19], s64 offen offset:2048 sc0 sc1
    buffer_load_dwordx4 v[180:183], v11, s[16:19], s64 offen offset:3072 sc0 sc1
    buffer_load_dwordx4 v[184:187], v12, s[16:19], s64 offen offset:0 sc0 sc1
    buffer_load_dwordx4 v[188:191], v12, s[16:19], s64 offen offset:1024 sc0 sc1
    buffer_load_dwordx4 v[192:195], v12, s[16:19], s64 offen offset:2048 sc0 sc1
    buffer_load_dwordx4 v[196:199], v12, s[16:19], s64 offen offset:3072 sc0 sc1
    s_mov_b32 s29, 262144
L_pb4_2:
    v_cmp_gt_u32 vcc, s98, v15
    s_cbranch_vccz L_pb4_2_ok
    s_sub_u32 s29, s29, 1
    s_cbranch_scc1 L_pb4_2_ok
    buffer_load_dword v15, v13, s[16:19], 0 offen sc0 sc1
    s_waitcnt vmcnt(0)
    s_branch L_pb4_2
L_pb4_2_ok:
    buffer_load_dwordx4 v[200:203], v2, s[16:19], s68 offen offset:0 sc0 sc1
    buffer_load_dwordx4 v[204:207], v2, s[16:19], s68 offen offset:1024 sc0 sc1
    buffer_load_dwordx4 v[208:211], v2, s[16:19], s68 offen offset:2048 sc0 sc1
    buffer_load_dwordx4 v[212:215], v2, s[16:19], s68 offen offset:3072 sc0 sc1
    buffer_load_dwordx4 v[216:219], v10, s[16:19], s68 offen offset:0 sc0 sc1
    buffer_load_dwordx4 v[220:223], v10, s[16:19], s68 offen offset:1024 sc0 sc1
    buffer_load_dwordx4 v[224:227], v10, s[16:19], s68 offen offset:2048 sc0 sc1
    buffer_load_dwordx4 v[228:231], v10, s[16:19], s68 offen offset:3072 sc0 sc1
    buffer_load_dwordx4 v[232:235], v11, s[16:19], s68 offen offset:0 sc0 sc1
    buffer_load_dwordx4 v[236:239], v11, s[16:19], s68 offen offset:1024 sc0 sc1
    buffer_load_dwordx4 v[240:243], v11, s[16:19], s68 offen offset:2048 sc0 sc1
    buffer_load_dwordx4 v[244:247], v11, s[16:19], s68 offen offset:3072 sc0 sc1
    buffer_load_dwordx4 v[248:251], v12, s[16:19], s68 offen offset:0 sc0 sc1
    buffer_load_dwordx4 v[252:255], v12, s[16:19], s68 offen offset:1024 sc0 sc1
    buffer_load_dwordx4 a[208:211], v12, s[16:19], s68 offen offset:2048 sc0 sc1
    buffer_load_dwordx4 a[212:215], v12, s[16:19], s68 offen offset:3072 sc0 sc1
    s_waitcnt vmcnt(32)
    v_mfma_f32_16x16x32_bf16 v[16:19], v[64:67], a[0:3], 0
    v_mfma_f32_16x16x32_bf16 v[20:23], v[64:67], a[4:7], 0
    v_mfma_f32_16x16x32_bf16 v[16:19], v[68:71], a[8:11], v[16:19]
    v_mfma_f32_16x16x32_bf16 v[20:23], v[68:71], a[12:15], v[20:23]
    v_mfma_f32_16x16x32_bf16 v[16:19], v[72:75], a[16:19], v[16:19]
    v_mfma_f32_16x16x32_bf16 v[20:23], v[72:75], a[20:23], v[20:23]
    v_mfma_f32_16x16x32_bf16 v[16:19], v[76:79], a[24:27], v[16:19]
    v_mfma_f32_16x16x32_bf16 v[20:23], v[76:79], a[28:31], v[20:23]
    v_mfma_f32_16x16x32_bf16 v[16:19], v[80:83], a[32:35], v[16:19]
    v_mfma_f32_16x16x32_bf16 v[20:23], v[80:83], a[36:39], v[20:23]
    v_mfma_f32_16x16x32_bf16 v[16:19], v[84:87], a[40:43], v[16:19]
    v_mfma_f32_16x16x32_bf16 v[20:23], v[84:87], a[44:47], v[20:23]
    v_mfma_f32_16x16x32_bf16 v[16:19], v[88:91], a[48:51], v[16:19]
    v_mfma_f32_16x16x32_bf16 v[20:23], v[88:91], a[52:55], v[20:23]
    v_mfma_f32_16x16x32_bf16 v[16:19], v[92:95], a[56:59], v[16:19]
    v_mfma_f32_16x16x32_bf16 v[20:23], v[92:95], a[60:63], v[20:23]
    v_mfma_f32_16x16x32_bf16 v[16:19], v[96:99], a[64:67], v[16:19]
    v_mfma_f32_16x16x32_bf16 v[20:23], v[96:99], a[68:71], v[20:23]
    v_mfma_f32_16x16x32_bf16 v[16:19], v[100:103], a[72:75], v[16:19]
    v_mfma_f32_16x16x32_bf16 v[20:23], v[100:103], a[76:79], v[20:23]
    v_mfma_f32_16x16x32_bf16 v[16:19], v[104:107], a[80:83], v[16:19]
    v_mfma_f32_16x16x32_bf16 v[20:23], v[104:107], a[84:87], v[20:23]
    v_mfma_f32_16x16x32_bf16 v[16:19], v[108:111], a[88:91], v[16:19]
    v_mfma_f32_16x16x32_bf16 v[20:23], v[108:111], a[92:95], v[20:23]
    v_mfma_f32_16x16x32_bf16 v[16:19], v[112:115], a[96:99], v[16:19]
    v_mfma_f32_16x16x32_bf16 v[20:23], v[112:115], a[100:103], v[20:23]
    v_mfma_f32_16x16x32_bf16 v[16:19], v[116:119], a[104:107], v[16:19]
    v_mfma_f32_16x16x32_bf16 v[20:23], v[116:119], a[108:111], v[20:23]
    v_mfma_f32_16x16x32_bf16 v[16:19], v[120:123], a[112:115], v[16:19]
    v_mfma_f32_16x16x32_bf16 v[20:23], v[120:123], a[116:119], v[20:23]
    v_mfma_f32_16x16x32_bf16 v[16:19], v[124:127], a[120:123], v[16:19]
    v_mfma_f32_16x16x32_bf16 v[20:23], v[124:127], a[124:127], v[20:23]
    v_mfma_f32_16x16x32_bf16 v[16:19], v[128:131], a[128:131], v[16:19]
    v_mfma_f32_16x16x32_bf16 v[20:23], v[128:131], a[132:135], v[20:23]
    v_mfma_f32_16x16x32_bf16 v[16:19], v[132:135], a[136:139], v[16:19]
    v_mfma_f32_16x16x32_bf16 v[20:23], v[132:135], a[140:143], v[20:23]
    s_nop 7
    v_cvt_pk_bf16_f32 v16, v16, v16
    v_lshlrev_b32 v16, 16, v16
    v_mul_f32 v16, 0xbfb8aa3b, v16
    v_exp_f32 v16, v16
    s_nop 0
    v_add_f32 v16, 1.0, v16
    v_rcp_f32 v16, v16
    s_nop 0
    v_cvt_pk_bf16_f32 v16, v16, v16
    v_lshlrev_b32 v16, 16, v16
    v_sub_f32 v17, 1.0, v16
    v_cvt_pk_bf16_f32 v17, v17, v17
    v_lshlrev_b32 v17, 16, v17
    v_cvt_pk_bf16_f32 v20, v20, v20
    v_lshlrev_b32 v20, 16, v20
    v_mul_f32 v20, 0xbfb8aa3b, v20
    v_exp_f32 v20, v20
    s_nop 0
    v_add_f32 v20, 1.0, v20
    v_rcp_f32 v20, v20
    s_nop 0
    v_cvt_pk_bf16_f32 v20, v20, v20
    v_lshlrev_b32 v20, 16, v20
    v_sub_f32 v21, 1.0, v20
    v_cvt_pk_bf16_f32 v21, v21, v21
    v_lshlrev_b32 v21, 16, v21
    buffer_load_dwordx2 v[112:113], v8, s[16:19], s62 offen sc0 sc1
    buffer_load_dwordx2 v[114:115], v9, s[16:19], s62 offen sc0 sc1
    buffer_load_dwordx2 v[116:117], v8, s[16:19], s66 offen sc0 sc1
    buffer_load_dwordx2 v[118:119], v9, s[16:19], s66 offen sc0 sc1
    buffer_load_dwordx2 v[120:121], v8, s[16:19], s70 offen sc0 sc1
    buffer_load_dwordx2 v[122:123], v9, s[16:19], s70 offen sc0 sc1
    v_lshlrev_b32 v56, 16, v24
    v_and_b32 v57, 0xffff0000, v24
    v_lshlrev_b32 v58, 16, v28
    v_and_b32 v59, 0xffff0000, v28
    v_pk_mul_f32 v[56:57], v[56:57], v[58:59]
    v_cvt_pk_bf16_f32 v60, v56, v57
    v_lshlrev_b32 v56, 16, v25
    v_and_b32 v57, 0xffff0000, v25
    v_lshlrev_b32 v58, 16, v29
    v_and_b32 v59, 0xffff0000, v29
    v_pk_mul_f32 v[56:57], v[56:57], v[58:59]
    v_cvt_pk_bf16_f32 v61, v56, v57
    v_lshlrev_b32 v56, 16, v26
    v_and_b32 v57, 0xffff0000, v26
    v_lshlrev_b32 v58, 16, v30
    v_and_b32 v59, 0xffff0000, v30
    v_pk_mul_f32 v[56:57], v[56:57], v[58:59]
    v_cvt_pk_bf16_f32 v62, v56, v57
    v_lshlrev_b32 v56, 16, v27
    v_and_b32 v57, 0xffff0000, v27
    v_lshlrev_b32 v58, 16, v31
    v_and_b32 v59, 0xffff0000, v31
    v_pk_mul_f32 v[56:57], v[56:57], v[58:59]
    v_cvt_pk_bf16_f32 v63, v56, v57
    v_lshlrev_b32 v24, 16, v60
    v_and_b32 v25, 0xffff0000, v60
    v_lshlrev_b32 v26, 16, v61
    v_and_b32 v27, 0xffff0000, v61
    v_lshlrev_b32 v28, 16, v62
    v_and_b32 v29, 0xffff0000, v62
    v_lshlrev_b32 v30, 16, v63
    v_and_b32 v31, 0xffff0000, v63
    v_lshlrev_b32 v56, 16, v32
    v_and_b32 v57, 0xffff0000, v32
    v_lshlrev_b32 v58, 16, v36
    v_and_b32 v59, 0xffff0000, v36
    v_pk_mul_f32 v[56:57], v[56:57], v[58:59]
    v_cvt_pk_bf16_f32 v60, v56, v57
    v_lshlrev_b32 v56, 16, v33
    v_and_b32 v57, 0xffff0000, v33
    v_lshlrev_b32 v58, 16, v37
    v_and_b32 v59, 0xffff0000, v37
    v_pk_mul_f32 v[56:57], v[56:57], v[58:59]
    v_cvt_pk_bf16_f32 v61, v56, v57
    v_lshlrev_b32 v56, 16, v34
    v_and_b32 v57, 0xffff0000, v34
    v_lshlrev_b32 v58, 16, v38
    v_and_b32 v59, 0xffff0000, v38
    v_pk_mul_f32 v[56:57], v[56:57], v[58:59]
    v_cvt_pk_bf16_f32 v62, v56, v57
    v_lshlrev_b32 v56, 16, v35
    v_and_b32 v57, 0xffff0000, v35
    v_lshlrev_b32 v58, 16, v39
    v_and_b32 v59, 0xffff0000, v39
    v_pk_mul_f32 v[56:57], v[56:57], v[58:59]
    v_cvt_pk_bf16_f32 v63, v56, v57
    v_lshlrev_b32 v32, 16, v60
    v_and_b32 v33, 0xffff0000, v60
    v_lshlrev_b32 v34, 16, v61
    v_and_b32 v35, 0xffff0000, v61
    v_lshlrev_b32 v36, 16, v62
    v_and_b32 v37, 0xffff0000, v62
    v_lshlrev_b32 v38, 16, v63
    v_and_b32 v39, 0xffff0000, v63
    v_lshlrev_b32 v56, 16, v40
    v_and_b32 v57, 0xffff0000, v40
    v_lshlrev_b32 v58, 16, v44
    v_and_b32 v59, 0xffff0000, v44
    v_pk_mul_f32 v[56:57], v[56:57], v[58:59]
    v_cvt_pk_bf16_f32 v60, v56, v57
    v_lshlrev_b32 v56, 16, v41
    v_and_b32 v57, 0xffff0000, v41
    v_lshlrev_b32 v58, 16, v45
    v_and_b32 v59, 0xffff0000, v45
    v_pk_mul_f32 v[56:57], v[56:57], v[58:59]
    v_cvt_pk_bf16_f32 v61, v56, v57
    v_lshlrev_b32 v56, 16, v42
    v_and_b32 v57, 0xffff0000, v42
    v_lshlrev_b32 v58, 16, v46
    v_and_b32 v59, 0xffff0000, v46
    v_pk_mul_f32 v[56:57], v[56:57], v[58:59]
    v_cvt_pk_bf16_f32 v62, v56, v57
    v_lshlrev_b32 v56, 16, v43
    v_and_b32 v57, 0xffff0000, v43
    v_lshlrev_b32 v58, 16, v47
    v_and_b32 v59, 0xffff0000, v47
    v_pk_mul_f32 v[56:57], v[56:57], v[58:59]
    v_cvt_pk_bf16_f32 v63, v56, v57
    v_lshlrev_b32 v40, 16, v60
    v_and_b32 v41, 0xffff0000, v60
    v_lshlrev_b32 v42, 16, v61
    v_and_b32 v43, 0xffff0000, v61
    v_lshlrev_b32 v44, 16, v62
    v_and_b32 v45, 0xffff0000, v62
    v_lshlrev_b32 v46, 16, v63
    v_and_b32 v47, 0xffff0000, v63
    v_and_b32 v6, 1, v1
    v_lshlrev_b32 v6, 4, v6
    v_mov_b32 v63, 0x3f80
    v_lshlrev_b32 v6, v6, v63
    v_bfe_u32 v63, v1, 3, 1
    v_bfe_u32 v96, v1, 1, 1
    v_lshl_add_u32 v63, v63, 1, v96
    v_bfe_u32 v96, v1, 2, 1
    v_lshlrev_b32 v96, 1, v96
    v_sub_u32 v96, v4, v96
    v_lshl_add_u32 v63, v96, 2, v63
    v_cmp_eq_u32 vcc, 0, v63
    s_nop 1
    v_cndmask_b32 v96, 0, v6, vcc
    v_cmp_eq_u32 vcc, 1, v63
    s_nop 1
    v_cndmask_b32 v97, 0, v6, vcc
    v_cmp_eq_u32 vcc, 2, v63
    s_nop 1
    v_cndmask_b32 v98, 0, v6, vcc
    v_cmp_eq_u32 vcc, 3, v63
    s_nop 1
    v_cndmask_b32 v99, 0, v6, vcc
    v_cmp_eq_u32 vcc, 4, v63
    s_nop 1
    v_cndmask_b32 v100, 0, v6, vcc
    v_cmp_eq_u32 vcc, 5, v63
    s_nop 1
    v_cndmask_b32 v101, 0, v6, vcc
    v_cmp_eq_u32 vcc, 6, v63
    s_nop 1
    v_cndmask_b32 v102, 0, v6, vcc
    v_cmp_eq_u32 vcc, 7, v63
    s_nop 1
    v_cndmask_b32 v103, 0, v6, vcc
    v_mfma_f32_16x16x32_bf16 v[64:67], v[96:99], a[144:147], 0
    s_nop 0
    v_mfma_f32_16x16x32_bf16 v[68:71], v[100:103], a[144:147], 0
    v_mfma_f32_16x16x32_bf16 v[64:67], v[96:99], a[148:151], v[64:67]
    v_mfma_f32_16x16x32_bf16 v[68:71], v[100:103], a[148:151], v[68:71]
    v_mfma_f32_16x16x32_bf16 v[64:67], v[96:99], a[152:155], v[64:67]
    v_mfma_f32_16x16x32_bf16 v[68:71], v[100:103], a[152:155], v[68:71]
    v_mfma_f32_16x16x32_bf16 v[64:67], v[96:99], a[156:159], v[64:67]
    v_mfma_f32_16x16x32_bf16 v[68:71], v[100:103], a[156:159], v[68:71]
    v_mfma_f32_16x16x32_bf16 v[64:67], v[96:99], a[160:163], v[64:67]
    v_mfma_f32_16x16x32_bf16 v[68:71], v[100:103], a[160:163], v[68:71]
    v_mfma_f32_16x16x32_bf16 v[64:67], v[96:99], a[164:167], v[64:67]
    v_mfma_f32_16x16x32_bf16 v[68:71], v[100:103], a[164:167], v[68:71]
    v_mfma_f32_16x16x32_bf16 v[64:67], v[96:99], a[168:171], v[64:67]
    v_mfma_f32_16x16x32_bf16 v[68:71], v[100:103], a[168:171], v[68:71]
    v_mfma_f32_16x16x32_bf16 v[64:67], v[96:99], a[172:175], v[64:67]
    v_mfma_f32_16x16x32_bf16 v[68:71], v[100:103], a[172:175], v[68:71]
    v_mfma_f32_16x16x32_bf16 v[64:67], v[96:99], a[176:179], v[64:67]
    v_mfma_f32_16x16x32_bf16 v[68:71], v[100:103], a[176:179], v[68:71]
    v_mfma_f32_16x16x32_bf16 v[64:67], v[96:99], a[180:183], v[64:67]
    v_mfma_f32_16x16x32_bf16 v[68:71], v[100:103], a[180:183], v[68:71]
    v_mfma_f32_16x16x32_bf16 v[64:67], v[96:99], a[184:187], v[64:67]
    v_mfma_f32_16x16x32_bf16 v[68:71], v[100:103], a[184:187], v[68:71]
    v_mfma_f32_16x16x32_bf16 v[64:67], v[96:99], a[188:191], v[64:67]
    v_mfma_f32_16x16x32_bf16 v[68:71], v[100:103], a[188:191], v[68:71]
    v_mfma_f32_16x16x32_bf16 v[64:67], v[96:99], a[192:195], v[64:67]
    v_mfma_f32_16x16x32_bf16 v[68:71], v[100:103], a[192:195], v[68:71]
    v_mfma_f32_16x16x32_bf16 v[64:67], v[96:99], a[196:199], v[64:67]
    v_mfma_f32_16x16x32_bf16 v[68:71], v[100:103], a[196:199], v[68:71]
    v_mfma_f32_16x16x32_bf16 v[64:67], v[96:99], a[200:203], v[64:67]
    v_mfma_f32_16x16x32_bf16 v[68:71], v[100:103], a[200:203], v[68:71]
    v_mfma_f32_16x16x32_bf16 v[64:67], v[96:99], a[204:207], v[64:67]
    v_mfma_f32_16x16x32_bf16 v[68:71], v[100:103], a[204:207], v[68:71]
    s_waitcnt vmcnt(36)
    v_mfma_f32_16x16x32_bf16 v[72:75], v[96:99], v[136:139], 0
    v_mfma_f32_16x16x32_bf16 v[76:79], v[100:103], v[136:139], 0
    v_mfma_f32_16x16x32_bf16 v[72:75], v[96:99], v[140:143], v[72:75]
    v_mfma_f32_16x16x32_bf16 v[76:79], v[100:103], v[140:143], v[76:79]
    s_waitcnt vmcnt(34)
    v_mfma_f32_16x16x32_bf16 v[72:75], v[96:99], v[144:147], v[72:75]
    v_mfma_f32_16x16x32_bf16 v[76:79], v[100:103], v[144:147], v[76:79]
    v_mfma_f32_16x16x32_bf16 v[72:75], v[96:99], v[148:151], v[72:75]
    v_mfma_f32_16x16x32_bf16 v[76:79], v[100:103], v[148:151], v[76:79]
    s_waitcnt vmcnt(32)
    v_mfma_f32_16x16x32_bf16 v[72:75], v[96:99], v[152:155], v[72:75]
    v_mfma_f32_16x16x32_bf16 v[76:79], v[100:103], v[152:155], v[76:79]
    v_mfma_f32_16x16x32_bf16 v[72:75], v[96:99], v[156:159], v[72:75]
    v_mfma_f32_16x16x32_bf16 v[76:79], v[100:103], v[156:159], v[76:79]
    s_waitcnt vmcnt(30)
    v_mfma_f32_16x16x32_bf16 v[72:75], v[96:99], v[160:163], v[72:75]
    v_mfma_f32_16x16x32_bf16 v[76:79], v[100:103], v[160:163], v[76:79]
    v_mfma_f32_16x16x32_bf16 v[72:75], v[96:99], v[164:167], v[72:75]
    v_mfma_f32_16x16x32_bf16 v[76:79], v[100:103], v[164:167], v[76:79]
    s_waitcnt vmcnt(28)
    v_mfma_f32_16x16x32_bf16 v[72:75], v[96:99], v[168:171], v[72:75]
    v_mfma_f32_16x16x32_bf16 v[76:79], v[100:103], v[168:171], v[76:79]
    v_mfma_f32_16x16x32_bf16 v[72:75], v[96:99], v[172:175], v[72:75]
    v_mfma_f32_16x16x32_bf16 v[76:79], v[100:103], v[172:175], v[76:79]
    s_waitcnt vmcnt(26)
    v_mfma_f32_16x16x32_bf16 v[72:75], v[96:99], v[176:179], v[72:75]
    v_mfma_f32_16x16x32_bf16 v[76:79], v[100:103], v[176:179], v[76:79]
    v_mfma_f32_16x16x32_bf16 v[72:75], v[96:99], v[180:183], v[72:75]
    v_mfma_f32_16x16x32_bf16 v[76:79], v[100:103], v[180:183], v[76:79]
    s_waitcnt vmcnt(24)
    v_mfma_f32_16x16x32_bf16 v[72:75], v[96:99], v[184:187], v[72:75]
    v_mfma_f32_16x16x32_bf16 v[76:79], v[100:103], v[184:187], v[76:79]
    v_mfma_f32_16x16x32_bf16 v[72:75], v[96:99], v[188:191], v[72:75]
    v_mfma_f32_16x16x32_bf16 v[76:79], v[100:103], v[188:191], v[76:79]
    s_waitcnt vmcnt(22)
    v_mfma_f32_16x16x32_bf16 v[72:75], v[96:99], v[192:195], v[72:75]
    v_mfma_f32_16x16x32_bf16 v[76:79], v[100:103], v[192:195], v[76:79]
    v_mfma_f32_16x16x32_bf16 v[72:75], v[96:99], v[196:199], v[72:75]
    v_mfma_f32_16x16x32_bf16 v[76:79], v[100:103], v[196:199], v[76:79]
    s_cmp_eq_u32 s63, 0
    s_cselect_b64 vcc, -1, 0
    v_cndmask_b32 v104, v20, v16, vcc
    v_cndmask_b32 v63, v21, v17, vcc
    v_mov_b32 v105, v104
    v_cvt_pk_bf16_f32 v60, v64, v65
    v_lshlrev_b32 v56, 16, v60
    v_and_b32 v57, 0xffff0000, v60
    v_mul_f32 v56, v63, v56
    v_mul_f32 v57, v63, v57
    v_cvt_pk_bf16_f32 v60, v56, v57
    v_lshlrev_b32 v64, 16, v60
    v_and_b32 v65, 0xffff0000, v60
    v_cvt_pk_bf16_f32 v60, v66, v67
    v_lshlrev_b32 v56, 16, v60
    v_and_b32 v57, 0xffff0000, v60
    v_mul_f32 v56, v63, v56
    v_mul_f32 v57, v63, v57
    v_cvt_pk_bf16_f32 v60, v56, v57
    v_lshlrev_b32 v66, 16, v60
    v_and_b32 v67, 0xffff0000, v60
    v_cvt_pk_bf16_f32 v60, v68, v69
    v_lshlrev_b32 v56, 16, v60
    v_and_b32 v57, 0xffff0000, v60
    v_mul_f32 v56, v63, v56
    v_mul_f32 v57, v63, v57
    v_cvt_pk_bf16_f32 v60, v56, v57
    v_lshlrev_b32 v68, 16, v60
    v_and_b32 v69, 0xffff0000, v60
    v_cvt_pk_bf16_f32 v60, v70, v71
    v_lshlrev_b32 v56, 16, v60
    v_and_b32 v57, 0xffff0000, v60
    v_mul_f32 v56, v63, v56
    v_mul_f32 v57, v63, v57
    v_cvt_pk_bf16_f32 v60, v56, v57
    v_lshlrev_b32 v70, 16, v60
    v_and_b32 v71, 0xffff0000, v60
    s_waitcnt vmcnt(20)
    v_mfma_f32_16x16x32_bf16 v[80:83], v[96:99], v[200:203], 0
    v_mfma_f32_16x16x32_bf16 v[84:87], v[100:103], v[200:203], 0
    v_mfma_f32_16x16x32_bf16 v[80:83], v[96:99], v[204:207], v[80:83]
    v_mfma_f32_16x16x32_bf16 v[84:87], v[100:103], v[204:207], v[84:87]
    s_waitcnt vmcnt(18)
    v_mfma_f32_16x16x32_bf16 v[80:83], v[96:99], v[208:211], v[80:83]
    v_mfma_f32_16x16x32_bf16 v[84:87], v[100:103], v[208:211], v[84:87]
    v_mfma_f32_16x16x32_bf16 v[80:83], v[96:99], v[212:215], v[80:83]
    v_mfma_f32_16x16x32_bf16 v[84:87], v[100:103], v[212:215], v[84:87]
    s_waitcnt vmcnt(16)
    v_mfma_f32_16x16x32_bf16 v[80:83], v[96:99], v[216:219], v[80:83]
    v_mfma_f32_16x16x32_bf16 v[84:87], v[100:103], v[216:219], v[84:87]
    v_mfma_f32_16x16x32_bf16 v[80:83], v[96:99], v[220:223], v[80:83]
    v_mfma_f32_16x16x32_bf16 v[84:87], v[100:103], v[220:223], v[84:87]
    s_waitcnt vmcnt(14)
    v_mfma_f32_16x16x32_bf16 v[80:83], v[96:99], v[224:227], v[80:83]
    v_mfma_f32_16x16x32_bf16 v[84:87], v[100:103], v[224:227], v[84:87]
    v_mfma_f32_16x16x32_bf16 v[80:83], v[96:99], v[228:231], v[80:83]
    v_mfma_f32_16x16x32_bf16 v[84:87], v[100:103], v[228:231], v[84:87]
    s_waitcnt vmcnt(12)
    v_mfma_f32_16x16x32_bf16 v[80:83], v[96:99], v[232:235], v[80:83]
    v_mfma_f32_16x16x32_bf16 v[84:87], v[100:103], v[232:235], v[84:87]
    v_mfma_f32_16x16x32_bf16 v[80:83], v[96:99], v[236:239], v[80:83]
    v_mfma_f32_16x16x32_bf16 v[84:87], v[100:103], v[236:239], v[84:87]
    s_waitcnt vmcnt(10)
    v_mfma_f32_16x16x32_bf16 v[80:83], v[96:99], v[240:243], v[80:83]
    v_mfma_f32_16x16x32_bf16 v[84:87], v[100:103], v[240:243], v[84:87]
    v_mfma_f32_16x16x32_bf16 v[80:83], v[96:99], v[244:247], v[80:83]
    v_mfma_f32_16x16x32_bf16 v[84:87], v[100:103], v[244:247], v[84:87]
    s_waitcnt vmcnt(8)
    v_mfma_f32_16x16x32_bf16 v[80:83], v[96:99], v[248:251], v[80:83]
    v_mfma_f32_16x16x32_bf16 v[84:87], v[100:103], v[248:251], v[84:87]
    v_mfma_f32_16x16x32_bf16 v[80:83], v[96:99], v[252:255], v[80:83]
    v_mfma_f32_16x16x32_bf16 v[84:87], v[100:103], v[252:255], v[84:87]
    s_waitcnt vmcnt(6)
    v_mfma_f32_16x16x32_bf16 v[80:83], v[96:99], a[208:211], v[80:83]
    v_mfma_f32_16x16x32_bf16 v[84:87], v[100:103], a[208:211], v[84:87]
    v_mfma_f32_16x16x32_bf16 v[80:83], v[96:99], a[212:215], v[80:83]
    v_mfma_f32_16x16x32_bf16 v[84:87], v[100:103], a[212:215], v[84:87]
    s_cmp_eq_u32 s67, 0
    s_cselect_b64 vcc, -1, 0
    v_cndmask_b32 v106, v20, v16, vcc
    v_cndmask_b32 v63, v21, v17, vcc
    v_mov_b32 v107, v106
    v_cvt_pk_bf16_f32 v60, v72, v73
    v_lshlrev_b32 v56, 16, v60
    v_and_b32 v57, 0xffff0000, v60
    v_mul_f32 v56, v63, v56
    v_mul_f32 v57, v63, v57
    v_cvt_pk_bf16_f32 v60, v56, v57
    v_lshlrev_b32 v72, 16, v60
    v_and_b32 v73, 0xffff0000, v60
    v_cvt_pk_bf16_f32 v60, v74, v75
    v_lshlrev_b32 v56, 16, v60
    v_and_b32 v57, 0xffff0000, v60
    v_mul_f32 v56, v63, v56
    v_mul_f32 v57, v63, v57
    v_cvt_pk_bf16_f32 v60, v56, v57
    v_lshlrev_b32 v74, 16, v60
    v_and_b32 v75, 0xffff0000, v60
    v_cvt_pk_bf16_f32 v60, v76, v77
    v_lshlrev_b32 v56, 16, v60
    v_and_b32 v57, 0xffff0000, v60
    v_mul_f32 v56, v63, v56
    v_mul_f32 v57, v63, v57
    v_cvt_pk_bf16_f32 v60, v56, v57
    v_lshlrev_b32 v76, 16, v60
    v_and_b32 v77, 0xffff0000, v60
    v_cvt_pk_bf16_f32 v60, v78, v79
    v_lshlrev_b32 v56, 16, v60
    v_and_b32 v57, 0xffff0000, v60
    v_mul_f32 v56, v63, v56
    v_mul_f32 v57, v63, v57
    v_cvt_pk_bf16_f32 v60, v56, v57
    v_lshlrev_b32 v78, 16, v60
    v_and_b32 v79, 0xffff0000, v60
    s_nop 7
    s_nop 1
    s_cmp_eq_u32 s71, 0
    s_cselect_b64 vcc, -1, 0
    v_cndmask_b32 v108, v20, v16, vcc
    v_cndmask_b32 v63, v21, v17, vcc
    v_mov_b32 v109, v108
    v_cvt_pk_bf16_f32 v60, v80, v81
    v_lshlrev_b32 v56, 16, v60
    v_and_b32 v57, 0xffff0000, v60
    v_mul_f32 v56, v63, v56
    v_mul_f32 v57, v63, v57
    v_cvt_pk_bf16_f32 v60, v56, v57
    v_lshlrev_b32 v80, 16, v60
    v_and_b32 v81, 0xffff0000, v60
    v_cvt_pk_bf16_f32 v60, v82, v83
    v_lshlrev_b32 v56, 16, v60
    v_and_b32 v57, 0xffff0000, v60
    v_mul_f32 v56, v63, v56
    v_mul_f32 v57, v63, v57
    v_cvt_pk_bf16_f32 v60, v56, v57
    v_lshlrev_b32 v82, 16, v60
    v_and_b32 v83, 0xffff0000, v60
    v_cvt_pk_bf16_f32 v60, v84, v85
    v_lshlrev_b32 v56, 16, v60
    v_and_b32 v57, 0xffff0000, v60
    v_mul_f32 v56, v63, v56
    v_mul_f32 v57, v63, v57
    v_cvt_pk_bf16_f32 v60, v56, v57
    v_lshlrev_b32 v84, 16, v60
    v_and_b32 v85, 0xffff0000, v60
    v_cvt_pk_bf16_f32 v60, v86, v87
    v_lshlrev_b32 v56, 16, v60
    v_and_b32 v57, 0xffff0000, v60
    v_mul_f32 v56, v63, v56
    v_mul_f32 v57, v63, v57
    v_cvt_pk_bf16_f32 v60, v56, v57
    v_lshlrev_b32 v86, 16, v60
    v_and_b32 v87, 0xffff0000, v60
    s_waitcnt vmcnt(0)
    s_mov_b32 s29, 262144
L_pc4:
    v_max_u32 v15, v112, v113
    v_max3_u32 v15, v15, v114, v115
    v_max3_u32 v15, v15, v116, v117
    v_max3_u32 v15, v15, v118, v119
    v_max3_u32 v15, v15, v120, v121
    v_max3_u32 v15, v15, v122, v123
    v_cmp_eq_u32 vcc, -1, v15
    s_cbranch_vccz L_pc4_ok
    s_sub_u32 s29, s29, 1
    s_cbranch_scc1 L_pc4_ok
    buffer_load_dwordx2 v[112:113], v8, s[16:19], s62 offen sc0 sc1
    buffer_load_dwordx2 v[114:115], v9, s[16:19], s62 offen sc0 sc1
    buffer_load_dwordx2 v[116:117], v8, s[16:19], s66 offen sc0 sc1
    buffer_load_dwordx2 v[118:119], v9, s[16:19], s66 offen sc0 sc1
    buffer_load_dwordx2 v[120:121], v8, s[16:19], s70 offen sc0 sc1
    buffer_load_dwordx2 v[122:123], v9, s[16:19], s70 offen sc0 sc1
    s_waitcnt vmcnt(0)
    s_branch L_pc4
L_pc4_ok:
    v_lshlrev_b32 v56, 16, v112
    v_and_b32 v57, 0xffff0000, v112
    v_lshlrev_b32 v58, 16, v113
    v_and_b32 v59, 0xffff0000, v113
    v_lshlrev_b32 v60, 16, v114
    v_and_b32 v61, 0xffff0000, v114
    v_lshlrev_b32 v62, 16, v115
    v_and_b32 v63, 0xffff0000, v115
    v_pk_add_f32 v[56:57], v[56:57], v[24:25]
    v_pk_add_f32 v[58:59], v[58:59], v[26:27]
    v_pk_add_f32 v[60:61], v[60:61], v[28:29]
    v_pk_add_f32 v[62:63], v[62:63], v[30:31]
    v_cvt_pk_bf16_f32 v112, v56, v57
    v_cvt_pk_bf16_f32 v113, v58, v59
    v_cvt_pk_bf16_f32 v114, v60, v61
    v_cvt_pk_bf16_f32 v115, v62, v63
    v_lshlrev_b32 v56, 16, v112
    v_and_b32 v57, 0xffff0000, v112
    v_lshlrev_b32 v58, 16, v113
    v_and_b32 v59, 0xffff0000, v113
    v_lshlrev_b32 v60, 16, v114
    v_and_b32 v61, 0xffff0000, v114
    v_lshlrev_b32 v62, 16, v115
    v_and_b32 v63, 0xffff0000, v115
    v_pk_mul_f32 v[56:57], v[56:57], v[104:105]
    v_pk_mul_f32 v[58:59], v[58:59], v[104:105]
    v_pk_mul_f32 v[60:61], v[60:61], v[104:105]
    v_pk_mul_f32 v[62:63], v[62:63], v[104:105]
    v_cvt_pk_bf16_f32 v112, v56, v57
    v_cvt_pk_bf16_f32 v113, v58, v59
    v_cvt_pk_bf16_f32 v114, v60, v61
    v_cvt_pk_bf16_f32 v115, v62, v63
    v_lshlrev_b32 v56, 16, v112
    v_and_b32 v57, 0xffff0000, v112
    v_lshlrev_b32 v58, 16, v113
    v_and_b32 v59, 0xffff0000, v113
    v_lshlrev_b32 v60, 16, v114
    v_and_b32 v61, 0xffff0000, v114
    v_lshlrev_b32 v62, 16, v115
    v_and_b32 v63, 0xffff0000, v115
    v_pk_add_f32 v[56:57], v[56:57], v[64:65]
    v_pk_add_f32 v[58:59], v[58:59], v[66:67]
    v_pk_add_f32 v[60:61], v[60:61], v[68:69]
    v_pk_add_f32 v[62:63], v[62:63], v[70:71]
    v_cvt_pk_bf16_f32 v112, v56, v57
    v_cvt_pk_bf16_f32 v113, v58, v59
    v_cvt_pk_bf16_f32 v114, v60, v61
    v_cvt_pk_bf16_f32 v115, v62, v63
    buffer_store_dwordx4 v[112:115], v5, s[44:47], s61 offen
    v_lshlrev_b32 v56, 16, v116
    v_and_b32 v57, 0xffff0000, v116
    v_lshlrev_b32 v58, 16, v117
    v_and_b32 v59, 0xffff0000, v117
    v_lshlrev_b32 v60, 16, v118
    v_and_b32 v61, 0xffff0000, v118
    v_lshlrev_b32 v62, 16, v119
    v_and_b32 v63, 0xffff0000, v119
    v_pk_add_f32 v[56:57], v[56:57], v[32:33]
    v_pk_add_f32 v[58:59], v[58:59], v[34:35]
    v_pk_add_f32 v[60:61], v[60:61], v[36:37]
    v_pk_add_f32 v[62:63], v[62:63], v[38:39]
    v_cvt_pk_bf16_f32 v116, v56, v57
    v_cvt_pk_bf16_f32 v117, v58, v59
    v_cvt_pk_bf16_f32 v118, v60, v61
    v_cvt_pk_bf16_f32 v119, v62, v63
    v_lshlrev_b32 v56, 16, v116
    v_and_b32 v57, 0xffff0000, v116
    v_lshlrev_b32 v58, 16, v117
    v_and_b32 v59, 0xffff0000, v117
    v_lshlrev_b32 v60, 16, v118
    v_and_b32 v61, 0xffff0000, v118
    v_lshlrev_b32 v62, 16, v119
    v_and_b32 v63, 0xffff0000, v119
    v_pk_mul_f32 v[56:57], v[56:57], v[106:107]
    v_pk_mul_f32 v[58:59], v[58:59], v[106:107]
    v_pk_mul_f32 v[60:61], v[60:61], v[106:107]
    v_pk_mul_f32 v[62:63], v[62:63], v[106:107]
    v_cvt_pk_bf16_f32 v116, v56, v57
    v_cvt_pk_bf16_f32 v117, v58, v59
    v_cvt_pk_bf16_f32 v118, v60, v61
    v_cvt_pk_bf16_f32 v119, v62, v63
    v_lshlrev_b32 v56, 16, v116
    v_and_b32 v57, 0xffff0000, v116
    v_lshlrev_b32 v58, 16, v117
    v_and_b32 v59, 0xffff0000, v117
    v_lshlrev_b32 v60, 16, v118
    v_and_b32 v61, 0xffff0000, v118
    v_lshlrev_b32 v62, 16, v119
    v_and_b32 v63, 0xffff0000, v119
    v_pk_add_f32 v[56:57], v[56:57], v[72:73]
    v_pk_add_f32 v[58:59], v[58:59], v[74:75]
    v_pk_add_f32 v[60:61], v[60:61], v[76:77]
    v_pk_add_f32 v[62:63], v[62:63], v[78:79]
    v_cvt_pk_bf16_f32 v116, v56, v57
    v_cvt_pk_bf16_f32 v117, v58, v59
    v_cvt_pk_bf16_f32 v118, v60, v61
    v_cvt_pk_bf16_f32 v119, v62, v63
    buffer_store_dwordx4 v[116:119], v5, s[44:47], s65 offen
    v_lshlrev_b32 v56, 16, v120
    v_and_b32 v57, 0xffff0000, v120
    v_lshlrev_b32 v58, 16, v121
    v_and_b32 v59, 0xffff0000, v121
    v_lshlrev_b32 v60, 16, v122
    v_and_b32 v61, 0xffff0000, v122
    v_lshlrev_b32 v62, 16, v123
    v_and_b32 v63, 0xffff0000, v123
    v_pk_add_f32 v[56:57], v[56:57], v[40:41]
    v_pk_add_f32 v[58:59], v[58:59], v[42:43]
    v_pk_add_f32 v[60:61], v[60:61], v[44:45]
    v_pk_add_f32 v[62:63], v[62:63], v[46:47]
    v_cvt_pk_bf16_f32 v120, v56, v57
    v_cvt_pk_bf16_f32 v121, v58, v59
    v_cvt_pk_bf16_f32 v122, v60, v61
    v_cvt_pk_bf16_f32 v123, v62, v63
    v_lshlrev_b32 v56, 16, v120
    v_and_b32 v57, 0xffff0000, v120
    v_lshlrev_b32 v58, 16, v121
    v_and_b32 v59, 0xffff0000, v121
    v_lshlrev_b32 v60, 16, v122
    v_and_b32 v61, 0xffff0000, v122
    v_lshlrev_b32 v62, 16, v123
    v_and_b32 v63, 0xffff0000, v123
    v_pk_mul_f32 v[56:57], v[56:57], v[108:109]
    v_pk_mul_f32 v[58:59], v[58:59], v[108:109]
    v_pk_mul_f32 v[60:61], v[60:61], v[108:109]
    v_pk_mul_f32 v[62:63], v[62:63], v[108:109]
    v_cvt_pk_bf16_f32 v120, v56, v57
    v_cvt_pk_bf16_f32 v121, v58, v59
    v_cvt_pk_bf16_f32 v122, v60, v61
    v_cvt_pk_bf16_f32 v123, v62, v63
    v_lshlrev_b32 v56, 16, v120
    v_and_b32 v57, 0xffff0000, v120
    v_lshlrev_b32 v58, 16, v121
    v_and_b32 v59, 0xffff0000, v121
    v_lshlrev_b32 v60, 16, v122
    v_and_b32 v61, 0xffff0000, v122
    v_lshlrev_b32 v62, 16, v123
    v_and_b32 v63, 0xffff0000, v123
    v_pk_add_f32 v[56:57], v[56:57], v[80:81]
    v_pk_add_f32 v[58:59], v[58:59], v[82:83]
    v_pk_add_f32 v[60:61], v[60:61], v[84:85]
    v_pk_add_f32 v[62:63], v[62:63], v[86:87]
    v_cvt_pk_bf16_f32 v120, v56, v57
    v_cvt_pk_bf16_f32 v121, v58, v59
    v_cvt_pk_bf16_f32 v122, v60, v61
    v_cvt_pk_bf16_f32 v123, v62, v63
    buffer_store_dwordx4 v[120:123], v5, s[44:47], s69 offen
L_done:
    s_endpgm
L_end:
.section .rodata,"a"
.p2align 6
.amdhsa_kernel gated_mix__ssm_conv_s4__swiglu_ffn__prompt_kernel
  .amdhsa_next_free_vgpr 512
  .amdhsa_next_free_sgpr 102
  .amdhsa_accum_offset 256
  .amdhsa_group_segment_fixed_size 0
  .amdhsa_kernarg_size 136
  .amdhsa_user_sgpr_count 2
  .amdhsa_user_sgpr_kernarg_segment_ptr 1
  .amdhsa_system_sgpr_workgroup_id_x 1
  .amdhsa_float_denorm_mode_32 3
.end_amdhsa_kernel
```
